```python
import torch

def _softmax(x, axis=-1):
    return torch.softmax(x, dim=axis)

def _gelu(x):
    return torch.nn.functional.gelu(x, approximate='tanh')

def _silu(x):
    return torch.nn.functional.silu(x)

def _sigmoid(x):
    return torch.sigmoid(x)

def _layernorm(x, axis=-1, eps=1e-05):
    m = x.mean(dim=axis, keepdim=True)
    v = x.var(dim=axis, keepdim=True, unbiased=False)
    return (x - m) / torch.sqrt(v + eps)

def _scatter_add(tgt, idx, src, axis=0):
    return tgt.clone().index_add_(axis, idx, src)

def _segment_sum(src, seg, n):
    out = torch.zeros((n,) + src.shape[1:], dtype=src.dtype)
    return out.index_add_(0, seg, src)

def _pad(x, pw):
    flat = tuple((v for pair in reversed(pw) for v in pair))
    return torch.nn.functional.pad(x, flat)
kernel_name = 'interleave_layers__linear_attn_block__memory_aug_recurrent_mem_tr__prompt'

def setup_inputs():

    _w = lambda a: (lambda t: t.to(torch.bfloat16) if t.is_floating_point() else t)(torch.as_tensor(a))

    def _A_setup():
        B, S, D = (1, 2048, 512)
        return {'x': _w((lambda *s: torch.randn(*s, dtype=torch.bfloat16) * 0.05)(B, S, D)), 'wqkv': _w((lambda *s: torch.randn(*s, dtype=torch.bfloat16) * 0.05)(D, 3 * D)), 'wo': _w((lambda *s: torch.randn(*s, dtype=torch.bfloat16) * 0.05)(D, D))}
    _A_in = _A_setup()

    def _B_setup():
        B, S, Dm = (1, 2048, 512)
        H, Dh = (32, 128)
        M, seg = (8, 32)
        seg = min(seg, S)
        S = S // seg * seg
        return {'x': _w((lambda *s: torch.randn(*s, dtype=torch.bfloat16) * 0.05)(B, S, Dm)), 'mem0': _w((lambda *s: torch.randn(*s, dtype=torch.bfloat16) * 0.4)(B, M, Dm)), 'Wq': _w((lambda *s: torch.randn(*s, dtype=torch.bfloat16) * 3.2)(Dm, H, Dh) * Dm ** (-0.5)), 'Wk': _w((lambda *s: torch.randn(*s, dtype=torch.bfloat16) * 3.2)(Dm, H, Dh) * Dm ** (-0.5)), 'Wv': _w((lambda *s: torch.randn(*s, dtype=torch.bfloat16) * 0.4)(Dm, H, Dh) * Dm ** (-0.5)), 'Wo': _w((lambda *s: torch.randn(*s, dtype=torch.bfloat16) * 0.4)(H, Dh, Dm) * (H * Dh) ** (-0.5)), 'seg_len': seg}
    _B_in = _B_setup()
    return {'A_x': _A_in['x'], 'A_wqkv': _A_in['wqkv'], 'A_wo': _A_in['wo'], 'B_x': _B_in['x'], 'B_mem0': _B_in['mem0'], 'B_Wq': _B_in['Wq'], 'B_Wk': _B_in['Wk'], 'B_Wv': _B_in['Wv'], 'B_Wo': _B_in['Wo'], 'B_seg_len': _B_in['seg_len']}

def reference(A_x, A_wqkv, A_wo, B_x, B_mem0, B_Wq, B_Wk, B_Wv, B_Wo, B_seg_len):

    def _A_ref(x, wqkv, wo):
        B, S, D = x.shape
        H = 32
        Dh = D // H
        qkv = (lambda x, *d: x.permute(*d))((x @ wqkv).reshape(B, S, 3, H, Dh), 2, 0, 3, 1, 4)
        q, k, v = (qkv[0], qkv[1], qkv[2])
        phi = lambda t: torch.where(t > 0, t + 1, torch.exp(t)) + 1e-06
        pq, pk = (phi(q), phi(k))
        kv = torch.einsum('bhsd,bhse->bhde', pk, v)
        z = torch.einsum('bhsd->bhd', pk)
        num = torch.einsum('bhqd,bhde->bhqe', pq, kv)
        den = torch.einsum('bhqd,bhd->bhq', pq, z)[..., None] + 1e-06
        o = num / den
        return (lambda x, *d: x.permute(*d))(o, 0, 2, 1, 3).reshape(B, S, D) @ wo

    def _B_ref(x, mem0, Wq, Wk, Wv, Wo, seg_len):
        B, S, Dm = x.shape
        H, Dh = (Wq.shape[1], Wq.shape[2])
        M = mem0.shape[1]
        scale = Dh ** (-0.5)
        n_seg = S // seg_len
        L = M + seg_len
        idx = torch.arange(L)
        mask = (idx[:, None] < M) | (idx[:, None] >= idx[None, :])
        mem = mem0
        outs = []
        for s in range(n_seg):
            xs = x[:, s * seg_len:(s + 1) * seg_len, :].clone()
            h = torch.concatenate([mem, xs], axis=1)
            q = torch.einsum('btd,dhe->bhte', h, Wq)
            k = torch.einsum('btd,dhe->bhte', h, Wk)
            v = torch.einsum('btd,dhe->bhte', h, Wv)
            scores = torch.einsum('bhqe,bhke->bhqk', q, k) * scale
            scores = torch.where(mask[None, None], scores, -1000000000.0)
            p = _softmax(scores, axis=-1)
            o = torch.einsum('bhqk,bhke->bhqe', p, v)
            o = torch.einsum('bhte,hed->btd', o, Wo)
            mem = o[:, :M, :].clone()
            outs.append(o[:, M:, :])
        return torch.concatenate(outs, axis=1)
    x = A_x
    x = x + _A_ref(_layernorm(x, axis=-1), A_wqkv, A_wo)
    x = x + _B_ref(_layernorm(x, axis=-1), B_mem0, B_Wq, B_Wk, B_Wv, B_Wo, B_seg_len)
    x = x + _A_ref(_layernorm(x, axis=-1), A_wqkv, A_wo)
    x = x + _B_ref(_layernorm(x, axis=-1), B_mem0, B_Wq, B_Wk, B_Wv, B_Wo, B_seg_len)
    return x
```

```asm
; @launch grid=(256,1,1) block=(256,1,1) lds=163840
.amdgcn_target "amdgcn-amd-amdhsa--gfx950"
.text
.globl interleave_layers__linear_attn_block__memory_aug_recurrent_mem_tr__prompt_kernel
.p2align 8
.type interleave_layers__linear_attn_block__memory_aug_recurrent_mem_tr__prompt_kernel,@function
interleave_layers__linear_attn_block__memory_aug_recurrent_mem_tr__prompt_kernel:
    s_cmp_ge_u32 s2, 256
    s_cbranch_scc1 L_end
    s_mov_b32 s101, 0
    s_load_dwordx4 s[8:11], s[0:1], 0
    s_load_dwordx2 s[12:13], s[0:1], 16
    s_load_dwordx4 s[16:19], s[0:1], 32
    s_load_dwordx4 s[20:23], s[0:1], 48
    s_load_dwordx2 s[24:25], s[0:1], 64
    s_load_dwordx4 s[28:31], s[0:1], 80
    s_load_dwordx2 s[4:5], s[0:1], 96
    s_getreg_b32 s36, hwreg(HW_REG_XCC_ID)
    s_and_b32 s36, s36, 15
    s_lshl_b32 s37, s36, 2
    s_lshr_b32 s37, 0x43210765, s37
    s_and_b32 s37, s37, 7
    s_cmp_lt_u32 s36, 8
    s_cselect_b32 s36, s37, s36
    s_mov_b32 s32, s36
    v_lshrrev_b32 v1, 6, v0
    s_nop 0
    v_readfirstlane_b32 s34, v1
    s_waitcnt lgkmcnt(0)
    s_cmp_lg_u32 s34, 0
    s_cbranch_scc1 L_noticket
    s_and_b32 s37, s32, 4
    s_lshl_b32 s37, s37, 5
    s_and_b32 s36, s32, 3
    s_lshl_b32 s36, s36, 2
    s_add_u32 s37, s37, s36
    s_and_b32 s36, s32, 8
    s_lshl_b32 s36, s36, 1
    s_add_u32 s37, s37, s36
    v_mov_b32 v1, s37
    v_mov_b32 v2, 1
    s_mov_b64 exec, 1
    global_atomic_add v3, v1, v2, s[30:31] sc0
    s_mov_b64 exec, -1
L_noticket:
    v_mov_b32 v6, 0
    s_cmp_lg_u32 s34, 0
    s_cbranch_scc1 L_nowr
    s_waitcnt vmcnt(0)
    s_mov_b64 exec, 1
    ds_write_b32 v6, v3
    s_mov_b64 exec, -1
L_nowr:
    s_waitcnt lgkmcnt(0)
    s_barrier
    ds_read_b32 v3, v6
    s_waitcnt lgkmcnt(0)
    v_readfirstlane_b32 s33, v3
    s_barrier
    s_cmp_ge_u32 s32, 8
    s_cbranch_scc1 L_overflow
    s_cmp_ge_u32 s33, 32
    s_cbranch_scc1 L_overflow
L_roles:
    s_cmp_gt_u32 s32, 2
    s_cbranch_scc1 L_aworker
    s_cmp_lg_u32 s32, 0
    s_cbranch_scc1 L_p1
L_chain:
    v_and_b32 v40, 63, v0
    v_and_b32 v41, 15, v0
    v_bfe_u32 v42, v0, 4, 2
    v_lshlrev_b32 v1, 4, v40
    v_mov_b32 v11, -1
    v_lshlrev_b32 v2, 2, v40
    v_xor_b32 v4, v40, v42
    v_lshlrev_b32 v4, 3, v4
    s_lshl_b32 s40, s34, 10
    v_lshlrev_b32 v5, 5, v41
    v_lshrrev_b32 v43, 2, v41
    v_xor_b32 v43, v43, v42
    v_lshl_add_u32 v5, v43, 3, v5
    v_add_u32 v5, s40, v5
    s_lshr_b32 s41, s34, 1
    s_lshl_b32 s41, s41, 10
    s_and_b32 s42, s34, 1
    s_lshl_b32 s42, s42, 5
    s_add_u32 s41, s41, s42
    s_add_u32 s41, s41, 28640
    v_add_u32 v6, s41, v1
    s_sub_u32 s42, 16416, s42
    v_add_u32 v45, s42, v1
    v_and_b32 v43, 2, v40
    v_cmp_ne_u32 vcc, 0, v43
    v_mov_b32 v46, 0xeeee
    v_mov_b32 v47, 0x4444
    v_cndmask_b32 v6, v45, v6, vcc
    v_cndmask_b32 v10, v47, v46, vcc
    v_lshrrev_b32 v45, 3, v41
    v_lshlrev_b32 v7, 13, v45
    v_and_b32 v45, 7, v41
    v_lshl_add_u32 v45, v42, 3, v45
    v_lshl_add_u32 v7, v45, 4, v7
    s_lshl_b32 s41, s34, 15
    s_add_u32 s41, s41, 32768
    v_add_u32 v7, s41, v7
    s_lshl_b32 s41, s34, 11
    v_add_u32 v3, s41, v1
    s_mov_b32 s77, s41
    s_add_u32 s51, s41, 8192
    v_lshrrev_b32 v45, 2, v41
    v_lshlrev_b32 v8, 13, v45
    v_and_b32 v45, 3, v41
    v_lshl_add_u32 v46, v42, 2, v45
    v_lshl_add_u32 v8, v46, 4, v8
    s_lshl_b32 s41, s34, 16
    s_lshl_b32 s42, s33, 8
    s_add_u32 s41, s41, s42
    v_add_u32 v8, s41, v8
    v_and_b32 v46, 12, v41
    v_add_u32 v46, v46, v42
    v_lshlrev_b32 v9, 4, v46
    v_lshl_add_u32 v9, v45, 2, v9
    v_add_u32 v9, s42, v9
    v_and_b32 v45, 1, v40
    v_lshlrev_b32 v45, 4, v45
    v_mov_b32 v47, 0x3f80
    v_lshlrev_b32 v47, v45, v47
    v_cndmask_b32_e64 v12, v47, 0, vcc
    v_lshrrev_b32 v46, 2, v41
    v_cmp_eq_u32 s[88:89], 2, v46
    v_cmp_eq_u32 s[90:91], 3, v46
    v_cmp_eq_u32 s[92:93], 0, v46
    v_cmp_eq_u32 s[94:95], 1, v46
    v_mov_b64 v[16:17], 0
    v_mov_b64 v[18:19], 0
    v_mov_b64 v[20:21], 0
    v_mov_b64 v[22:23], 0
    s_mov_b32 s96, 0x3e0293ee
    s_mov_b32 s97, s96
    s_cmp_eq_u32 s34, 0
    s_cselect_b32 s76, 2, 64
    s_mov_b32 s50, 0
    s_mov_b32 s48, 0
    v_mov_b64 v[44:45], -1
    v_mov_b64 v[46:47], -1
    s_lshl_b32 s40, s33, 13
    s_add_u32 s41, s40, 0x100000
    s_add_u32 s42, s4, s41
    s_addc_u32 s43, s5, 0
    global_store_dwordx4 v3, v[44:47], s[42:43] offset:0 sc1
    global_store_dwordx4 v3, v[44:47], s[42:43] offset:1024 sc1
    s_add_u32 s41, s40, 0x140000
    s_add_u32 s42, s4, s41
    s_addc_u32 s43, s5, 0
    global_store_dwordx4 v3, v[44:47], s[42:43] offset:0 sc1
    global_store_dwordx4 v3, v[44:47], s[42:43] offset:1024 sc1
    s_lshl_b32 s41, s34, 13
    s_add_u32 s41, s41, 0x180000
    s_add_u32 s42, s4, s41
    s_addc_u32 s43, s5, 0
    global_store_dword v9, v44, s[42:43] sc1
    s_add_u32 s41, s40, 0x4000000
    s_add_u32 s42, s4, s41
    s_addc_u32 s43, s5, 0
    global_store_dwordx4 v3, v[44:47], s[42:43] offset:0 sc1
    global_store_dwordx4 v3, v[44:47], s[42:43] offset:1024 sc1
    s_add_u32 s41, s40, 0x6000000
    s_add_u32 s42, s4, s41
    s_addc_u32 s43, s5, 0
    global_store_dwordx4 v3, v[44:47], s[42:43] offset:0 sc1
    global_store_dwordx4 v3, v[44:47], s[42:43] offset:1024 sc1
    s_add_u32 s41, s40, 0x5000000
    s_add_u32 s42, s4, s41
    s_addc_u32 s43, s5, 0
    global_store_dwordx4 v3, v[44:47], s[42:43] offset:0 sc1
    global_store_dwordx4 v3, v[44:47], s[42:43] offset:1024 sc1
    s_add_u32 s41, s40, 0x7000000
    s_add_u32 s42, s4, s41
    s_addc_u32 s43, s5, 0
    global_store_dwordx4 v3, v[44:47], s[42:43] offset:0 sc1
    global_store_dwordx4 v3, v[44:47], s[42:43] offset:1024 sc1
    s_nop 1
    v_and_b32 v47, 63, v0
    v_lshrrev_b32 v48, 4, v47
    v_bfe_u32 v49, v47, 2, 2
    v_and_b32 v50, 3, v47
    v_and_b32 v52, 15, v47
    s_lshl_b32 s40, s33, 8
    s_lshl_b32 s41, s34, 17
    s_add_u32 s40, s40, s41
    v_lshlrev_b32 v53, 1, v48
    v_xor_b32 v53, v53, v52
    v_lshlrev_b32 v53, 4, v53
    v_lshl_add_u32 v40, v48, 13, v53
    v_add_u32 v40, s40, v40
    v_lshlrev_b32 v53, 1, v48
    v_or_b32 v53, 8, v53
    v_xor_b32 v53, v53, v52
    v_lshlrev_b32 v53, 4, v53
    v_lshl_add_u32 v41, v48, 13, v53
    v_add_u32 v41, s40, v41
    s_lshl_b32 s41, s34, 2
    v_lshrrev_b32 v53, 1, v50
    v_add_u32 v53, s41, v53
    v_and_b32 v54, 1, v48
    v_lshlrev_b32 v54, 3, v54
    v_lshl_add_u32 v54, v49, 1, v54
    v_xor_b32 v53, v53, v54
    v_lshlrev_b32 v53, 4, v53
    v_and_b32 v54, 1, v50
    v_lshl_add_u32 v53, v54, 3, v53
    v_lshl_add_u32 v54, v48, 3, v49
    v_lshl_add_u32 v42, v54, 8, v53
    v_xor_b32 v43, 32, v42
    s_lshl_b32 s47, s34, 12
    s_lshl_b32 s46, s34, 15
    s_add_u32 s46, s46, 32768
    v_lshrrev_b32 v44, 2, v47
    v_lshlrev_b32 v44, 10, v44
    v_lshl_add_u32 v44, v50, 4, v44
    s_lshl_b32 s40, s33, 17
    s_lshl_b32 s41, s34, 8
    s_add_u32 s40, s40, s41
    v_add_u32 v44, s40, v44
    s_add_u32 s42, s24, 0x0
    s_addc_u32 s43, s25, 0
    s_add_u32 s44, s46, 16384
    s_mov_b32 m0, s44
    s_add_u32 s44, s44, 1024
    global_load_lds_dwordx4 v44, s[42:43]
    s_add_u32 s42, s42, 0x4000
    s_addc_u32 s43, s43, 0
    s_mov_b32 m0, s44
    s_add_u32 s44, s44, 1024
    global_load_lds_dwordx4 v44, s[42:43]
    s_add_u32 s42, s42, 0x4000
    s_addc_u32 s43, s43, 0
    s_mov_b32 m0, s44
    s_add_u32 s44, s44, 1024
    global_load_lds_dwordx4 v44, s[42:43]
    s_add_u32 s42, s42, 0x4000
    s_addc_u32 s43, s43, 0
    s_mov_b32 m0, s44
    s_add_u32 s44, s44, 1024
    global_load_lds_dwordx4 v44, s[42:43]
    s_add_u32 s42, s42, 0x4000
    s_addc_u32 s43, s43, 0
    s_mov_b32 m0, s44
    s_add_u32 s44, s44, 1024
    global_load_lds_dwordx4 v44, s[42:43]
    s_add_u32 s42, s42, 0x4000
    s_addc_u32 s43, s43, 0
    s_mov_b32 m0, s44
    s_add_u32 s44, s44, 1024
    global_load_lds_dwordx4 v44, s[42:43]
    s_add_u32 s42, s42, 0x4000
    s_addc_u32 s43, s43, 0
    s_mov_b32 m0, s44
    s_add_u32 s44, s44, 1024
    global_load_lds_dwordx4 v44, s[42:43]
    s_add_u32 s42, s42, 0x4000
    s_addc_u32 s43, s43, 0
    s_mov_b32 m0, s44
    s_add_u32 s44, s44, 1024
    global_load_lds_dwordx4 v44, s[42:43]
    s_add_u32 s42, s24, 0x40
    s_addc_u32 s43, s25, 0
    s_add_u32 s44, s46, 24576
    s_mov_b32 m0, s44
    s_add_u32 s44, s44, 1024
    global_load_lds_dwordx4 v44, s[42:43]
    s_add_u32 s42, s42, 0x4000
    s_addc_u32 s43, s43, 0
    s_mov_b32 m0, s44
    s_add_u32 s44, s44, 1024
    global_load_lds_dwordx4 v44, s[42:43]
    s_add_u32 s42, s42, 0x4000
    s_addc_u32 s43, s43, 0
    s_mov_b32 m0, s44
    s_add_u32 s44, s44, 1024
    global_load_lds_dwordx4 v44, s[42:43]
    s_add_u32 s42, s42, 0x4000
    s_addc_u32 s43, s43, 0
    s_mov_b32 m0, s44
    s_add_u32 s44, s44, 1024
    global_load_lds_dwordx4 v44, s[42:43]
    s_add_u32 s42, s42, 0x4000
    s_addc_u32 s43, s43, 0
    s_mov_b32 m0, s44
    s_add_u32 s44, s44, 1024
    global_load_lds_dwordx4 v44, s[42:43]
    s_add_u32 s42, s42, 0x4000
    s_addc_u32 s43, s43, 0
    s_mov_b32 m0, s44
    s_add_u32 s44, s44, 1024
    global_load_lds_dwordx4 v44, s[42:43]
    s_add_u32 s42, s42, 0x4000
    s_addc_u32 s43, s43, 0
    s_mov_b32 m0, s44
    s_add_u32 s44, s44, 1024
    global_load_lds_dwordx4 v44, s[42:43]
    s_add_u32 s42, s42, 0x4000
    s_addc_u32 s43, s43, 0
    s_mov_b32 m0, s44
    s_add_u32 s44, s44, 1024
    global_load_lds_dwordx4 v44, s[42:43]
    s_add_u32 s42, s24, 0x80
    s_addc_u32 s43, s25, 0
    s_add_u32 s44, s46, 0
    s_mov_b32 m0, s44
    s_add_u32 s44, s44, 1024
    global_load_lds_dwordx4 v44, s[42:43]
    s_add_u32 s42, s42, 0x4000
    s_addc_u32 s43, s43, 0
    s_mov_b32 m0, s44
    s_add_u32 s44, s44, 1024
    global_load_lds_dwordx4 v44, s[42:43]
    s_add_u32 s42, s42, 0x4000
    s_addc_u32 s43, s43, 0
    s_mov_b32 m0, s44
    s_add_u32 s44, s44, 1024
    global_load_lds_dwordx4 v44, s[42:43]
    s_add_u32 s42, s42, 0x4000
    s_addc_u32 s43, s43, 0
    s_mov_b32 m0, s44
    s_add_u32 s44, s44, 1024
    global_load_lds_dwordx4 v44, s[42:43]
    s_add_u32 s42, s42, 0x4000
    s_addc_u32 s43, s43, 0
    s_mov_b32 m0, s44
    s_add_u32 s44, s44, 1024
    global_load_lds_dwordx4 v44, s[42:43]
    s_add_u32 s42, s42, 0x4000
    s_addc_u32 s43, s43, 0
    s_mov_b32 m0, s44
    s_add_u32 s44, s44, 1024
    global_load_lds_dwordx4 v44, s[42:43]
    s_add_u32 s42, s42, 0x4000
    s_addc_u32 s43, s43, 0
    s_mov_b32 m0, s44
    s_add_u32 s44, s44, 1024
    global_load_lds_dwordx4 v44, s[42:43]
    s_add_u32 s42, s42, 0x4000
    s_addc_u32 s43, s43, 0
    s_mov_b32 m0, s44
    s_add_u32 s44, s44, 1024
    global_load_lds_dwordx4 v44, s[42:43]
    s_add_u32 s42, s24, 0xc0
    s_addc_u32 s43, s25, 0
    s_add_u32 s44, s46, 8192
    s_mov_b32 m0, s44
    s_add_u32 s44, s44, 1024
    global_load_lds_dwordx4 v44, s[42:43]
    s_add_u32 s42, s42, 0x4000
    s_addc_u32 s43, s43, 0
    s_mov_b32 m0, s44
    s_add_u32 s44, s44, 1024
    global_load_lds_dwordx4 v44, s[42:43]
    s_add_u32 s42, s42, 0x4000
    s_addc_u32 s43, s43, 0
    s_mov_b32 m0, s44
    s_add_u32 s44, s44, 1024
    global_load_lds_dwordx4 v44, s[42:43]
    s_add_u32 s42, s42, 0x4000
    s_addc_u32 s43, s43, 0
    s_mov_b32 m0, s44
    s_add_u32 s44, s44, 1024
    global_load_lds_dwordx4 v44, s[42:43]
    s_add_u32 s42, s42, 0x4000
    s_addc_u32 s43, s43, 0
    s_mov_b32 m0, s44
    s_add_u32 s44, s44, 1024
    global_load_lds_dwordx4 v44, s[42:43]
    s_add_u32 s42, s42, 0x4000
    s_addc_u32 s43, s43, 0
    s_mov_b32 m0, s44
    s_add_u32 s44, s44, 1024
    global_load_lds_dwordx4 v44, s[42:43]
    s_add_u32 s42, s42, 0x4000
    s_addc_u32 s43, s43, 0
    s_mov_b32 m0, s44
    s_add_u32 s44, s44, 1024
    global_load_lds_dwordx4 v44, s[42:43]
    s_add_u32 s42, s42, 0x4000
    s_addc_u32 s43, s43, 0
    s_mov_b32 m0, s44
    s_add_u32 s44, s44, 1024
    global_load_lds_dwordx4 v44, s[42:43]
    s_add_u32 s42, s18, 0x0
    s_addc_u32 s43, s19, 0
    s_add_u32 s44, s47, 0
    s_mov_b32 m0, s44
    s_add_u32 s44, s44, 1024
    global_load_lds_dwordx4 v40, s[42:43]
    s_add_u32 s42, s42, 0x8000
    s_addc_u32 s43, s43, 0
    s_mov_b32 m0, s44
    s_add_u32 s44, s44, 1024
    global_load_lds_dwordx4 v40, s[42:43]
    s_add_u32 s42, s42, 0x8000
    s_addc_u32 s43, s43, 0
    s_mov_b32 m0, s44
    s_add_u32 s44, s44, 1024
    global_load_lds_dwordx4 v41, s[42:43]
    s_add_u32 s42, s42, 0x8000
    s_addc_u32 s43, s43, 0
    s_mov_b32 m0, s44
    s_add_u32 s44, s44, 1024
    global_load_lds_dwordx4 v41, s[42:43]
    s_add_u32 s42, s18, 0x80000
    s_addc_u32 s43, s19, 0
    s_add_u32 s44, s47, 16384
    s_mov_b32 m0, s44
    s_add_u32 s44, s44, 1024
    global_load_lds_dwordx4 v40, s[42:43]
    s_add_u32 s42, s42, 0x8000
    s_addc_u32 s43, s43, 0
    s_mov_b32 m0, s44
    s_add_u32 s44, s44, 1024
    global_load_lds_dwordx4 v40, s[42:43]
    s_add_u32 s42, s42, 0x8000
    s_addc_u32 s43, s43, 0
    s_mov_b32 m0, s44
    s_add_u32 s44, s44, 1024
    global_load_lds_dwordx4 v41, s[42:43]
    s_add_u32 s42, s42, 0x8000
    s_addc_u32 s43, s43, 0
    s_mov_b32 m0, s44
    s_add_u32 s44, s44, 1024
    global_load_lds_dwordx4 v41, s[42:43]
    v_lshrrev_b32 v51, 1, v49
    v_lshlrev_b32 v51, 5, v51
    v_and_b32 v53, 1, v48
    v_lshl_add_u32 v51, v53, 4, v51
    v_lshrrev_b32 v53, 1, v48
    v_lshl_add_u32 v51, v53, 2, v51
    v_and_b32 v53, 1, v49
    v_add_u32 v51, v51, v53
    v_lshlrev_b32 v45, 6, v51
    v_lshl_add_u32 v45, v50, 3, v45
    v_add_u32 v45, s46, v45
    v_and_b32 v53, 3, v52
    v_lshlrev_b32 v46, 11, v53
    v_lshrrev_b32 v53, 2, v52
    v_lshl_add_u32 v53, v48, 3, v53
    v_lshl_add_u32 v46, v53, 4, v46
    v_add_u32 v46, s46, v46
    s_waitcnt vmcnt(32)
    ds_read_b64_tr_b16 v[48:49], v45 offset:16384
    ds_read_b64_tr_b16 v[50:51], v45 offset:16512
    ds_read_b64_tr_b16 v[52:53], v45 offset:16416
    ds_read_b64_tr_b16 v[54:55], v45 offset:16544
    ds_read_b64_tr_b16 v[56:57], v45 offset:16896
    ds_read_b64_tr_b16 v[58:59], v45 offset:17024
    ds_read_b64_tr_b16 v[60:61], v45 offset:16928
    ds_read_b64_tr_b16 v[62:63], v45 offset:17056
    ds_read_b64_tr_b16 v[64:65], v45 offset:20480
    ds_read_b64_tr_b16 v[66:67], v45 offset:20608
    ds_read_b64_tr_b16 v[68:69], v45 offset:20512
    ds_read_b64_tr_b16 v[70:71], v45 offset:20640
    ds_read_b64_tr_b16 v[72:73], v45 offset:20992
    ds_read_b64_tr_b16 v[74:75], v45 offset:21120
    ds_read_b64_tr_b16 v[76:77], v45 offset:21024
    ds_read_b64_tr_b16 v[78:79], v45 offset:21152
    s_waitcnt lgkmcnt(0)
    ds_write_b128 v46, v[48:51] offset:16384
    ds_write_b128 v46, v[52:55] offset:16448
    ds_write_b128 v46, v[56:59] offset:16896
    ds_write_b128 v46, v[60:63] offset:16960
    ds_write_b128 v46, v[64:67] offset:17408
    ds_write_b128 v46, v[68:71] offset:17472
    ds_write_b128 v46, v[72:75] offset:17920
    ds_write_b128 v46, v[76:79] offset:17984
    s_waitcnt lgkmcnt(0)
    s_waitcnt vmcnt(24)
    ds_read_b64_tr_b16 v[48:49], v45 offset:24576
    ds_read_b64_tr_b16 v[50:51], v45 offset:24704
    ds_read_b64_tr_b16 v[52:53], v45 offset:24608
    ds_read_b64_tr_b16 v[54:55], v45 offset:24736
    ds_read_b64_tr_b16 v[56:57], v45 offset:25088
    ds_read_b64_tr_b16 v[58:59], v45 offset:25216
    ds_read_b64_tr_b16 v[60:61], v45 offset:25120
    ds_read_b64_tr_b16 v[62:63], v45 offset:25248
    ds_read_b64_tr_b16 v[64:65], v45 offset:28672
    ds_read_b64_tr_b16 v[66:67], v45 offset:28800
    ds_read_b64_tr_b16 v[68:69], v45 offset:28704
    ds_read_b64_tr_b16 v[70:71], v45 offset:28832
    ds_read_b64_tr_b16 v[72:73], v45 offset:29184
    ds_read_b64_tr_b16 v[74:75], v45 offset:29312
    ds_read_b64_tr_b16 v[76:77], v45 offset:29216
    ds_read_b64_tr_b16 v[78:79], v45 offset:29344
    s_waitcnt lgkmcnt(0)
    ds_write_b128 v46, v[48:51] offset:24576
    ds_write_b128 v46, v[52:55] offset:24640
    ds_write_b128 v46, v[56:59] offset:25088
    ds_write_b128 v46, v[60:63] offset:25152
    ds_write_b128 v46, v[64:67] offset:25600
    ds_write_b128 v46, v[68:71] offset:25664
    ds_write_b128 v46, v[72:75] offset:26112
    ds_write_b128 v46, v[76:79] offset:26176
    s_waitcnt lgkmcnt(0)
    ds_read_b128 a[192:195], v7 offset:16384
    ds_read_b128 a[196:199], v7 offset:16896
    ds_read_b128 a[200:203], v7 offset:18432
    ds_read_b128 a[204:207], v7 offset:18944
    ds_read_b128 a[208:211], v7 offset:20480
    ds_read_b128 a[212:215], v7 offset:20992
    ds_read_b128 a[216:219], v7 offset:22528
    ds_read_b128 a[220:223], v7 offset:23040
    ds_read_b128 a[224:227], v7 offset:17408
    ds_read_b128 a[228:231], v7 offset:17920
    ds_read_b128 a[232:235], v7 offset:19456
    ds_read_b128 a[236:239], v7 offset:19968
    ds_read_b128 a[240:243], v7 offset:21504
    ds_read_b128 a[244:247], v7 offset:22016
    ds_read_b128 a[248:251], v7 offset:23552
    ds_read_b128 a[252:255], v7 offset:24064
    s_waitcnt lgkmcnt(0)
    s_barrier
    s_cmp_lg_u32 s34, 0
    s_cbranch_scc1 Lmid_1
    v_mov_b32 v112, 32
    v_mov_b32 v113, 1
    s_mov_b64 exec, 1
    global_atomic_add v112, v113, s[30:31]
    s_mov_b64 exec, -1
Lmid_1:
    s_add_u32 s42, s18, 0x100000
    s_addc_u32 s43, s19, 0
    s_add_u32 s44, s47, 49152
    s_mov_b32 m0, s44
    s_add_u32 s44, s44, 1024
    global_load_lds_dwordx4 v40, s[42:43]
    s_add_u32 s42, s42, 0x8000
    s_addc_u32 s43, s43, 0
    s_mov_b32 m0, s44
    s_add_u32 s44, s44, 1024
    global_load_lds_dwordx4 v40, s[42:43]
    s_add_u32 s42, s42, 0x8000
    s_addc_u32 s43, s43, 0
    s_mov_b32 m0, s44
    s_add_u32 s44, s44, 1024
    global_load_lds_dwordx4 v41, s[42:43]
    s_add_u32 s42, s42, 0x8000
    s_addc_u32 s43, s43, 0
    s_mov_b32 m0, s44
    s_add_u32 s44, s44, 1024
    global_load_lds_dwordx4 v41, s[42:43]
    s_add_u32 s42, s18, 0x180000
    s_addc_u32 s43, s19, 0
    s_add_u32 s44, s47, 81920
    s_mov_b32 m0, s44
    s_add_u32 s44, s44, 1024
    global_load_lds_dwordx4 v40, s[42:43]
    s_add_u32 s42, s42, 0x8000
    s_addc_u32 s43, s43, 0
    s_mov_b32 m0, s44
    s_add_u32 s44, s44, 1024
    global_load_lds_dwordx4 v40, s[42:43]
    s_add_u32 s42, s42, 0x8000
    s_addc_u32 s43, s43, 0
    s_mov_b32 m0, s44
    s_add_u32 s44, s44, 1024
    global_load_lds_dwordx4 v41, s[42:43]
    s_add_u32 s42, s42, 0x8000
    s_addc_u32 s43, s43, 0
    s_mov_b32 m0, s44
    s_add_u32 s44, s44, 1024
    global_load_lds_dwordx4 v41, s[42:43]
    s_add_u32 s42, s18, 0x200000
    s_addc_u32 s43, s19, 0
    s_add_u32 s44, s47, 114688
    s_mov_b32 m0, s44
    s_add_u32 s44, s44, 1024
    global_load_lds_dwordx4 v40, s[42:43]
    s_add_u32 s42, s42, 0x8000
    s_addc_u32 s43, s43, 0
    s_mov_b32 m0, s44
    s_add_u32 s44, s44, 1024
    global_load_lds_dwordx4 v40, s[42:43]
    s_add_u32 s42, s42, 0x8000
    s_addc_u32 s43, s43, 0
    s_mov_b32 m0, s44
    s_add_u32 s44, s44, 1024
    global_load_lds_dwordx4 v41, s[42:43]
    s_add_u32 s42, s42, 0x8000
    s_addc_u32 s43, s43, 0
    s_mov_b32 m0, s44
    s_add_u32 s44, s44, 1024
    global_load_lds_dwordx4 v41, s[42:43]
    s_add_u32 s42, s18, 0x280000
    s_addc_u32 s43, s19, 0
    s_add_u32 s44, s47, 147456
    s_mov_b32 m0, s44
    s_add_u32 s44, s44, 1024
    global_load_lds_dwordx4 v40, s[42:43]
    s_add_u32 s42, s42, 0x8000
    s_addc_u32 s43, s43, 0
    s_mov_b32 m0, s44
    s_add_u32 s44, s44, 1024
    global_load_lds_dwordx4 v40, s[42:43]
    s_add_u32 s42, s42, 0x8000
    s_addc_u32 s43, s43, 0
    s_mov_b32 m0, s44
    s_add_u32 s44, s44, 1024
    global_load_lds_dwordx4 v41, s[42:43]
    s_add_u32 s42, s42, 0x8000
    s_addc_u32 s43, s43, 0
    s_mov_b32 m0, s44
    s_add_u32 s44, s44, 1024
    global_load_lds_dwordx4 v41, s[42:43]
    s_waitcnt vmcnt(32)
    ds_read_b64_tr_b16 v[48:49], v45 offset:0
    ds_read_b64_tr_b16 v[50:51], v45 offset:128
    ds_read_b64_tr_b16 v[52:53], v45 offset:32
    ds_read_b64_tr_b16 v[54:55], v45 offset:160
    ds_read_b64_tr_b16 v[56:57], v45 offset:512
    ds_read_b64_tr_b16 v[58:59], v45 offset:640
    ds_read_b64_tr_b16 v[60:61], v45 offset:544
    ds_read_b64_tr_b16 v[62:63], v45 offset:672
    ds_read_b64_tr_b16 v[64:65], v45 offset:4096
    ds_read_b64_tr_b16 v[66:67], v45 offset:4224
    ds_read_b64_tr_b16 v[68:69], v45 offset:4128
    ds_read_b64_tr_b16 v[70:71], v45 offset:4256
    ds_read_b64_tr_b16 v[72:73], v45 offset:4608
    ds_read_b64_tr_b16 v[74:75], v45 offset:4736
    ds_read_b64_tr_b16 v[76:77], v45 offset:4640
    ds_read_b64_tr_b16 v[78:79], v45 offset:4768
    s_waitcnt lgkmcnt(0)
    ds_write_b128 v46, v[48:51] offset:0
    ds_write_b128 v46, v[52:55] offset:64
    ds_write_b128 v46, v[56:59] offset:512
    ds_write_b128 v46, v[60:63] offset:576
    ds_write_b128 v46, v[64:67] offset:1024
    ds_write_b128 v46, v[68:71] offset:1088
    ds_write_b128 v46, v[72:75] offset:1536
    ds_write_b128 v46, v[76:79] offset:1600
    s_waitcnt lgkmcnt(0)
    s_waitcnt vmcnt(24)
    ds_read_b64_tr_b16 v[48:49], v45 offset:8192
    ds_read_b64_tr_b16 v[50:51], v45 offset:8320
    ds_read_b64_tr_b16 v[52:53], v45 offset:8224
    ds_read_b64_tr_b16 v[54:55], v45 offset:8352
    ds_read_b64_tr_b16 v[56:57], v45 offset:8704
    ds_read_b64_tr_b16 v[58:59], v45 offset:8832
    ds_read_b64_tr_b16 v[60:61], v45 offset:8736
    ds_read_b64_tr_b16 v[62:63], v45 offset:8864
    ds_read_b64_tr_b16 v[64:65], v45 offset:12288
    ds_read_b64_tr_b16 v[66:67], v45 offset:12416
    ds_read_b64_tr_b16 v[68:69], v45 offset:12320
    ds_read_b64_tr_b16 v[70:71], v45 offset:12448
    ds_read_b64_tr_b16 v[72:73], v45 offset:12800
    ds_read_b64_tr_b16 v[74:75], v45 offset:12928
    ds_read_b64_tr_b16 v[76:77], v45 offset:12832
    ds_read_b64_tr_b16 v[78:79], v45 offset:12960
    s_waitcnt lgkmcnt(0)
    ds_write_b128 v46, v[48:51] offset:8192
    ds_write_b128 v46, v[52:55] offset:8256
    ds_write_b128 v46, v[56:59] offset:8704
    ds_write_b128 v46, v[60:63] offset:8768
    ds_write_b128 v46, v[64:67] offset:9216
    ds_write_b128 v46, v[68:71] offset:9280
    ds_write_b128 v46, v[72:75] offset:9728
    ds_write_b128 v46, v[76:79] offset:9792
    s_waitcnt lgkmcnt(0)
    s_waitcnt vmcnt(20) lgkmcnt(0)
    s_barrier
    v_add_u32 v47, 0, v42
    v_add_u32 v44, 0, v43
    s_cmp_lg_u32 s34, 0
    s_cbranch_scc1 Lwv_3
    ds_read_b64_tr_b16 v[48:49], v47 offset:0
    ds_read_b64_tr_b16 v[50:51], v47 offset:1024
    ds_read_b64_tr_b16 v[52:53], v47 offset:8192
    ds_read_b64_tr_b16 v[54:55], v47 offset:9216
    ds_read_b64_tr_b16 v[64:65], v44 offset:0
    ds_read_b64_tr_b16 v[66:67], v44 offset:1024
    ds_read_b64_tr_b16 v[68:69], v44 offset:8192
    ds_read_b64_tr_b16 v[70:71], v44 offset:9216
    s_branch Lwd_2
Lwv_3:
    s_cmp_lg_u32 s34, 1
    s_cbranch_scc1 Lwv_4
    ds_read_b64_tr_b16 a[0:1], v47 offset:0
    ds_read_b64_tr_b16 a[2:3], v47 offset:1024
    ds_read_b64_tr_b16 a[4:5], v47 offset:8192
    ds_read_b64_tr_b16 a[6:7], v47 offset:9216
    ds_read_b64_tr_b16 a[48:49], v44 offset:0
    ds_read_b64_tr_b16 a[50:51], v44 offset:1024
    ds_read_b64_tr_b16 a[52:53], v44 offset:8192
    ds_read_b64_tr_b16 a[54:55], v44 offset:9216
    s_branch Lwd_2
Lwv_4:
    s_cmp_lg_u32 s34, 2
    s_cbranch_scc1 Lwv_5
    ds_read_b64_tr_b16 a[16:17], v47 offset:0
    ds_read_b64_tr_b16 a[18:19], v47 offset:1024
    ds_read_b64_tr_b16 a[20:21], v47 offset:8192
    ds_read_b64_tr_b16 a[22:23], v47 offset:9216
    ds_read_b64_tr_b16 a[64:65], v44 offset:0
    ds_read_b64_tr_b16 a[66:67], v44 offset:1024
    ds_read_b64_tr_b16 a[68:69], v44 offset:8192
    ds_read_b64_tr_b16 a[70:71], v44 offset:9216
    s_branch Lwd_2
Lwv_5:
    ds_read_b64_tr_b16 a[32:33], v47 offset:0
    ds_read_b64_tr_b16 a[34:35], v47 offset:1024
    ds_read_b64_tr_b16 a[36:37], v47 offset:8192
    ds_read_b64_tr_b16 a[38:39], v47 offset:9216
    ds_read_b64_tr_b16 a[80:81], v44 offset:0
    ds_read_b64_tr_b16 a[82:83], v44 offset:1024
    ds_read_b64_tr_b16 a[84:85], v44 offset:8192
    ds_read_b64_tr_b16 a[86:87], v44 offset:9216
Lwd_2:
    s_waitcnt vmcnt(16) lgkmcnt(0)
    s_barrier
    s_add_u32 s42, s18, 0x300000
    s_addc_u32 s43, s19, 0
    s_add_u32 s44, s47, 0
    s_mov_b32 m0, s44
    s_add_u32 s44, s44, 1024
    global_load_lds_dwordx4 v40, s[42:43]
    s_add_u32 s42, s42, 0x8000
    s_addc_u32 s43, s43, 0
    s_mov_b32 m0, s44
    s_add_u32 s44, s44, 1024
    global_load_lds_dwordx4 v40, s[42:43]
    s_add_u32 s42, s42, 0x8000
    s_addc_u32 s43, s43, 0
    s_mov_b32 m0, s44
    s_add_u32 s44, s44, 1024
    global_load_lds_dwordx4 v41, s[42:43]
    s_add_u32 s42, s42, 0x8000
    s_addc_u32 s43, s43, 0
    s_mov_b32 m0, s44
    s_add_u32 s44, s44, 1024
    global_load_lds_dwordx4 v41, s[42:43]
    v_add_u32 v47, 16384, v42
    v_add_u32 v44, 16384, v43
    s_cmp_lg_u32 s34, 0
    s_cbranch_scc1 Lwv_7
    ds_read_b64_tr_b16 v[56:57], v47 offset:0
    ds_read_b64_tr_b16 v[58:59], v47 offset:1024
    ds_read_b64_tr_b16 v[60:61], v47 offset:8192
    ds_read_b64_tr_b16 v[62:63], v47 offset:9216
    ds_read_b64_tr_b16 v[72:73], v44 offset:0
    ds_read_b64_tr_b16 v[74:75], v44 offset:1024
    ds_read_b64_tr_b16 v[76:77], v44 offset:8192
    ds_read_b64_tr_b16 v[78:79], v44 offset:9216
    s_branch Lwd_6
Lwv_7:
    s_cmp_lg_u32 s34, 1
    s_cbranch_scc1 Lwv_8
    ds_read_b64_tr_b16 a[8:9], v47 offset:0
    ds_read_b64_tr_b16 a[10:11], v47 offset:1024
    ds_read_b64_tr_b16 a[12:13], v47 offset:8192
    ds_read_b64_tr_b16 a[14:15], v47 offset:9216
    ds_read_b64_tr_b16 a[56:57], v44 offset:0
    ds_read_b64_tr_b16 a[58:59], v44 offset:1024
    ds_read_b64_tr_b16 a[60:61], v44 offset:8192
    ds_read_b64_tr_b16 a[62:63], v44 offset:9216
    s_branch Lwd_6
Lwv_8:
    s_cmp_lg_u32 s34, 2
    s_cbranch_scc1 Lwv_9
    ds_read_b64_tr_b16 a[24:25], v47 offset:0
    ds_read_b64_tr_b16 a[26:27], v47 offset:1024
    ds_read_b64_tr_b16 a[28:29], v47 offset:8192
    ds_read_b64_tr_b16 a[30:31], v47 offset:9216
    ds_read_b64_tr_b16 a[72:73], v44 offset:0
    ds_read_b64_tr_b16 a[74:75], v44 offset:1024
    ds_read_b64_tr_b16 a[76:77], v44 offset:8192
    ds_read_b64_tr_b16 a[78:79], v44 offset:9216
    s_branch Lwd_6
Lwv_9:
    ds_read_b64_tr_b16 a[40:41], v47 offset:0
    ds_read_b64_tr_b16 a[42:43], v47 offset:1024
    ds_read_b64_tr_b16 a[44:45], v47 offset:8192
    ds_read_b64_tr_b16 a[46:47], v47 offset:9216
    ds_read_b64_tr_b16 a[88:89], v44 offset:0
    ds_read_b64_tr_b16 a[90:91], v44 offset:1024
    ds_read_b64_tr_b16 a[92:93], v44 offset:8192
    ds_read_b64_tr_b16 a[94:95], v44 offset:9216
Lwd_6:
    s_waitcnt vmcnt(16) lgkmcnt(0)
    s_barrier
    s_add_u32 s42, s18, 0x380000
    s_addc_u32 s43, s19, 0
    s_add_u32 s44, s47, 16384
    s_mov_b32 m0, s44
    s_add_u32 s44, s44, 1024
    global_load_lds_dwordx4 v40, s[42:43]
    s_add_u32 s42, s42, 0x8000
    s_addc_u32 s43, s43, 0
    s_mov_b32 m0, s44
    s_add_u32 s44, s44, 1024
    global_load_lds_dwordx4 v40, s[42:43]
    s_add_u32 s42, s42, 0x8000
    s_addc_u32 s43, s43, 0
    s_mov_b32 m0, s44
    s_add_u32 s44, s44, 1024
    global_load_lds_dwordx4 v41, s[42:43]
    s_add_u32 s42, s42, 0x8000
    s_addc_u32 s43, s43, 0
    s_mov_b32 m0, s44
    s_add_u32 s44, s44, 1024
    global_load_lds_dwordx4 v41, s[42:43]
    v_add_u32 v47, 49152, v42
    v_add_u32 v44, 49152, v43
    s_cmp_lg_u32 s34, 0
    s_cbranch_scc1 Lwv_11
    ds_read_b64_tr_b16 a[0:1], v47 offset:0
    ds_read_b64_tr_b16 a[2:3], v47 offset:1024
    ds_read_b64_tr_b16 a[4:5], v47 offset:8192
    ds_read_b64_tr_b16 a[6:7], v47 offset:9216
    ds_read_b64_tr_b16 a[48:49], v44 offset:0
    ds_read_b64_tr_b16 a[50:51], v44 offset:1024
    ds_read_b64_tr_b16 a[52:53], v44 offset:8192
    ds_read_b64_tr_b16 a[54:55], v44 offset:9216
    s_branch Lwd_10
Lwv_11:
    s_cmp_lg_u32 s34, 1
    s_cbranch_scc1 Lwv_12
    ds_read_b64_tr_b16 v[48:49], v47 offset:0
    ds_read_b64_tr_b16 v[50:51], v47 offset:1024
    ds_read_b64_tr_b16 v[52:53], v47 offset:8192
    ds_read_b64_tr_b16 v[54:55], v47 offset:9216
    ds_read_b64_tr_b16 v[64:65], v44 offset:0
    ds_read_b64_tr_b16 v[66:67], v44 offset:1024
    ds_read_b64_tr_b16 v[68:69], v44 offset:8192
    ds_read_b64_tr_b16 v[70:71], v44 offset:9216
    s_branch Lwd_10
Lwv_12:
    s_cmp_lg_u32 s34, 2
    s_cbranch_scc1 Lwv_13
    ds_read_b64_tr_b16 a[32:33], v47 offset:0
    ds_read_b64_tr_b16 a[34:35], v47 offset:1024
    ds_read_b64_tr_b16 a[36:37], v47 offset:8192
    ds_read_b64_tr_b16 a[38:39], v47 offset:9216
    ds_read_b64_tr_b16 a[80:81], v44 offset:0
    ds_read_b64_tr_b16 a[82:83], v44 offset:1024
    ds_read_b64_tr_b16 a[84:85], v44 offset:8192
    ds_read_b64_tr_b16 a[86:87], v44 offset:9216
    s_branch Lwd_10
Lwv_13:
    ds_read_b64_tr_b16 a[16:17], v47 offset:0
    ds_read_b64_tr_b16 a[18:19], v47 offset:1024
    ds_read_b64_tr_b16 a[20:21], v47 offset:8192
    ds_read_b64_tr_b16 a[22:23], v47 offset:9216
    ds_read_b64_tr_b16 a[64:65], v44 offset:0
    ds_read_b64_tr_b16 a[66:67], v44 offset:1024
    ds_read_b64_tr_b16 a[68:69], v44 offset:8192
    ds_read_b64_tr_b16 a[70:71], v44 offset:9216
Lwd_10:
    s_waitcnt vmcnt(16) lgkmcnt(0)
    s_barrier
    s_add_u32 s42, s20, 0x0
    s_addc_u32 s43, s21, 0
    s_add_u32 s44, s47, 49152
    s_mov_b32 m0, s44
    s_add_u32 s44, s44, 1024
    global_load_lds_dwordx4 v40, s[42:43]
    s_add_u32 s42, s42, 0x8000
    s_addc_u32 s43, s43, 0
    s_mov_b32 m0, s44
    s_add_u32 s44, s44, 1024
    global_load_lds_dwordx4 v40, s[42:43]
    s_add_u32 s42, s42, 0x8000
    s_addc_u32 s43, s43, 0
    s_mov_b32 m0, s44
    s_add_u32 s44, s44, 1024
    global_load_lds_dwordx4 v41, s[42:43]
    s_add_u32 s42, s42, 0x8000
    s_addc_u32 s43, s43, 0
    s_mov_b32 m0, s44
    s_add_u32 s44, s44, 1024
    global_load_lds_dwordx4 v41, s[42:43]
    v_add_u32 v47, 81920, v42
    v_add_u32 v44, 81920, v43
    s_cmp_lg_u32 s34, 0
    s_cbranch_scc1 Lwv_15
    ds_read_b64_tr_b16 a[8:9], v47 offset:0
    ds_read_b64_tr_b16 a[10:11], v47 offset:1024
    ds_read_b64_tr_b16 a[12:13], v47 offset:8192
    ds_read_b64_tr_b16 a[14:15], v47 offset:9216
    ds_read_b64_tr_b16 a[56:57], v44 offset:0
    ds_read_b64_tr_b16 a[58:59], v44 offset:1024
    ds_read_b64_tr_b16 a[60:61], v44 offset:8192
    ds_read_b64_tr_b16 a[62:63], v44 offset:9216
    s_branch Lwd_14
Lwv_15:
    s_cmp_lg_u32 s34, 1
    s_cbranch_scc1 Lwv_16
    ds_read_b64_tr_b16 v[56:57], v47 offset:0
    ds_read_b64_tr_b16 v[58:59], v47 offset:1024
    ds_read_b64_tr_b16 v[60:61], v47 offset:8192
    ds_read_b64_tr_b16 v[62:63], v47 offset:9216
    ds_read_b64_tr_b16 v[72:73], v44 offset:0
    ds_read_b64_tr_b16 v[74:75], v44 offset:1024
    ds_read_b64_tr_b16 v[76:77], v44 offset:8192
    ds_read_b64_tr_b16 v[78:79], v44 offset:9216
    s_branch Lwd_14
Lwv_16:
    s_cmp_lg_u32 s34, 2
    s_cbranch_scc1 Lwv_17
    ds_read_b64_tr_b16 a[40:41], v47 offset:0
    ds_read_b64_tr_b16 a[42:43], v47 offset:1024
    ds_read_b64_tr_b16 a[44:45], v47 offset:8192
    ds_read_b64_tr_b16 a[46:47], v47 offset:9216
    ds_read_b64_tr_b16 a[88:89], v44 offset:0
    ds_read_b64_tr_b16 a[90:91], v44 offset:1024
    ds_read_b64_tr_b16 a[92:93], v44 offset:8192
    ds_read_b64_tr_b16 a[94:95], v44 offset:9216
    s_branch Lwd_14
Lwv_17:
    ds_read_b64_tr_b16 a[24:25], v47 offset:0
    ds_read_b64_tr_b16 a[26:27], v47 offset:1024
    ds_read_b64_tr_b16 a[28:29], v47 offset:8192
    ds_read_b64_tr_b16 a[30:31], v47 offset:9216
    ds_read_b64_tr_b16 a[72:73], v44 offset:0
    ds_read_b64_tr_b16 a[74:75], v44 offset:1024
    ds_read_b64_tr_b16 a[76:77], v44 offset:8192
    ds_read_b64_tr_b16 a[78:79], v44 offset:9216
Lwd_14:
    s_waitcnt vmcnt(16) lgkmcnt(0)
    s_barrier
    s_add_u32 s42, s20, 0x80000
    s_addc_u32 s43, s21, 0
    s_add_u32 s44, s47, 81920
    s_mov_b32 m0, s44
    s_add_u32 s44, s44, 1024
    global_load_lds_dwordx4 v40, s[42:43]
    s_add_u32 s42, s42, 0x8000
    s_addc_u32 s43, s43, 0
    s_mov_b32 m0, s44
    s_add_u32 s44, s44, 1024
    global_load_lds_dwordx4 v40, s[42:43]
    s_add_u32 s42, s42, 0x8000
    s_addc_u32 s43, s43, 0
    s_mov_b32 m0, s44
    s_add_u32 s44, s44, 1024
    global_load_lds_dwordx4 v41, s[42:43]
    s_add_u32 s42, s42, 0x8000
    s_addc_u32 s43, s43, 0
    s_mov_b32 m0, s44
    s_add_u32 s44, s44, 1024
    global_load_lds_dwordx4 v41, s[42:43]
    v_add_u32 v47, 114688, v42
    v_add_u32 v44, 114688, v43
    s_cmp_lg_u32 s34, 0
    s_cbranch_scc1 Lwv_19
    ds_read_b64_tr_b16 a[16:17], v47 offset:0
    ds_read_b64_tr_b16 a[18:19], v47 offset:1024
    ds_read_b64_tr_b16 a[20:21], v47 offset:8192
    ds_read_b64_tr_b16 a[22:23], v47 offset:9216
    ds_read_b64_tr_b16 a[64:65], v44 offset:0
    ds_read_b64_tr_b16 a[66:67], v44 offset:1024
    ds_read_b64_tr_b16 a[68:69], v44 offset:8192
    ds_read_b64_tr_b16 a[70:71], v44 offset:9216
    s_branch Lwd_18
Lwv_19:
    s_cmp_lg_u32 s34, 1
    s_cbranch_scc1 Lwv_20
    ds_read_b64_tr_b16 a[32:33], v47 offset:0
    ds_read_b64_tr_b16 a[34:35], v47 offset:1024
    ds_read_b64_tr_b16 a[36:37], v47 offset:8192
    ds_read_b64_tr_b16 a[38:39], v47 offset:9216
    ds_read_b64_tr_b16 a[80:81], v44 offset:0
    ds_read_b64_tr_b16 a[82:83], v44 offset:1024
    ds_read_b64_tr_b16 a[84:85], v44 offset:8192
    ds_read_b64_tr_b16 a[86:87], v44 offset:9216
    s_branch Lwd_18
Lwv_20:
    s_cmp_lg_u32 s34, 2
    s_cbranch_scc1 Lwv_21
    ds_read_b64_tr_b16 v[48:49], v47 offset:0
    ds_read_b64_tr_b16 v[50:51], v47 offset:1024
    ds_read_b64_tr_b16 v[52:53], v47 offset:8192
    ds_read_b64_tr_b16 v[54:55], v47 offset:9216
    ds_read_b64_tr_b16 v[64:65], v44 offset:0
    ds_read_b64_tr_b16 v[66:67], v44 offset:1024
    ds_read_b64_tr_b16 v[68:69], v44 offset:8192
    ds_read_b64_tr_b16 v[70:71], v44 offset:9216
    s_branch Lwd_18
Lwv_21:
    ds_read_b64_tr_b16 a[0:1], v47 offset:0
    ds_read_b64_tr_b16 a[2:3], v47 offset:1024
    ds_read_b64_tr_b16 a[4:5], v47 offset:8192
    ds_read_b64_tr_b16 a[6:7], v47 offset:9216
    ds_read_b64_tr_b16 a[48:49], v44 offset:0
    ds_read_b64_tr_b16 a[50:51], v44 offset:1024
    ds_read_b64_tr_b16 a[52:53], v44 offset:8192
    ds_read_b64_tr_b16 a[54:55], v44 offset:9216
Lwd_18:
    s_waitcnt vmcnt(16) lgkmcnt(0)
    s_barrier
    s_add_u32 s42, s20, 0x100000
    s_addc_u32 s43, s21, 0
    s_add_u32 s44, s47, 114688
    s_mov_b32 m0, s44
    s_add_u32 s44, s44, 1024
    global_load_lds_dwordx4 v40, s[42:43]
    s_add_u32 s42, s42, 0x8000
    s_addc_u32 s43, s43, 0
    s_mov_b32 m0, s44
    s_add_u32 s44, s44, 1024
    global_load_lds_dwordx4 v40, s[42:43]
    s_add_u32 s42, s42, 0x8000
    s_addc_u32 s43, s43, 0
    s_mov_b32 m0, s44
    s_add_u32 s44, s44, 1024
    global_load_lds_dwordx4 v41, s[42:43]
    s_add_u32 s42, s42, 0x8000
    s_addc_u32 s43, s43, 0
    s_mov_b32 m0, s44
    s_add_u32 s44, s44, 1024
    global_load_lds_dwordx4 v41, s[42:43]
    v_add_u32 v47, 147456, v42
    v_add_u32 v44, 147456, v43
    s_cmp_lg_u32 s34, 0
    s_cbranch_scc1 Lwv_23
    ds_read_b64_tr_b16 a[24:25], v47 offset:0
    ds_read_b64_tr_b16 a[26:27], v47 offset:1024
    ds_read_b64_tr_b16 a[28:29], v47 offset:8192
    ds_read_b64_tr_b16 a[30:31], v47 offset:9216
    ds_read_b64_tr_b16 a[72:73], v44 offset:0
    ds_read_b64_tr_b16 a[74:75], v44 offset:1024
    ds_read_b64_tr_b16 a[76:77], v44 offset:8192
    ds_read_b64_tr_b16 a[78:79], v44 offset:9216
    s_branch Lwd_22
Lwv_23:
    s_cmp_lg_u32 s34, 1
    s_cbranch_scc1 Lwv_24
    ds_read_b64_tr_b16 a[40:41], v47 offset:0
    ds_read_b64_tr_b16 a[42:43], v47 offset:1024
    ds_read_b64_tr_b16 a[44:45], v47 offset:8192
    ds_read_b64_tr_b16 a[46:47], v47 offset:9216
    ds_read_b64_tr_b16 a[88:89], v44 offset:0
    ds_read_b64_tr_b16 a[90:91], v44 offset:1024
    ds_read_b64_tr_b16 a[92:93], v44 offset:8192
    ds_read_b64_tr_b16 a[94:95], v44 offset:9216
    s_branch Lwd_22
Lwv_24:
    s_cmp_lg_u32 s34, 2
    s_cbranch_scc1 Lwv_25
    ds_read_b64_tr_b16 v[56:57], v47 offset:0
    ds_read_b64_tr_b16 v[58:59], v47 offset:1024
    ds_read_b64_tr_b16 v[60:61], v47 offset:8192
    ds_read_b64_tr_b16 v[62:63], v47 offset:9216
    ds_read_b64_tr_b16 v[72:73], v44 offset:0
    ds_read_b64_tr_b16 v[74:75], v44 offset:1024
    ds_read_b64_tr_b16 v[76:77], v44 offset:8192
    ds_read_b64_tr_b16 v[78:79], v44 offset:9216
    s_branch Lwd_22
Lwv_25:
    ds_read_b64_tr_b16 a[8:9], v47 offset:0
    ds_read_b64_tr_b16 a[10:11], v47 offset:1024
    ds_read_b64_tr_b16 a[12:13], v47 offset:8192
    ds_read_b64_tr_b16 a[14:15], v47 offset:9216
    ds_read_b64_tr_b16 a[56:57], v44 offset:0
    ds_read_b64_tr_b16 a[58:59], v44 offset:1024
    ds_read_b64_tr_b16 a[60:61], v44 offset:8192
    ds_read_b64_tr_b16 a[62:63], v44 offset:9216
Lwd_22:
    s_waitcnt vmcnt(16) lgkmcnt(0)
    s_barrier
    s_add_u32 s42, s20, 0x180000
    s_addc_u32 s43, s21, 0
    s_add_u32 s44, s47, 147456
    s_mov_b32 m0, s44
    s_add_u32 s44, s44, 1024
    global_load_lds_dwordx4 v40, s[42:43]
    s_add_u32 s42, s42, 0x8000
    s_addc_u32 s43, s43, 0
    s_mov_b32 m0, s44
    s_add_u32 s44, s44, 1024
    global_load_lds_dwordx4 v40, s[42:43]
    s_add_u32 s42, s42, 0x8000
    s_addc_u32 s43, s43, 0
    s_mov_b32 m0, s44
    s_add_u32 s44, s44, 1024
    global_load_lds_dwordx4 v41, s[42:43]
    s_add_u32 s42, s42, 0x8000
    s_addc_u32 s43, s43, 0
    s_mov_b32 m0, s44
    s_add_u32 s44, s44, 1024
    global_load_lds_dwordx4 v41, s[42:43]
    v_add_u32 v47, 0, v42
    v_add_u32 v44, 0, v43
    s_cmp_lg_u32 s34, 0
    s_cbranch_scc1 Lwv_27
    ds_read_b64_tr_b16 a[32:33], v47 offset:0
    ds_read_b64_tr_b16 a[34:35], v47 offset:1024
    ds_read_b64_tr_b16 a[36:37], v47 offset:8192
    ds_read_b64_tr_b16 a[38:39], v47 offset:9216
    ds_read_b64_tr_b16 a[80:81], v44 offset:0
    ds_read_b64_tr_b16 a[82:83], v44 offset:1024
    ds_read_b64_tr_b16 a[84:85], v44 offset:8192
    ds_read_b64_tr_b16 a[86:87], v44 offset:9216
    s_branch Lwd_26
Lwv_27:
    s_cmp_lg_u32 s34, 1
    s_cbranch_scc1 Lwv_28
    ds_read_b64_tr_b16 a[16:17], v47 offset:0
    ds_read_b64_tr_b16 a[18:19], v47 offset:1024
    ds_read_b64_tr_b16 a[20:21], v47 offset:8192
    ds_read_b64_tr_b16 a[22:23], v47 offset:9216
    ds_read_b64_tr_b16 a[64:65], v44 offset:0
    ds_read_b64_tr_b16 a[66:67], v44 offset:1024
    ds_read_b64_tr_b16 a[68:69], v44 offset:8192
    ds_read_b64_tr_b16 a[70:71], v44 offset:9216
    s_branch Lwd_26
Lwv_28:
    s_cmp_lg_u32 s34, 2
    s_cbranch_scc1 Lwv_29
    ds_read_b64_tr_b16 a[0:1], v47 offset:0
    ds_read_b64_tr_b16 a[2:3], v47 offset:1024
    ds_read_b64_tr_b16 a[4:5], v47 offset:8192
    ds_read_b64_tr_b16 a[6:7], v47 offset:9216
    ds_read_b64_tr_b16 a[48:49], v44 offset:0
    ds_read_b64_tr_b16 a[50:51], v44 offset:1024
    ds_read_b64_tr_b16 a[52:53], v44 offset:8192
    ds_read_b64_tr_b16 a[54:55], v44 offset:9216
    s_branch Lwd_26
Lwv_29:
    ds_read_b64_tr_b16 v[48:49], v47 offset:0
    ds_read_b64_tr_b16 v[50:51], v47 offset:1024
    ds_read_b64_tr_b16 v[52:53], v47 offset:8192
    ds_read_b64_tr_b16 v[54:55], v47 offset:9216
    ds_read_b64_tr_b16 v[64:65], v44 offset:0
    ds_read_b64_tr_b16 v[66:67], v44 offset:1024
    ds_read_b64_tr_b16 v[68:69], v44 offset:8192
    ds_read_b64_tr_b16 v[70:71], v44 offset:9216
Lwd_26:
    s_waitcnt vmcnt(16) lgkmcnt(0)
    s_barrier
    s_add_u32 s42, s20, 0x200000
    s_addc_u32 s43, s21, 0
    s_add_u32 s44, s47, 0
    s_mov_b32 m0, s44
    s_add_u32 s44, s44, 1024
    global_load_lds_dwordx4 v40, s[42:43]
    s_add_u32 s42, s42, 0x8000
    s_addc_u32 s43, s43, 0
    s_mov_b32 m0, s44
    s_add_u32 s44, s44, 1024
    global_load_lds_dwordx4 v40, s[42:43]
    s_add_u32 s42, s42, 0x8000
    s_addc_u32 s43, s43, 0
    s_mov_b32 m0, s44
    s_add_u32 s44, s44, 1024
    global_load_lds_dwordx4 v41, s[42:43]
    s_add_u32 s42, s42, 0x8000
    s_addc_u32 s43, s43, 0
    s_mov_b32 m0, s44
    s_add_u32 s44, s44, 1024
    global_load_lds_dwordx4 v41, s[42:43]
    v_add_u32 v47, 16384, v42
    v_add_u32 v44, 16384, v43
    s_cmp_lg_u32 s34, 0
    s_cbranch_scc1 Lwv_31
    ds_read_b64_tr_b16 a[40:41], v47 offset:0
    ds_read_b64_tr_b16 a[42:43], v47 offset:1024
    ds_read_b64_tr_b16 a[44:45], v47 offset:8192
    ds_read_b64_tr_b16 a[46:47], v47 offset:9216
    ds_read_b64_tr_b16 a[88:89], v44 offset:0
    ds_read_b64_tr_b16 a[90:91], v44 offset:1024
    ds_read_b64_tr_b16 a[92:93], v44 offset:8192
    ds_read_b64_tr_b16 a[94:95], v44 offset:9216
    s_branch Lwd_30
Lwv_31:
    s_cmp_lg_u32 s34, 1
    s_cbranch_scc1 Lwv_32
    ds_read_b64_tr_b16 a[24:25], v47 offset:0
    ds_read_b64_tr_b16 a[26:27], v47 offset:1024
    ds_read_b64_tr_b16 a[28:29], v47 offset:8192
    ds_read_b64_tr_b16 a[30:31], v47 offset:9216
    ds_read_b64_tr_b16 a[72:73], v44 offset:0
    ds_read_b64_tr_b16 a[74:75], v44 offset:1024
    ds_read_b64_tr_b16 a[76:77], v44 offset:8192
    ds_read_b64_tr_b16 a[78:79], v44 offset:9216
    s_branch Lwd_30
Lwv_32:
    s_cmp_lg_u32 s34, 2
    s_cbranch_scc1 Lwv_33
    ds_read_b64_tr_b16 a[8:9], v47 offset:0
    ds_read_b64_tr_b16 a[10:11], v47 offset:1024
    ds_read_b64_tr_b16 a[12:13], v47 offset:8192
    ds_read_b64_tr_b16 a[14:15], v47 offset:9216
    ds_read_b64_tr_b16 a[56:57], v44 offset:0
    ds_read_b64_tr_b16 a[58:59], v44 offset:1024
    ds_read_b64_tr_b16 a[60:61], v44 offset:8192
    ds_read_b64_tr_b16 a[62:63], v44 offset:9216
    s_branch Lwd_30
Lwv_33:
    ds_read_b64_tr_b16 v[56:57], v47 offset:0
    ds_read_b64_tr_b16 v[58:59], v47 offset:1024
    ds_read_b64_tr_b16 v[60:61], v47 offset:8192
    ds_read_b64_tr_b16 v[62:63], v47 offset:9216
    ds_read_b64_tr_b16 v[72:73], v44 offset:0
    ds_read_b64_tr_b16 v[74:75], v44 offset:1024
    ds_read_b64_tr_b16 v[76:77], v44 offset:8192
    ds_read_b64_tr_b16 v[78:79], v44 offset:9216
Lwd_30:
    s_waitcnt vmcnt(16) lgkmcnt(0)
    s_barrier
    s_add_u32 s42, s20, 0x280000
    s_addc_u32 s43, s21, 0
    s_add_u32 s44, s47, 16384
    s_mov_b32 m0, s44
    s_add_u32 s44, s44, 1024
    global_load_lds_dwordx4 v40, s[42:43]
    s_add_u32 s42, s42, 0x8000
    s_addc_u32 s43, s43, 0
    s_mov_b32 m0, s44
    s_add_u32 s44, s44, 1024
    global_load_lds_dwordx4 v40, s[42:43]
    s_add_u32 s42, s42, 0x8000
    s_addc_u32 s43, s43, 0
    s_mov_b32 m0, s44
    s_add_u32 s44, s44, 1024
    global_load_lds_dwordx4 v41, s[42:43]
    s_add_u32 s42, s42, 0x8000
    s_addc_u32 s43, s43, 0
    s_mov_b32 m0, s44
    s_add_u32 s44, s44, 1024
    global_load_lds_dwordx4 v41, s[42:43]
    v_add_u32 v47, 49152, v42
    v_add_u32 v44, 49152, v43
    s_cmp_lg_u32 s34, 0
    s_cbranch_scc1 Lwv_35
    ds_read_b64_tr_b16 v[80:81], v47 offset:0
    ds_read_b64_tr_b16 v[82:83], v47 offset:1024
    ds_read_b64_tr_b16 v[84:85], v47 offset:8192
    ds_read_b64_tr_b16 v[86:87], v47 offset:9216
    ds_read_b64_tr_b16 v[96:97], v44 offset:0
    ds_read_b64_tr_b16 v[98:99], v44 offset:1024
    ds_read_b64_tr_b16 v[100:101], v44 offset:8192
    ds_read_b64_tr_b16 v[102:103], v44 offset:9216
    s_branch Lwd_34
Lwv_35:
    s_cmp_lg_u32 s34, 1
    s_cbranch_scc1 Lwv_36
    ds_read_b64_tr_b16 a[96:97], v47 offset:0
    ds_read_b64_tr_b16 a[98:99], v47 offset:1024
    ds_read_b64_tr_b16 a[100:101], v47 offset:8192
    ds_read_b64_tr_b16 a[102:103], v47 offset:9216
    ds_read_b64_tr_b16 a[144:145], v44 offset:0
    ds_read_b64_tr_b16 a[146:147], v44 offset:1024
    ds_read_b64_tr_b16 a[148:149], v44 offset:8192
    ds_read_b64_tr_b16 a[150:151], v44 offset:9216
    s_branch Lwd_34
Lwv_36:
    s_cmp_lg_u32 s34, 2
    s_cbranch_scc1 Lwv_37
    ds_read_b64_tr_b16 a[112:113], v47 offset:0
    ds_read_b64_tr_b16 a[114:115], v47 offset:1024
    ds_read_b64_tr_b16 a[116:117], v47 offset:8192
    ds_read_b64_tr_b16 a[118:119], v47 offset:9216
    ds_read_b64_tr_b16 a[160:161], v44 offset:0
    ds_read_b64_tr_b16 a[162:163], v44 offset:1024
    ds_read_b64_tr_b16 a[164:165], v44 offset:8192
    ds_read_b64_tr_b16 a[166:167], v44 offset:9216
    s_branch Lwd_34
Lwv_37:
    ds_read_b64_tr_b16 a[128:129], v47 offset:0
    ds_read_b64_tr_b16 a[130:131], v47 offset:1024
    ds_read_b64_tr_b16 a[132:133], v47 offset:8192
    ds_read_b64_tr_b16 a[134:135], v47 offset:9216
    ds_read_b64_tr_b16 a[176:177], v44 offset:0
    ds_read_b64_tr_b16 a[178:179], v44 offset:1024
    ds_read_b64_tr_b16 a[180:181], v44 offset:8192
    ds_read_b64_tr_b16 a[182:183], v44 offset:9216
Lwd_34:
    s_waitcnt vmcnt(16) lgkmcnt(0)
    s_barrier
    s_add_u32 s42, s20, 0x300000
    s_addc_u32 s43, s21, 0
    s_add_u32 s44, s47, 49152
    s_mov_b32 m0, s44
    s_add_u32 s44, s44, 1024
    global_load_lds_dwordx4 v40, s[42:43]
    s_add_u32 s42, s42, 0x8000
    s_addc_u32 s43, s43, 0
    s_mov_b32 m0, s44
    s_add_u32 s44, s44, 1024
    global_load_lds_dwordx4 v40, s[42:43]
    s_add_u32 s42, s42, 0x8000
    s_addc_u32 s43, s43, 0
    s_mov_b32 m0, s44
    s_add_u32 s44, s44, 1024
    global_load_lds_dwordx4 v41, s[42:43]
    s_add_u32 s42, s42, 0x8000
    s_addc_u32 s43, s43, 0
    s_mov_b32 m0, s44
    s_add_u32 s44, s44, 1024
    global_load_lds_dwordx4 v41, s[42:43]
    v_add_u32 v47, 81920, v42
    v_add_u32 v44, 81920, v43
    s_cmp_lg_u32 s34, 0
    s_cbranch_scc1 Lwv_39
    ds_read_b64_tr_b16 v[88:89], v47 offset:0
    ds_read_b64_tr_b16 v[90:91], v47 offset:1024
    ds_read_b64_tr_b16 v[92:93], v47 offset:8192
    ds_read_b64_tr_b16 v[94:95], v47 offset:9216
    ds_read_b64_tr_b16 v[104:105], v44 offset:0
    ds_read_b64_tr_b16 v[106:107], v44 offset:1024
    ds_read_b64_tr_b16 v[108:109], v44 offset:8192
    ds_read_b64_tr_b16 v[110:111], v44 offset:9216
    s_branch Lwd_38
Lwv_39:
    s_cmp_lg_u32 s34, 1
    s_cbranch_scc1 Lwv_40
    ds_read_b64_tr_b16 a[104:105], v47 offset:0
    ds_read_b64_tr_b16 a[106:107], v47 offset:1024
    ds_read_b64_tr_b16 a[108:109], v47 offset:8192
    ds_read_b64_tr_b16 a[110:111], v47 offset:9216
    ds_read_b64_tr_b16 a[152:153], v44 offset:0
    ds_read_b64_tr_b16 a[154:155], v44 offset:1024
    ds_read_b64_tr_b16 a[156:157], v44 offset:8192
    ds_read_b64_tr_b16 a[158:159], v44 offset:9216
    s_branch Lwd_38
Lwv_40:
    s_cmp_lg_u32 s34, 2
    s_cbranch_scc1 Lwv_41
    ds_read_b64_tr_b16 a[120:121], v47 offset:0
    ds_read_b64_tr_b16 a[122:123], v47 offset:1024
    ds_read_b64_tr_b16 a[124:125], v47 offset:8192
    ds_read_b64_tr_b16 a[126:127], v47 offset:9216
    ds_read_b64_tr_b16 a[168:169], v44 offset:0
    ds_read_b64_tr_b16 a[170:171], v44 offset:1024
    ds_read_b64_tr_b16 a[172:173], v44 offset:8192
    ds_read_b64_tr_b16 a[174:175], v44 offset:9216
    s_branch Lwd_38
Lwv_41:
    ds_read_b64_tr_b16 a[136:137], v47 offset:0
    ds_read_b64_tr_b16 a[138:139], v47 offset:1024
    ds_read_b64_tr_b16 a[140:141], v47 offset:8192
    ds_read_b64_tr_b16 a[142:143], v47 offset:9216
    ds_read_b64_tr_b16 a[184:185], v44 offset:0
    ds_read_b64_tr_b16 a[186:187], v44 offset:1024
    ds_read_b64_tr_b16 a[188:189], v44 offset:8192
    ds_read_b64_tr_b16 a[190:191], v44 offset:9216
Lwd_38:
    s_waitcnt vmcnt(16) lgkmcnt(0)
    s_barrier
    s_add_u32 s42, s20, 0x380000
    s_addc_u32 s43, s21, 0
    s_add_u32 s44, s47, 81920
    s_mov_b32 m0, s44
    s_add_u32 s44, s44, 1024
    global_load_lds_dwordx4 v40, s[42:43]
    s_add_u32 s42, s42, 0x8000
    s_addc_u32 s43, s43, 0
    s_mov_b32 m0, s44
    s_add_u32 s44, s44, 1024
    global_load_lds_dwordx4 v40, s[42:43]
    s_add_u32 s42, s42, 0x8000
    s_addc_u32 s43, s43, 0
    s_mov_b32 m0, s44
    s_add_u32 s44, s44, 1024
    global_load_lds_dwordx4 v41, s[42:43]
    s_add_u32 s42, s42, 0x8000
    s_addc_u32 s43, s43, 0
    s_mov_b32 m0, s44
    s_add_u32 s44, s44, 1024
    global_load_lds_dwordx4 v41, s[42:43]
    v_add_u32 v47, 114688, v42
    v_add_u32 v44, 114688, v43
    s_cmp_lg_u32 s34, 0
    s_cbranch_scc1 Lwv_43
    ds_read_b64_tr_b16 a[96:97], v47 offset:0
    ds_read_b64_tr_b16 a[98:99], v47 offset:1024
    ds_read_b64_tr_b16 a[100:101], v47 offset:8192
    ds_read_b64_tr_b16 a[102:103], v47 offset:9216
    ds_read_b64_tr_b16 a[144:145], v44 offset:0
    ds_read_b64_tr_b16 a[146:147], v44 offset:1024
    ds_read_b64_tr_b16 a[148:149], v44 offset:8192
    ds_read_b64_tr_b16 a[150:151], v44 offset:9216
    s_branch Lwd_42
Lwv_43:
    s_cmp_lg_u32 s34, 1
    s_cbranch_scc1 Lwv_44
    ds_read_b64_tr_b16 v[80:81], v47 offset:0
    ds_read_b64_tr_b16 v[82:83], v47 offset:1024
    ds_read_b64_tr_b16 v[84:85], v47 offset:8192
    ds_read_b64_tr_b16 v[86:87], v47 offset:9216
    ds_read_b64_tr_b16 v[96:97], v44 offset:0
    ds_read_b64_tr_b16 v[98:99], v44 offset:1024
    ds_read_b64_tr_b16 v[100:101], v44 offset:8192
    ds_read_b64_tr_b16 v[102:103], v44 offset:9216
    s_branch Lwd_42
Lwv_44:
    s_cmp_lg_u32 s34, 2
    s_cbranch_scc1 Lwv_45
    ds_read_b64_tr_b16 a[128:129], v47 offset:0
    ds_read_b64_tr_b16 a[130:131], v47 offset:1024
    ds_read_b64_tr_b16 a[132:133], v47 offset:8192
    ds_read_b64_tr_b16 a[134:135], v47 offset:9216
    ds_read_b64_tr_b16 a[176:177], v44 offset:0
    ds_read_b64_tr_b16 a[178:179], v44 offset:1024
    ds_read_b64_tr_b16 a[180:181], v44 offset:8192
    ds_read_b64_tr_b16 a[182:183], v44 offset:9216
    s_branch Lwd_42
Lwv_45:
    ds_read_b64_tr_b16 a[112:113], v47 offset:0
    ds_read_b64_tr_b16 a[114:115], v47 offset:1024
    ds_read_b64_tr_b16 a[116:117], v47 offset:8192
    ds_read_b64_tr_b16 a[118:119], v47 offset:9216
    ds_read_b64_tr_b16 a[160:161], v44 offset:0
    ds_read_b64_tr_b16 a[162:163], v44 offset:1024
    ds_read_b64_tr_b16 a[164:165], v44 offset:8192
    ds_read_b64_tr_b16 a[166:167], v44 offset:9216
Lwd_42:
    s_waitcnt vmcnt(16) lgkmcnt(0)
    s_barrier
    s_add_u32 s42, s22, 0x0
    s_addc_u32 s43, s23, 0
    s_add_u32 s44, s47, 114688
    s_mov_b32 m0, s44
    s_add_u32 s44, s44, 1024
    global_load_lds_dwordx4 v40, s[42:43]
    s_add_u32 s42, s42, 0x8000
    s_addc_u32 s43, s43, 0
    s_mov_b32 m0, s44
    s_add_u32 s44, s44, 1024
    global_load_lds_dwordx4 v40, s[42:43]
    s_add_u32 s42, s42, 0x8000
    s_addc_u32 s43, s43, 0
    s_mov_b32 m0, s44
    s_add_u32 s44, s44, 1024
    global_load_lds_dwordx4 v41, s[42:43]
    s_add_u32 s42, s42, 0x8000
    s_addc_u32 s43, s43, 0
    s_mov_b32 m0, s44
    s_add_u32 s44, s44, 1024
    global_load_lds_dwordx4 v41, s[42:43]
    v_add_u32 v47, 147456, v42
    v_add_u32 v44, 147456, v43
    s_cmp_lg_u32 s34, 0
    s_cbranch_scc1 Lwv_47
    ds_read_b64_tr_b16 a[104:105], v47 offset:0
    ds_read_b64_tr_b16 a[106:107], v47 offset:1024
    ds_read_b64_tr_b16 a[108:109], v47 offset:8192
    ds_read_b64_tr_b16 a[110:111], v47 offset:9216
    ds_read_b64_tr_b16 a[152:153], v44 offset:0
    ds_read_b64_tr_b16 a[154:155], v44 offset:1024
    ds_read_b64_tr_b16 a[156:157], v44 offset:8192
    ds_read_b64_tr_b16 a[158:159], v44 offset:9216
    s_branch Lwd_46
Lwv_47:
    s_cmp_lg_u32 s34, 1
    s_cbranch_scc1 Lwv_48
    ds_read_b64_tr_b16 v[88:89], v47 offset:0
    ds_read_b64_tr_b16 v[90:91], v47 offset:1024
    ds_read_b64_tr_b16 v[92:93], v47 offset:8192
    ds_read_b64_tr_b16 v[94:95], v47 offset:9216
    ds_read_b64_tr_b16 v[104:105], v44 offset:0
    ds_read_b64_tr_b16 v[106:107], v44 offset:1024
    ds_read_b64_tr_b16 v[108:109], v44 offset:8192
    ds_read_b64_tr_b16 v[110:111], v44 offset:9216
    s_branch Lwd_46
Lwv_48:
    s_cmp_lg_u32 s34, 2
    s_cbranch_scc1 Lwv_49
    ds_read_b64_tr_b16 a[136:137], v47 offset:0
    ds_read_b64_tr_b16 a[138:139], v47 offset:1024
    ds_read_b64_tr_b16 a[140:141], v47 offset:8192
    ds_read_b64_tr_b16 a[142:143], v47 offset:9216
    ds_read_b64_tr_b16 a[184:185], v44 offset:0
    ds_read_b64_tr_b16 a[186:187], v44 offset:1024
    ds_read_b64_tr_b16 a[188:189], v44 offset:8192
    ds_read_b64_tr_b16 a[190:191], v44 offset:9216
    s_branch Lwd_46
Lwv_49:
    ds_read_b64_tr_b16 a[120:121], v47 offset:0
    ds_read_b64_tr_b16 a[122:123], v47 offset:1024
    ds_read_b64_tr_b16 a[124:125], v47 offset:8192
    ds_read_b64_tr_b16 a[126:127], v47 offset:9216
    ds_read_b64_tr_b16 a[168:169], v44 offset:0
    ds_read_b64_tr_b16 a[170:171], v44 offset:1024
    ds_read_b64_tr_b16 a[172:173], v44 offset:8192
    ds_read_b64_tr_b16 a[174:175], v44 offset:9216
Lwd_46:
    s_waitcnt vmcnt(16) lgkmcnt(0)
    s_barrier
    s_add_u32 s42, s22, 0x80000
    s_addc_u32 s43, s23, 0
    s_add_u32 s44, s47, 147456
    s_mov_b32 m0, s44
    s_add_u32 s44, s44, 1024
    global_load_lds_dwordx4 v40, s[42:43]
    s_add_u32 s42, s42, 0x8000
    s_addc_u32 s43, s43, 0
    s_mov_b32 m0, s44
    s_add_u32 s44, s44, 1024
    global_load_lds_dwordx4 v40, s[42:43]
    s_add_u32 s42, s42, 0x8000
    s_addc_u32 s43, s43, 0
    s_mov_b32 m0, s44
    s_add_u32 s44, s44, 1024
    global_load_lds_dwordx4 v41, s[42:43]
    s_add_u32 s42, s42, 0x8000
    s_addc_u32 s43, s43, 0
    s_mov_b32 m0, s44
    s_add_u32 s44, s44, 1024
    global_load_lds_dwordx4 v41, s[42:43]
    v_add_u32 v47, 0, v42
    v_add_u32 v44, 0, v43
    s_cmp_lg_u32 s34, 0
    s_cbranch_scc1 Lwv_51
    ds_read_b64_tr_b16 a[112:113], v47 offset:0
    ds_read_b64_tr_b16 a[114:115], v47 offset:1024
    ds_read_b64_tr_b16 a[116:117], v47 offset:8192
    ds_read_b64_tr_b16 a[118:119], v47 offset:9216
    ds_read_b64_tr_b16 a[160:161], v44 offset:0
    ds_read_b64_tr_b16 a[162:163], v44 offset:1024
    ds_read_b64_tr_b16 a[164:165], v44 offset:8192
    ds_read_b64_tr_b16 a[166:167], v44 offset:9216
    s_branch Lwd_50
Lwv_51:
    s_cmp_lg_u32 s34, 1
    s_cbranch_scc1 Lwv_52
    ds_read_b64_tr_b16 a[128:129], v47 offset:0
    ds_read_b64_tr_b16 a[130:131], v47 offset:1024
    ds_read_b64_tr_b16 a[132:133], v47 offset:8192
    ds_read_b64_tr_b16 a[134:135], v47 offset:9216
    ds_read_b64_tr_b16 a[176:177], v44 offset:0
    ds_read_b64_tr_b16 a[178:179], v44 offset:1024
    ds_read_b64_tr_b16 a[180:181], v44 offset:8192
    ds_read_b64_tr_b16 a[182:183], v44 offset:9216
    s_branch Lwd_50
Lwv_52:
    s_cmp_lg_u32 s34, 2
    s_cbranch_scc1 Lwv_53
    ds_read_b64_tr_b16 v[80:81], v47 offset:0
    ds_read_b64_tr_b16 v[82:83], v47 offset:1024
    ds_read_b64_tr_b16 v[84:85], v47 offset:8192
    ds_read_b64_tr_b16 v[86:87], v47 offset:9216
    ds_read_b64_tr_b16 v[96:97], v44 offset:0
    ds_read_b64_tr_b16 v[98:99], v44 offset:1024
    ds_read_b64_tr_b16 v[100:101], v44 offset:8192
    ds_read_b64_tr_b16 v[102:103], v44 offset:9216
    s_branch Lwd_50
Lwv_53:
    ds_read_b64_tr_b16 a[96:97], v47 offset:0
    ds_read_b64_tr_b16 a[98:99], v47 offset:1024
    ds_read_b64_tr_b16 a[100:101], v47 offset:8192
    ds_read_b64_tr_b16 a[102:103], v47 offset:9216
    ds_read_b64_tr_b16 a[144:145], v44 offset:0
    ds_read_b64_tr_b16 a[146:147], v44 offset:1024
    ds_read_b64_tr_b16 a[148:149], v44 offset:8192
    ds_read_b64_tr_b16 a[150:151], v44 offset:9216
Lwd_50:
    s_waitcnt vmcnt(16) lgkmcnt(0)
    s_barrier
    s_add_u32 s42, s22, 0x100000
    s_addc_u32 s43, s23, 0
    s_add_u32 s44, s47, 0
    s_mov_b32 m0, s44
    s_add_u32 s44, s44, 1024
    global_load_lds_dwordx4 v40, s[42:43]
    s_add_u32 s42, s42, 0x8000
    s_addc_u32 s43, s43, 0
    s_mov_b32 m0, s44
    s_add_u32 s44, s44, 1024
    global_load_lds_dwordx4 v40, s[42:43]
    s_add_u32 s42, s42, 0x8000
    s_addc_u32 s43, s43, 0
    s_mov_b32 m0, s44
    s_add_u32 s44, s44, 1024
    global_load_lds_dwordx4 v41, s[42:43]
    s_add_u32 s42, s42, 0x8000
    s_addc_u32 s43, s43, 0
    s_mov_b32 m0, s44
    s_add_u32 s44, s44, 1024
    global_load_lds_dwordx4 v41, s[42:43]
    v_add_u32 v47, 16384, v42
    v_add_u32 v44, 16384, v43
    s_cmp_lg_u32 s34, 0
    s_cbranch_scc1 Lwv_55
    ds_read_b64_tr_b16 a[120:121], v47 offset:0
    ds_read_b64_tr_b16 a[122:123], v47 offset:1024
    ds_read_b64_tr_b16 a[124:125], v47 offset:8192
    ds_read_b64_tr_b16 a[126:127], v47 offset:9216
    ds_read_b64_tr_b16 a[168:169], v44 offset:0
    ds_read_b64_tr_b16 a[170:171], v44 offset:1024
    ds_read_b64_tr_b16 a[172:173], v44 offset:8192
    ds_read_b64_tr_b16 a[174:175], v44 offset:9216
    s_branch Lwd_54
Lwv_55:
    s_cmp_lg_u32 s34, 1
    s_cbranch_scc1 Lwv_56
    ds_read_b64_tr_b16 a[136:137], v47 offset:0
    ds_read_b64_tr_b16 a[138:139], v47 offset:1024
    ds_read_b64_tr_b16 a[140:141], v47 offset:8192
    ds_read_b64_tr_b16 a[142:143], v47 offset:9216
    ds_read_b64_tr_b16 a[184:185], v44 offset:0
    ds_read_b64_tr_b16 a[186:187], v44 offset:1024
    ds_read_b64_tr_b16 a[188:189], v44 offset:8192
    ds_read_b64_tr_b16 a[190:191], v44 offset:9216
    s_branch Lwd_54
Lwv_56:
    s_cmp_lg_u32 s34, 2
    s_cbranch_scc1 Lwv_57
    ds_read_b64_tr_b16 v[88:89], v47 offset:0
    ds_read_b64_tr_b16 v[90:91], v47 offset:1024
    ds_read_b64_tr_b16 v[92:93], v47 offset:8192
    ds_read_b64_tr_b16 v[94:95], v47 offset:9216
    ds_read_b64_tr_b16 v[104:105], v44 offset:0
    ds_read_b64_tr_b16 v[106:107], v44 offset:1024
    ds_read_b64_tr_b16 v[108:109], v44 offset:8192
    ds_read_b64_tr_b16 v[110:111], v44 offset:9216
    s_branch Lwd_54
Lwv_57:
    ds_read_b64_tr_b16 a[104:105], v47 offset:0
    ds_read_b64_tr_b16 a[106:107], v47 offset:1024
    ds_read_b64_tr_b16 a[108:109], v47 offset:8192
    ds_read_b64_tr_b16 a[110:111], v47 offset:9216
    ds_read_b64_tr_b16 a[152:153], v44 offset:0
    ds_read_b64_tr_b16 a[154:155], v44 offset:1024
    ds_read_b64_tr_b16 a[156:157], v44 offset:8192
    ds_read_b64_tr_b16 a[158:159], v44 offset:9216
Lwd_54:
    s_waitcnt vmcnt(16) lgkmcnt(0)
    s_barrier
    s_add_u32 s42, s22, 0x180000
    s_addc_u32 s43, s23, 0
    s_add_u32 s44, s47, 16384
    s_mov_b32 m0, s44
    s_add_u32 s44, s44, 1024
    global_load_lds_dwordx4 v40, s[42:43]
    s_add_u32 s42, s42, 0x8000
    s_addc_u32 s43, s43, 0
    s_mov_b32 m0, s44
    s_add_u32 s44, s44, 1024
    global_load_lds_dwordx4 v40, s[42:43]
    s_add_u32 s42, s42, 0x8000
    s_addc_u32 s43, s43, 0
    s_mov_b32 m0, s44
    s_add_u32 s44, s44, 1024
    global_load_lds_dwordx4 v41, s[42:43]
    s_add_u32 s42, s42, 0x8000
    s_addc_u32 s43, s43, 0
    s_mov_b32 m0, s44
    s_add_u32 s44, s44, 1024
    global_load_lds_dwordx4 v41, s[42:43]
    v_add_u32 v47, 49152, v42
    v_add_u32 v44, 49152, v43
    s_cmp_lg_u32 s34, 0
    s_cbranch_scc1 Lwv_59
    ds_read_b64_tr_b16 a[128:129], v47 offset:0
    ds_read_b64_tr_b16 a[130:131], v47 offset:1024
    ds_read_b64_tr_b16 a[132:133], v47 offset:8192
    ds_read_b64_tr_b16 a[134:135], v47 offset:9216
    ds_read_b64_tr_b16 a[176:177], v44 offset:0
    ds_read_b64_tr_b16 a[178:179], v44 offset:1024
    ds_read_b64_tr_b16 a[180:181], v44 offset:8192
    ds_read_b64_tr_b16 a[182:183], v44 offset:9216
    s_branch Lwd_58
Lwv_59:
    s_cmp_lg_u32 s34, 1
    s_cbranch_scc1 Lwv_60
    ds_read_b64_tr_b16 a[112:113], v47 offset:0
    ds_read_b64_tr_b16 a[114:115], v47 offset:1024
    ds_read_b64_tr_b16 a[116:117], v47 offset:8192
    ds_read_b64_tr_b16 a[118:119], v47 offset:9216
    ds_read_b64_tr_b16 a[160:161], v44 offset:0
    ds_read_b64_tr_b16 a[162:163], v44 offset:1024
    ds_read_b64_tr_b16 a[164:165], v44 offset:8192
    ds_read_b64_tr_b16 a[166:167], v44 offset:9216
    s_branch Lwd_58
Lwv_60:
    s_cmp_lg_u32 s34, 2
    s_cbranch_scc1 Lwv_61
    ds_read_b64_tr_b16 a[96:97], v47 offset:0
    ds_read_b64_tr_b16 a[98:99], v47 offset:1024
    ds_read_b64_tr_b16 a[100:101], v47 offset:8192
    ds_read_b64_tr_b16 a[102:103], v47 offset:9216
    ds_read_b64_tr_b16 a[144:145], v44 offset:0
    ds_read_b64_tr_b16 a[146:147], v44 offset:1024
    ds_read_b64_tr_b16 a[148:149], v44 offset:8192
    ds_read_b64_tr_b16 a[150:151], v44 offset:9216
    s_branch Lwd_58
Lwv_61:
    ds_read_b64_tr_b16 v[80:81], v47 offset:0
    ds_read_b64_tr_b16 v[82:83], v47 offset:1024
    ds_read_b64_tr_b16 v[84:85], v47 offset:8192
    ds_read_b64_tr_b16 v[86:87], v47 offset:9216
    ds_read_b64_tr_b16 v[96:97], v44 offset:0
    ds_read_b64_tr_b16 v[98:99], v44 offset:1024
    ds_read_b64_tr_b16 v[100:101], v44 offset:8192
    ds_read_b64_tr_b16 v[102:103], v44 offset:9216
Lwd_58:
    s_waitcnt vmcnt(16) lgkmcnt(0)
    s_barrier
    s_add_u32 s42, s22, 0x200000
    s_addc_u32 s43, s23, 0
    s_add_u32 s44, s47, 49152
    s_mov_b32 m0, s44
    s_add_u32 s44, s44, 1024
    global_load_lds_dwordx4 v40, s[42:43]
    s_add_u32 s42, s42, 0x8000
    s_addc_u32 s43, s43, 0
    s_mov_b32 m0, s44
    s_add_u32 s44, s44, 1024
    global_load_lds_dwordx4 v40, s[42:43]
    s_add_u32 s42, s42, 0x8000
    s_addc_u32 s43, s43, 0
    s_mov_b32 m0, s44
    s_add_u32 s44, s44, 1024
    global_load_lds_dwordx4 v41, s[42:43]
    s_add_u32 s42, s42, 0x8000
    s_addc_u32 s43, s43, 0
    s_mov_b32 m0, s44
    s_add_u32 s44, s44, 1024
    global_load_lds_dwordx4 v41, s[42:43]
    v_add_u32 v47, 81920, v42
    v_add_u32 v44, 81920, v43
    s_cmp_lg_u32 s34, 0
    s_cbranch_scc1 Lwv_63
    ds_read_b64_tr_b16 a[136:137], v47 offset:0
    ds_read_b64_tr_b16 a[138:139], v47 offset:1024
    ds_read_b64_tr_b16 a[140:141], v47 offset:8192
    ds_read_b64_tr_b16 a[142:143], v47 offset:9216
    ds_read_b64_tr_b16 a[184:185], v44 offset:0
    ds_read_b64_tr_b16 a[186:187], v44 offset:1024
    ds_read_b64_tr_b16 a[188:189], v44 offset:8192
    ds_read_b64_tr_b16 a[190:191], v44 offset:9216
    s_branch Lwd_62
Lwv_63:
    s_cmp_lg_u32 s34, 1
    s_cbranch_scc1 Lwv_64
    ds_read_b64_tr_b16 a[120:121], v47 offset:0
    ds_read_b64_tr_b16 a[122:123], v47 offset:1024
    ds_read_b64_tr_b16 a[124:125], v47 offset:8192
    ds_read_b64_tr_b16 a[126:127], v47 offset:9216
    ds_read_b64_tr_b16 a[168:169], v44 offset:0
    ds_read_b64_tr_b16 a[170:171], v44 offset:1024
    ds_read_b64_tr_b16 a[172:173], v44 offset:8192
    ds_read_b64_tr_b16 a[174:175], v44 offset:9216
    s_branch Lwd_62
Lwv_64:
    s_cmp_lg_u32 s34, 2
    s_cbranch_scc1 Lwv_65
    ds_read_b64_tr_b16 a[104:105], v47 offset:0
    ds_read_b64_tr_b16 a[106:107], v47 offset:1024
    ds_read_b64_tr_b16 a[108:109], v47 offset:8192
    ds_read_b64_tr_b16 a[110:111], v47 offset:9216
    ds_read_b64_tr_b16 a[152:153], v44 offset:0
    ds_read_b64_tr_b16 a[154:155], v44 offset:1024
    ds_read_b64_tr_b16 a[156:157], v44 offset:8192
    ds_read_b64_tr_b16 a[158:159], v44 offset:9216
    s_branch Lwd_62
Lwv_65:
    ds_read_b64_tr_b16 v[88:89], v47 offset:0
    ds_read_b64_tr_b16 v[90:91], v47 offset:1024
    ds_read_b64_tr_b16 v[92:93], v47 offset:8192
    ds_read_b64_tr_b16 v[94:95], v47 offset:9216
    ds_read_b64_tr_b16 v[104:105], v44 offset:0
    ds_read_b64_tr_b16 v[106:107], v44 offset:1024
    ds_read_b64_tr_b16 v[108:109], v44 offset:8192
    ds_read_b64_tr_b16 v[110:111], v44 offset:9216
Lwd_62:
    s_waitcnt vmcnt(16) lgkmcnt(0)
    s_barrier
    s_add_u32 s42, s22, 0x280000
    s_addc_u32 s43, s23, 0
    s_add_u32 s44, s47, 81920
    s_mov_b32 m0, s44
    s_add_u32 s44, s44, 1024
    global_load_lds_dwordx4 v40, s[42:43]
    s_add_u32 s42, s42, 0x8000
    s_addc_u32 s43, s43, 0
    s_mov_b32 m0, s44
    s_add_u32 s44, s44, 1024
    global_load_lds_dwordx4 v40, s[42:43]
    s_add_u32 s42, s42, 0x8000
    s_addc_u32 s43, s43, 0
    s_mov_b32 m0, s44
    s_add_u32 s44, s44, 1024
    global_load_lds_dwordx4 v41, s[42:43]
    s_add_u32 s42, s42, 0x8000
    s_addc_u32 s43, s43, 0
    s_mov_b32 m0, s44
    s_add_u32 s44, s44, 1024
    global_load_lds_dwordx4 v41, s[42:43]
    v_add_u32 v47, 114688, v42
    v_add_u32 v44, 114688, v43
    s_cmp_lg_u32 s34, 0
    s_cbranch_scc1 Lwv_67
    ds_read_b64_tr_b16 v[128:129], v47 offset:0
    ds_read_b64_tr_b16 v[130:131], v47 offset:1024
    ds_read_b64_tr_b16 v[132:133], v47 offset:8192
    ds_read_b64_tr_b16 v[134:135], v47 offset:9216
    ds_read_b64_tr_b16 v[192:193], v44 offset:0
    ds_read_b64_tr_b16 v[194:195], v44 offset:1024
    ds_read_b64_tr_b16 v[196:197], v44 offset:8192
    ds_read_b64_tr_b16 v[198:199], v44 offset:9216
    s_branch Lwd_66
Lwv_67:
    s_cmp_lg_u32 s34, 1
    s_cbranch_scc1 Lwv_68
    ds_read_b64_tr_b16 v[144:145], v47 offset:0
    ds_read_b64_tr_b16 v[146:147], v47 offset:1024
    ds_read_b64_tr_b16 v[148:149], v47 offset:8192
    ds_read_b64_tr_b16 v[150:151], v47 offset:9216
    ds_read_b64_tr_b16 v[208:209], v44 offset:0
    ds_read_b64_tr_b16 v[210:211], v44 offset:1024
    ds_read_b64_tr_b16 v[212:213], v44 offset:8192
    ds_read_b64_tr_b16 v[214:215], v44 offset:9216
    s_branch Lwd_66
Lwv_68:
    s_cmp_lg_u32 s34, 2
    s_cbranch_scc1 Lwv_69
    ds_read_b64_tr_b16 v[160:161], v47 offset:0
    ds_read_b64_tr_b16 v[162:163], v47 offset:1024
    ds_read_b64_tr_b16 v[164:165], v47 offset:8192
    ds_read_b64_tr_b16 v[166:167], v47 offset:9216
    ds_read_b64_tr_b16 v[224:225], v44 offset:0
    ds_read_b64_tr_b16 v[226:227], v44 offset:1024
    ds_read_b64_tr_b16 v[228:229], v44 offset:8192
    ds_read_b64_tr_b16 v[230:231], v44 offset:9216
    s_branch Lwd_66
Lwv_69:
    ds_read_b64_tr_b16 v[176:177], v47 offset:0
    ds_read_b64_tr_b16 v[178:179], v47 offset:1024
    ds_read_b64_tr_b16 v[180:181], v47 offset:8192
    ds_read_b64_tr_b16 v[182:183], v47 offset:9216
    ds_read_b64_tr_b16 v[240:241], v44 offset:0
    ds_read_b64_tr_b16 v[242:243], v44 offset:1024
    ds_read_b64_tr_b16 v[244:245], v44 offset:8192
    ds_read_b64_tr_b16 v[246:247], v44 offset:9216
Lwd_66:
    s_waitcnt vmcnt(16) lgkmcnt(0)
    s_barrier
    s_add_u32 s42, s22, 0x300000
    s_addc_u32 s43, s23, 0
    s_add_u32 s44, s47, 114688
    s_mov_b32 m0, s44
    s_add_u32 s44, s44, 1024
    global_load_lds_dwordx4 v40, s[42:43]
    s_add_u32 s42, s42, 0x8000
    s_addc_u32 s43, s43, 0
    s_mov_b32 m0, s44
    s_add_u32 s44, s44, 1024
    global_load_lds_dwordx4 v40, s[42:43]
    s_add_u32 s42, s42, 0x8000
    s_addc_u32 s43, s43, 0
    s_mov_b32 m0, s44
    s_add_u32 s44, s44, 1024
    global_load_lds_dwordx4 v41, s[42:43]
    s_add_u32 s42, s42, 0x8000
    s_addc_u32 s43, s43, 0
    s_mov_b32 m0, s44
    s_add_u32 s44, s44, 1024
    global_load_lds_dwordx4 v41, s[42:43]
    v_add_u32 v47, 147456, v42
    v_add_u32 v44, 147456, v43
    s_cmp_lg_u32 s34, 0
    s_cbranch_scc1 Lwv_71
    ds_read_b64_tr_b16 v[136:137], v47 offset:0
    ds_read_b64_tr_b16 v[138:139], v47 offset:1024
    ds_read_b64_tr_b16 v[140:141], v47 offset:8192
    ds_read_b64_tr_b16 v[142:143], v47 offset:9216
    ds_read_b64_tr_b16 v[200:201], v44 offset:0
    ds_read_b64_tr_b16 v[202:203], v44 offset:1024
    ds_read_b64_tr_b16 v[204:205], v44 offset:8192
    ds_read_b64_tr_b16 v[206:207], v44 offset:9216
    s_branch Lwd_70
Lwv_71:
    s_cmp_lg_u32 s34, 1
    s_cbranch_scc1 Lwv_72
    ds_read_b64_tr_b16 v[152:153], v47 offset:0
    ds_read_b64_tr_b16 v[154:155], v47 offset:1024
    ds_read_b64_tr_b16 v[156:157], v47 offset:8192
    ds_read_b64_tr_b16 v[158:159], v47 offset:9216
    ds_read_b64_tr_b16 v[216:217], v44 offset:0
    ds_read_b64_tr_b16 v[218:219], v44 offset:1024
    ds_read_b64_tr_b16 v[220:221], v44 offset:8192
    ds_read_b64_tr_b16 v[222:223], v44 offset:9216
    s_branch Lwd_70
Lwv_72:
    s_cmp_lg_u32 s34, 2
    s_cbranch_scc1 Lwv_73
    ds_read_b64_tr_b16 v[168:169], v47 offset:0
    ds_read_b64_tr_b16 v[170:171], v47 offset:1024
    ds_read_b64_tr_b16 v[172:173], v47 offset:8192
    ds_read_b64_tr_b16 v[174:175], v47 offset:9216
    ds_read_b64_tr_b16 v[232:233], v44 offset:0
    ds_read_b64_tr_b16 v[234:235], v44 offset:1024
    ds_read_b64_tr_b16 v[236:237], v44 offset:8192
    ds_read_b64_tr_b16 v[238:239], v44 offset:9216
    s_branch Lwd_70
Lwv_73:
    ds_read_b64_tr_b16 v[184:185], v47 offset:0
    ds_read_b64_tr_b16 v[186:187], v47 offset:1024
    ds_read_b64_tr_b16 v[188:189], v47 offset:8192
    ds_read_b64_tr_b16 v[190:191], v47 offset:9216
    ds_read_b64_tr_b16 v[248:249], v44 offset:0
    ds_read_b64_tr_b16 v[250:251], v44 offset:1024
    ds_read_b64_tr_b16 v[252:253], v44 offset:8192
    ds_read_b64_tr_b16 v[254:255], v44 offset:9216
Lwd_70:
    s_waitcnt vmcnt(16) lgkmcnt(0)
    s_barrier
    s_add_u32 s42, s22, 0x380000
    s_addc_u32 s43, s23, 0
    s_add_u32 s44, s47, 147456
    s_mov_b32 m0, s44
    s_add_u32 s44, s44, 1024
    global_load_lds_dwordx4 v40, s[42:43]
    s_add_u32 s42, s42, 0x8000
    s_addc_u32 s43, s43, 0
    s_mov_b32 m0, s44
    s_add_u32 s44, s44, 1024
    global_load_lds_dwordx4 v40, s[42:43]
    s_add_u32 s42, s42, 0x8000
    s_addc_u32 s43, s43, 0
    s_mov_b32 m0, s44
    s_add_u32 s44, s44, 1024
    global_load_lds_dwordx4 v41, s[42:43]
    s_add_u32 s42, s42, 0x8000
    s_addc_u32 s43, s43, 0
    s_mov_b32 m0, s44
    s_add_u32 s44, s44, 1024
    global_load_lds_dwordx4 v41, s[42:43]
    v_add_u32 v47, 0, v42
    v_add_u32 v44, 0, v43
    s_cmp_lg_u32 s34, 0
    s_cbranch_scc1 Lwv_75
    ds_read_b64_tr_b16 v[144:145], v47 offset:0
    ds_read_b64_tr_b16 v[146:147], v47 offset:1024
    ds_read_b64_tr_b16 v[148:149], v47 offset:8192
    ds_read_b64_tr_b16 v[150:151], v47 offset:9216
    ds_read_b64_tr_b16 v[208:209], v44 offset:0
    ds_read_b64_tr_b16 v[210:211], v44 offset:1024
    ds_read_b64_tr_b16 v[212:213], v44 offset:8192
    ds_read_b64_tr_b16 v[214:215], v44 offset:9216
    s_branch Lwd_74
Lwv_75:
    s_cmp_lg_u32 s34, 1
    s_cbranch_scc1 Lwv_76
    ds_read_b64_tr_b16 v[128:129], v47 offset:0
    ds_read_b64_tr_b16 v[130:131], v47 offset:1024
    ds_read_b64_tr_b16 v[132:133], v47 offset:8192
    ds_read_b64_tr_b16 v[134:135], v47 offset:9216
    ds_read_b64_tr_b16 v[192:193], v44 offset:0
    ds_read_b64_tr_b16 v[194:195], v44 offset:1024
    ds_read_b64_tr_b16 v[196:197], v44 offset:8192
    ds_read_b64_tr_b16 v[198:199], v44 offset:9216
    s_branch Lwd_74
Lwv_76:
    s_cmp_lg_u32 s34, 2
    s_cbranch_scc1 Lwv_77
    ds_read_b64_tr_b16 v[176:177], v47 offset:0
    ds_read_b64_tr_b16 v[178:179], v47 offset:1024
    ds_read_b64_tr_b16 v[180:181], v47 offset:8192
    ds_read_b64_tr_b16 v[182:183], v47 offset:9216
    ds_read_b64_tr_b16 v[240:241], v44 offset:0
    ds_read_b64_tr_b16 v[242:243], v44 offset:1024
    ds_read_b64_tr_b16 v[244:245], v44 offset:8192
    ds_read_b64_tr_b16 v[246:247], v44 offset:9216
    s_branch Lwd_74
Lwv_77:
    ds_read_b64_tr_b16 v[160:161], v47 offset:0
    ds_read_b64_tr_b16 v[162:163], v47 offset:1024
    ds_read_b64_tr_b16 v[164:165], v47 offset:8192
    ds_read_b64_tr_b16 v[166:167], v47 offset:9216
    ds_read_b64_tr_b16 v[224:225], v44 offset:0
    ds_read_b64_tr_b16 v[226:227], v44 offset:1024
    ds_read_b64_tr_b16 v[228:229], v44 offset:8192
    ds_read_b64_tr_b16 v[230:231], v44 offset:9216
Lwd_74:
    s_waitcnt vmcnt(16) lgkmcnt(0)
    s_barrier
    v_add_u32 v47, 16384, v42
    v_add_u32 v44, 16384, v43
    s_cmp_lg_u32 s34, 0
    s_cbranch_scc1 Lwv_79
    ds_read_b64_tr_b16 v[152:153], v47 offset:0
    ds_read_b64_tr_b16 v[154:155], v47 offset:1024
    ds_read_b64_tr_b16 v[156:157], v47 offset:8192
    ds_read_b64_tr_b16 v[158:159], v47 offset:9216
    ds_read_b64_tr_b16 v[216:217], v44 offset:0
    ds_read_b64_tr_b16 v[218:219], v44 offset:1024
    ds_read_b64_tr_b16 v[220:221], v44 offset:8192
    ds_read_b64_tr_b16 v[222:223], v44 offset:9216
    s_branch Lwd_78
Lwv_79:
    s_cmp_lg_u32 s34, 1
    s_cbranch_scc1 Lwv_80
    ds_read_b64_tr_b16 v[136:137], v47 offset:0
    ds_read_b64_tr_b16 v[138:139], v47 offset:1024
    ds_read_b64_tr_b16 v[140:141], v47 offset:8192
    ds_read_b64_tr_b16 v[142:143], v47 offset:9216
    ds_read_b64_tr_b16 v[200:201], v44 offset:0
    ds_read_b64_tr_b16 v[202:203], v44 offset:1024
    ds_read_b64_tr_b16 v[204:205], v44 offset:8192
    ds_read_b64_tr_b16 v[206:207], v44 offset:9216
    s_branch Lwd_78
Lwv_80:
    s_cmp_lg_u32 s34, 2
    s_cbranch_scc1 Lwv_81
    ds_read_b64_tr_b16 v[184:185], v47 offset:0
    ds_read_b64_tr_b16 v[186:187], v47 offset:1024
    ds_read_b64_tr_b16 v[188:189], v47 offset:8192
    ds_read_b64_tr_b16 v[190:191], v47 offset:9216
    ds_read_b64_tr_b16 v[248:249], v44 offset:0
    ds_read_b64_tr_b16 v[250:251], v44 offset:1024
    ds_read_b64_tr_b16 v[252:253], v44 offset:8192
    ds_read_b64_tr_b16 v[254:255], v44 offset:9216
    s_branch Lwd_78
Lwv_81:
    ds_read_b64_tr_b16 v[168:169], v47 offset:0
    ds_read_b64_tr_b16 v[170:171], v47 offset:1024
    ds_read_b64_tr_b16 v[172:173], v47 offset:8192
    ds_read_b64_tr_b16 v[174:175], v47 offset:9216
    ds_read_b64_tr_b16 v[232:233], v44 offset:0
    ds_read_b64_tr_b16 v[234:235], v44 offset:1024
    ds_read_b64_tr_b16 v[236:237], v44 offset:8192
    ds_read_b64_tr_b16 v[238:239], v44 offset:9216
Lwd_78:
    s_waitcnt vmcnt(12) lgkmcnt(0)
    s_barrier
    v_add_u32 v47, 49152, v42
    v_add_u32 v44, 49152, v43
    s_cmp_lg_u32 s34, 0
    s_cbranch_scc1 Lwv_83
    ds_read_b64_tr_b16 v[160:161], v47 offset:0
    ds_read_b64_tr_b16 v[162:163], v47 offset:1024
    ds_read_b64_tr_b16 v[164:165], v47 offset:8192
    ds_read_b64_tr_b16 v[166:167], v47 offset:9216
    ds_read_b64_tr_b16 v[224:225], v44 offset:0
    ds_read_b64_tr_b16 v[226:227], v44 offset:1024
    ds_read_b64_tr_b16 v[228:229], v44 offset:8192
    ds_read_b64_tr_b16 v[230:231], v44 offset:9216
    s_branch Lwd_82
Lwv_83:
    s_cmp_lg_u32 s34, 1
    s_cbranch_scc1 Lwv_84
    ds_read_b64_tr_b16 v[176:177], v47 offset:0
    ds_read_b64_tr_b16 v[178:179], v47 offset:1024
    ds_read_b64_tr_b16 v[180:181], v47 offset:8192
    ds_read_b64_tr_b16 v[182:183], v47 offset:9216
    ds_read_b64_tr_b16 v[240:241], v44 offset:0
    ds_read_b64_tr_b16 v[242:243], v44 offset:1024
    ds_read_b64_tr_b16 v[244:245], v44 offset:8192
    ds_read_b64_tr_b16 v[246:247], v44 offset:9216
    s_branch Lwd_82
Lwv_84:
    s_cmp_lg_u32 s34, 2
    s_cbranch_scc1 Lwv_85
    ds_read_b64_tr_b16 v[128:129], v47 offset:0
    ds_read_b64_tr_b16 v[130:131], v47 offset:1024
    ds_read_b64_tr_b16 v[132:133], v47 offset:8192
    ds_read_b64_tr_b16 v[134:135], v47 offset:9216
    ds_read_b64_tr_b16 v[192:193], v44 offset:0
    ds_read_b64_tr_b16 v[194:195], v44 offset:1024
    ds_read_b64_tr_b16 v[196:197], v44 offset:8192
    ds_read_b64_tr_b16 v[198:199], v44 offset:9216
    s_branch Lwd_82
Lwv_85:
    ds_read_b64_tr_b16 v[144:145], v47 offset:0
    ds_read_b64_tr_b16 v[146:147], v47 offset:1024
    ds_read_b64_tr_b16 v[148:149], v47 offset:8192
    ds_read_b64_tr_b16 v[150:151], v47 offset:9216
    ds_read_b64_tr_b16 v[208:209], v44 offset:0
    ds_read_b64_tr_b16 v[210:211], v44 offset:1024
    ds_read_b64_tr_b16 v[212:213], v44 offset:8192
    ds_read_b64_tr_b16 v[214:215], v44 offset:9216
Lwd_82:
    s_waitcnt vmcnt(8) lgkmcnt(0)
    s_barrier
    v_add_u32 v47, 81920, v42
    v_add_u32 v44, 81920, v43
    s_cmp_lg_u32 s34, 0
    s_cbranch_scc1 Lwv_87
    ds_read_b64_tr_b16 v[168:169], v47 offset:0
    ds_read_b64_tr_b16 v[170:171], v47 offset:1024
    ds_read_b64_tr_b16 v[172:173], v47 offset:8192
    ds_read_b64_tr_b16 v[174:175], v47 offset:9216
    ds_read_b64_tr_b16 v[232:233], v44 offset:0
    ds_read_b64_tr_b16 v[234:235], v44 offset:1024
    ds_read_b64_tr_b16 v[236:237], v44 offset:8192
    ds_read_b64_tr_b16 v[238:239], v44 offset:9216
    s_branch Lwd_86
Lwv_87:
    s_cmp_lg_u32 s34, 1
    s_cbranch_scc1 Lwv_88
    ds_read_b64_tr_b16 v[184:185], v47 offset:0
    ds_read_b64_tr_b16 v[186:187], v47 offset:1024
    ds_read_b64_tr_b16 v[188:189], v47 offset:8192
    ds_read_b64_tr_b16 v[190:191], v47 offset:9216
    ds_read_b64_tr_b16 v[248:249], v44 offset:0
    ds_read_b64_tr_b16 v[250:251], v44 offset:1024
    ds_read_b64_tr_b16 v[252:253], v44 offset:8192
    ds_read_b64_tr_b16 v[254:255], v44 offset:9216
    s_branch Lwd_86
Lwv_88:
    s_cmp_lg_u32 s34, 2
    s_cbranch_scc1 Lwv_89
    ds_read_b64_tr_b16 v[136:137], v47 offset:0
    ds_read_b64_tr_b16 v[138:139], v47 offset:1024
    ds_read_b64_tr_b16 v[140:141], v47 offset:8192
    ds_read_b64_tr_b16 v[142:143], v47 offset:9216
    ds_read_b64_tr_b16 v[200:201], v44 offset:0
    ds_read_b64_tr_b16 v[202:203], v44 offset:1024
    ds_read_b64_tr_b16 v[204:205], v44 offset:8192
    ds_read_b64_tr_b16 v[206:207], v44 offset:9216
    s_branch Lwd_86
Lwv_89:
    ds_read_b64_tr_b16 v[152:153], v47 offset:0
    ds_read_b64_tr_b16 v[154:155], v47 offset:1024
    ds_read_b64_tr_b16 v[156:157], v47 offset:8192
    ds_read_b64_tr_b16 v[158:159], v47 offset:9216
    ds_read_b64_tr_b16 v[216:217], v44 offset:0
    ds_read_b64_tr_b16 v[218:219], v44 offset:1024
    ds_read_b64_tr_b16 v[220:221], v44 offset:8192
    ds_read_b64_tr_b16 v[222:223], v44 offset:9216
Lwd_86:
    s_waitcnt vmcnt(4) lgkmcnt(0)
    s_barrier
    v_add_u32 v47, 114688, v42
    v_add_u32 v44, 114688, v43
    s_cmp_lg_u32 s34, 0
    s_cbranch_scc1 Lwv_91
    ds_read_b64_tr_b16 v[176:177], v47 offset:0
    ds_read_b64_tr_b16 v[178:179], v47 offset:1024
    ds_read_b64_tr_b16 v[180:181], v47 offset:8192
    ds_read_b64_tr_b16 v[182:183], v47 offset:9216
    ds_read_b64_tr_b16 v[240:241], v44 offset:0
    ds_read_b64_tr_b16 v[242:243], v44 offset:1024
    ds_read_b64_tr_b16 v[244:245], v44 offset:8192
    ds_read_b64_tr_b16 v[246:247], v44 offset:9216
    s_branch Lwd_90
Lwv_91:
    s_cmp_lg_u32 s34, 1
    s_cbranch_scc1 Lwv_92
    ds_read_b64_tr_b16 v[160:161], v47 offset:0
    ds_read_b64_tr_b16 v[162:163], v47 offset:1024
    ds_read_b64_tr_b16 v[164:165], v47 offset:8192
    ds_read_b64_tr_b16 v[166:167], v47 offset:9216
    ds_read_b64_tr_b16 v[224:225], v44 offset:0
    ds_read_b64_tr_b16 v[226:227], v44 offset:1024
    ds_read_b64_tr_b16 v[228:229], v44 offset:8192
    ds_read_b64_tr_b16 v[230:231], v44 offset:9216
    s_branch Lwd_90
Lwv_92:
    s_cmp_lg_u32 s34, 2
    s_cbranch_scc1 Lwv_93
    ds_read_b64_tr_b16 v[144:145], v47 offset:0
    ds_read_b64_tr_b16 v[146:147], v47 offset:1024
    ds_read_b64_tr_b16 v[148:149], v47 offset:8192
    ds_read_b64_tr_b16 v[150:151], v47 offset:9216
    ds_read_b64_tr_b16 v[208:209], v44 offset:0
    ds_read_b64_tr_b16 v[210:211], v44 offset:1024
    ds_read_b64_tr_b16 v[212:213], v44 offset:8192
    ds_read_b64_tr_b16 v[214:215], v44 offset:9216
    s_branch Lwd_90
Lwv_93:
    ds_read_b64_tr_b16 v[128:129], v47 offset:0
    ds_read_b64_tr_b16 v[130:131], v47 offset:1024
    ds_read_b64_tr_b16 v[132:133], v47 offset:8192
    ds_read_b64_tr_b16 v[134:135], v47 offset:9216
    ds_read_b64_tr_b16 v[192:193], v44 offset:0
    ds_read_b64_tr_b16 v[194:195], v44 offset:1024
    ds_read_b64_tr_b16 v[196:197], v44 offset:8192
    ds_read_b64_tr_b16 v[198:199], v44 offset:9216
Lwd_90:
    s_waitcnt vmcnt(0) lgkmcnt(0)
    s_barrier
    v_add_u32 v47, 147456, v42
    v_add_u32 v44, 147456, v43
    s_cmp_lg_u32 s34, 0
    s_cbranch_scc1 Lwv_95
    ds_read_b64_tr_b16 v[184:185], v47 offset:0
    ds_read_b64_tr_b16 v[186:187], v47 offset:1024
    ds_read_b64_tr_b16 v[188:189], v47 offset:8192
    ds_read_b64_tr_b16 v[190:191], v47 offset:9216
    ds_read_b64_tr_b16 v[248:249], v44 offset:0
    ds_read_b64_tr_b16 v[250:251], v44 offset:1024
    ds_read_b64_tr_b16 v[252:253], v44 offset:8192
    ds_read_b64_tr_b16 v[254:255], v44 offset:9216
    s_branch Lwd_94
Lwv_95:
    s_cmp_lg_u32 s34, 1
    s_cbranch_scc1 Lwv_96
    ds_read_b64_tr_b16 v[168:169], v47 offset:0
    ds_read_b64_tr_b16 v[170:171], v47 offset:1024
    ds_read_b64_tr_b16 v[172:173], v47 offset:8192
    ds_read_b64_tr_b16 v[174:175], v47 offset:9216
    ds_read_b64_tr_b16 v[232:233], v44 offset:0
    ds_read_b64_tr_b16 v[234:235], v44 offset:1024
    ds_read_b64_tr_b16 v[236:237], v44 offset:8192
    ds_read_b64_tr_b16 v[238:239], v44 offset:9216
    s_branch Lwd_94
Lwv_96:
    s_cmp_lg_u32 s34, 2
    s_cbranch_scc1 Lwv_97
    ds_read_b64_tr_b16 v[152:153], v47 offset:0
    ds_read_b64_tr_b16 v[154:155], v47 offset:1024
    ds_read_b64_tr_b16 v[156:157], v47 offset:8192
    ds_read_b64_tr_b16 v[158:159], v47 offset:9216
    ds_read_b64_tr_b16 v[216:217], v44 offset:0
    ds_read_b64_tr_b16 v[218:219], v44 offset:1024
    ds_read_b64_tr_b16 v[220:221], v44 offset:8192
    ds_read_b64_tr_b16 v[222:223], v44 offset:9216
    s_branch Lwd_94
Lwv_97:
    ds_read_b64_tr_b16 v[136:137], v47 offset:0
    ds_read_b64_tr_b16 v[138:139], v47 offset:1024
    ds_read_b64_tr_b16 v[140:141], v47 offset:8192
    ds_read_b64_tr_b16 v[142:143], v47 offset:9216
    ds_read_b64_tr_b16 v[200:201], v44 offset:0
    ds_read_b64_tr_b16 v[202:203], v44 offset:1024
    ds_read_b64_tr_b16 v[204:205], v44 offset:8192
    ds_read_b64_tr_b16 v[206:207], v44 offset:9216
Lwd_94:
    s_waitcnt lgkmcnt(0)
    s_barrier
    ds_write_b128 v7, v[48:51] offset:16384
    ds_write_b128 v7, v[52:55] offset:16896
    ds_write_b128 v7, v[56:59] offset:17408
    ds_write_b128 v7, v[60:63] offset:17920
    ds_write_b128 v7, v[64:67] offset:18432
    ds_write_b128 v7, v[68:71] offset:18944
    ds_write_b128 v7, v[72:75] offset:19456
    ds_write_b128 v7, v[76:79] offset:19968
    ds_write_b128 v7, v[80:83] offset:20480
    ds_write_b128 v7, v[84:87] offset:20992
    ds_write_b128 v7, v[88:91] offset:21504
    ds_write_b128 v7, v[92:95] offset:22016
    ds_write_b128 v7, v[96:99] offset:22528
    ds_write_b128 v7, v[100:103] offset:23040
    ds_write_b128 v7, v[104:107] offset:23552
    ds_write_b128 v7, v[108:111] offset:24064
    s_waitcnt lgkmcnt(0)
    v_mov_b32 v41, 32
    s_cmp_lg_u32 s34, 0
    s_cbranch_scc1 Liwd_99
Liw_98:
    global_load_dword v40, v41, s[30:31] sc1
    s_waitcnt vmcnt(0)
    v_readfirstlane_b32 s36, v40
    s_cmp_ge_u32 s36, 32
    s_cbranch_scc1 Liwd_99
    s_sleep 2
    s_add_u32 s101, s101, 1
    s_cmp_gt_u32 s101, 0x40000
    s_cbranch_scc1 L_end
    s_branch Liw_98
Liwd_99:
    s_and_b32 s37, s32, 4
    s_lshl_b32 s37, s37, 5
    s_and_b32 s36, s32, 3
    s_lshl_b32 s36, s36, 2
    s_add_u32 s37, s37, s36
    s_and_b32 s36, s32, 8
    s_lshl_b32 s36, s36, 1
    s_add_u32 s37, s37, s36
    v_mov_b32 v41, s37
    s_barrier
    global_load_dword v40, v41, s[30:31] sc1
    s_waitcnt vmcnt(0)
    v_readfirstlane_b32 s37, v40
    s_cmp_lt_u32 s37, 32
    s_cselect_b32 s35, 1, 0
    v_mov_b64 v[44:45], -1
    v_mov_b64 v[46:47], -1
    s_lshl_b32 s40, s33, 13
    s_add_u32 s41, s40, 0xae00000
    s_add_u32 s42, s4, s41
    s_addc_u32 s43, s5, 0
    global_store_dwordx4 v3, v[44:47], s[42:43] sc1
    s_add_u32 s41, s40, 0xbe00000
    s_add_u32 s42, s4, s41
    s_addc_u32 s43, s5, 0
    global_store_dwordx4 v3, v[44:47], s[42:43] sc1
    s_add_u32 s41, s40, 0xae40000
    s_add_u32 s42, s4, s41
    s_addc_u32 s43, s5, 0
    global_store_dwordx4 v3, v[44:47], s[42:43] sc1
    s_add_u32 s41, s40, 0xbe40000
    s_add_u32 s42, s4, s41
    s_addc_u32 s43, s5, 0
    global_store_dwordx4 v3, v[44:47], s[42:43] sc1
    s_add_u32 s41, s40, 0xae80000
    s_add_u32 s42, s4, s41
    s_addc_u32 s43, s5, 0
    global_store_dwordx4 v3, v[44:47], s[42:43] sc1
    s_add_u32 s41, s40, 0xbe80000
    s_add_u32 s42, s4, s41
    s_addc_u32 s43, s5, 0
    global_store_dwordx4 v3, v[44:47], s[42:43] sc1
    s_add_u32 s41, s40, 0xaec0000
    s_add_u32 s42, s4, s41
    s_addc_u32 s43, s5, 0
    global_store_dwordx4 v3, v[44:47], s[42:43] sc1
    s_add_u32 s41, s40, 0xbec0000
    s_add_u32 s42, s4, s41
    s_addc_u32 s43, s5, 0
    global_store_dwordx4 v3, v[44:47], s[42:43] sc1
    s_add_u32 s41, s40, 0xaf00000
    s_add_u32 s42, s4, s41
    s_addc_u32 s43, s5, 0
    global_store_dwordx4 v3, v[44:47], s[42:43] sc1
    s_add_u32 s41, s40, 0xbf00000
    s_add_u32 s42, s4, s41
    s_addc_u32 s43, s5, 0
    global_store_dwordx4 v3, v[44:47], s[42:43] sc1
    s_add_u32 s41, s40, 0xaf40000
    s_add_u32 s42, s4, s41
    s_addc_u32 s43, s5, 0
    global_store_dwordx4 v3, v[44:47], s[42:43] sc1
    s_add_u32 s41, s40, 0xbf40000
    s_add_u32 s42, s4, s41
    s_addc_u32 s43, s5, 0
    global_store_dwordx4 v3, v[44:47], s[42:43] sc1
    s_add_u32 s41, s40, 0xaf80000
    s_add_u32 s42, s4, s41
    s_addc_u32 s43, s5, 0
    global_store_dwordx4 v3, v[44:47], s[42:43] sc1
    s_add_u32 s41, s40, 0xbf80000
    s_add_u32 s42, s4, s41
    s_addc_u32 s43, s5, 0
    global_store_dwordx4 v3, v[44:47], s[42:43] sc1
    s_add_u32 s41, s40, 0xafc0000
    s_add_u32 s42, s4, s41
    s_addc_u32 s43, s5, 0
    global_store_dwordx4 v3, v[44:47], s[42:43] sc1
    s_add_u32 s41, s40, 0xbfc0000
    s_add_u32 s42, s4, s41
    s_addc_u32 s43, s5, 0
    global_store_dwordx4 v3, v[44:47], s[42:43] sc1
    s_add_u32 s41, s40, 0xb000000
    s_add_u32 s42, s4, s41
    s_addc_u32 s43, s5, 0
    global_store_dwordx4 v3, v[44:47], s[42:43] sc1
    s_add_u32 s41, s40, 0xc000000
    s_add_u32 s42, s4, s41
    s_addc_u32 s43, s5, 0
    global_store_dwordx4 v3, v[44:47], s[42:43] sc1
    s_nop 1
L_ch_layer:
    s_mov_b32 s49, 0
    s_mov_b64 s[52:53], 0
    s_lshl_b32 s40, s48, 5
    s_add_u32 s40, s40, s33
    s_lshl_b32 s40, s40, 8
    s_add_u32 s41, s40, 0x10000
    s_add_u32 s72, s4, s41
    s_addc_u32 s73, s5, 0
    s_add_u32 s41, s40, 0x13ff4
    s_add_u32 s70, s4, s41
    s_addc_u32 s71, s5, 0
    s_lshl_b32 s40, s48, 11
    s_add_u32 s40, s40, s33
    s_lshl_b32 s40, s40, 13
    s_add_u32 s41, s40, 0x4000000
    s_add_u32 s64, s4, s41
    s_addc_u32 s65, s5, 0
    s_add_u32 s41, s40, 0x6000000
    s_add_u32 s66, s4, s41
    s_addc_u32 s67, s5, 0
    s_add_u32 s41, s40, 0x9fc0000
    s_add_u32 s68, s4, s41
    s_addc_u32 s69, s5, 0
    v_bfe_u32 v27, v2, 4, 2
    v_bfe_u32 v28, v2, 2, 1
    v_lshl_add_u32 v27, v27, 1, v28
    v_lshlrev_b32 v27, 10, v27
    v_bfe_u32 v28, v2, 3, 1
    v_lshl_add_u32 v27, v28, 2, v27
    v_bfe_u32 v28, v2, 6, 2
    v_lshl_add_u32 v27, v28, 5, v27
    v_mov_b32 v0, 0
    s_lshl_b32 s40, s34, 8
    v_add_u32 v27, s40, v27
    global_load_dword v40, v27, s[16:17] offset:0
    global_load_dword v41, v27, s[16:17] offset:8
    global_load_dword v42, v27, s[16:17] offset:16
    global_load_dword v43, v27, s[16:17] offset:24
    global_load_dword v44, v27, s[16:17] offset:128
    global_load_dword v45, v27, s[16:17] offset:136
    global_load_dword v46, v27, s[16:17] offset:144
    global_load_dword v47, v27, s[16:17] offset:152
Lpt_100:
    global_load_dwordx4 v[96:99], v3, s[64:65] offset:0 sc1
    global_load_dwordx4 v[100:103], v3, s[64:65] offset:1024 sc1
    global_load_dwordx4 v[104:107], v3, s[66:67] offset:0 sc1
    global_load_dwordx4 v[108:111], v3, s[66:67] offset:1024 sc1
    s_add_u32 s101, s101, 1
    s_cmp_gt_u32 s101, 0x40000
    s_cbranch_scc1 L_end
    s_waitcnt vmcnt(0)
    v_max_u32 v28, v96, v100
    v_max3_u32 v28, v28, v104, v108
    v_cmp_eq_u32 vcc, -1, v28
    s_cbranch_vccnz Lpt_100
    ds_write_b128 v3, v[96:99] offset:0
    ds_write_b128 v3, v[100:103] offset:1024
    ds_write_b128 v3, v[104:107] offset:8192
    ds_write_b128 v3, v[108:111] offset:9216
    s_waitcnt lgkmcnt(0)
    v_mov_b64 v[72:73], 0
    v_mov_b64 v[74:75], 0
    v_mov_b64 v[76:77], 0
    v_mov_b64 v[78:79], 0
    v_mov_b64 v[80:81], 0
    v_mov_b64 v[82:83], 0
    v_mov_b64 v[84:85], 0
    v_mov_b64 v[86:87], 0
    v_mov_b64 v[88:89], 0
    v_mov_b64 v[90:91], 0
    v_mov_b64 v[92:93], 0
    v_mov_b64 v[94:95], 0
    s_add_u32 s64, s64, 0x40000
    s_addc_u32 s65, s65, 0
    s_add_u32 s66, s66, 0x40000
    s_addc_u32 s67, s67, 0
    s_add_u32 s68, s68, 0x40000
    s_addc_u32 s69, s69, 0
    s_add_u32 s70, s70, 0x4
    s_addc_u32 s71, s71, 0
    s_and_b32 s40, s50, 0
    v_mov_b32 v13, s50
    s_lshl_b32 s40, s40, 18
    s_add_u32 s41, s40, 0x100000
    s_add_u32 s54, s4, s41
    s_addc_u32 s55, s5, 0
    s_add_u32 s56, s54, 0x8000
    s_addc_u32 s57, s55, 0
    s_lshl_b32 s42, s33, 13
    s_add_u32 s74, s54, s42
    s_addc_u32 s75, s55, 0
    s_add_u32 s78, s74, 0x1000
    s_addc_u32 s79, s75, 0
    s_xor_b32 s41, s41, 0x40000
    s_add_u32 s41, s41, s42
    s_add_u32 s62, s4, s41
    s_addc_u32 s63, s5, 0
    v_xor_b32 v24, 2048, v3
    v_xor_b32 v25, 4096, v3
    v_xor_b32 v26, 6144, v3
    ds_read_b128 v[48:51], v7 offset:16384
    ds_read_b128 v[52:55], v7 offset:16896
    ds_read_b128 v[56:59], v7 offset:20480
    ds_read_b128 v[60:63], v7 offset:20992
    ds_read_b128 v[64:67], v7 offset:18432
    ds_read_b128 v[68:71], v7 offset:18944
    ds_read_b128 v[96:99], v7 offset:22528
    ds_read_b128 v[100:103], v7 offset:23040
    ds_read_b128 v[104:107], v7 offset:17408
    ds_read_b128 v[108:111], v7 offset:17920
    ds_read_b128 v[112:115], v7 offset:21504
    ds_read_b128 v[116:119], v7 offset:22016
    ds_read_b128 v[120:123], v7 offset:19456
    ds_read_b128 v[124:127], v7 offset:19968
    ds_read_b128 v[32:35], v7 offset:23552
    ds_read_b128 v[36:39], v7 offset:24064
    s_waitcnt vmcnt(0)
    ds_write_b128 v3, v[40:43] offset:16384
    ds_write_b128 v3, v[44:47] offset:17408
    s_waitcnt lgkmcnt(2)
    s_branch L_ch_step
.p2align 6
L_ch_retryA:
    global_load_dwordx4 v[40:43], v3, s[58:59] sc1
    global_load_dwordx4 v[44:47], v3, s[58:59] offset:1024 sc1
    s_add_u32 s101, s101, 1
    s_cmp_gt_u32 s101, 0x40000
    s_cbranch_scc1 L_end
L_ch_pollA:
    s_waitcnt vmcnt(2) lgkmcnt(0)
    v_max_u32 v27, v40, v44
    v_cmp_eq_u32 vcc, -1, v27
    ds_write_b128 v3, v[40:43] offset:16384
    ds_write_b128 v3, v[44:47] offset:17408
    s_cbranch_vccnz L_ch_retryA
L_ch_step:
    v_smfmac_f32_16x16x64_bf16 v[72:75], v[40:43], v[48:55], v10
    v_smfmac_f32_16x16x64_bf16 v[76:79], v[40:43], v[56:63], v10
    v_smfmac_f32_16x16x64_bf16 v[80:83], v[40:43], v[64:71], v10
    v_smfmac_f32_16x16x64_bf16 v[84:87], v[40:43], v[96:103], v10
    s_waitcnt lgkmcnt(0)
    s_barrier
    ds_read_b128 v[48:51], v24 offset:16384
    ds_read_b128 v[52:55], v24 offset:17408
    v_smfmac_f32_16x16x64_bf16 v[72:75], v[44:47], v[104:111], v10
    ds_read_b128 v[56:59], v25 offset:16384
    v_smfmac_f32_16x16x64_bf16 v[76:79], v[44:47], v[112:119], v10
    ds_read_b128 v[60:63], v25 offset:17408
    v_smfmac_f32_16x16x64_bf16 v[80:83], v[44:47], v[120:127], v10
    ds_read_b128 v[64:67], v26 offset:16384
    v_smfmac_f32_16x16x64_bf16 v[84:87], v[44:47], v[32:39], v10
    ds_read_b128 v[68:71], v26 offset:17408
    v_smfmac_f32_16x16x64_bf16 v[88:91], v[40:43], v[128:135], v10
    v_smfmac_f32_16x16x64_bf16 v[92:95], v[40:43], v[192:199], v10
    v_smfmac_f32_16x16x64_bf16 v[88:91], v[44:47], v[136:143], v10
    v_smfmac_f32_16x16x64_bf16 v[92:95], v[44:47], v[200:207], v10
    s_waitcnt vmcnt(0)
    s_waitcnt lgkmcnt(5)
    v_smfmac_f32_16x16x64_bf16 v[72:75], v[48:51], a[0:7], v10
    global_store_dwordx4 v3, v[16:19], s[68:69] sc1
    v_smfmac_f32_16x16x64_bf16 v[76:79], v[48:51], a[96:103], v10
    s_waitcnt lgkmcnt(4)
    v_smfmac_f32_16x16x64_bf16 v[72:75], v[52:55], a[8:15], v10
    s_cmp_lt_u32 s49, s76
    s_cbranch_scc0 L_ch_flag
L_ch_noflag:
    v_smfmac_f32_16x16x64_bf16 v[76:79], v[52:55], a[104:111], v10
    s_waitcnt lgkmcnt(3)
    v_smfmac_f32_16x16x64_bf16 v[72:75], v[56:59], a[16:23], v10
    ds_read_b128 v[112:115], v1 offset:0
    v_smfmac_f32_16x16x64_bf16 v[76:79], v[56:59], a[112:119], v10
    ds_read_b128 v[116:119], v1 offset:1024
    s_waitcnt lgkmcnt(4)
    v_smfmac_f32_16x16x64_bf16 v[72:75], v[60:63], a[24:31], v10
    ds_read_b128 v[120:123], v1 offset:2048
    v_smfmac_f32_16x16x64_bf16 v[76:79], v[60:63], a[120:127], v10
    ds_read_b128 v[124:127], v1 offset:3072
    s_waitcnt lgkmcnt(5)
    v_smfmac_f32_16x16x64_bf16 v[72:75], v[64:67], a[32:39], v10
    ds_read_b128 v[24:27], v1 offset:4096
    v_smfmac_f32_16x16x64_bf16 v[76:79], v[64:67], a[128:135], v10
    ds_read_b128 v[28:31], v1 offset:5120
    s_waitcnt lgkmcnt(6)
    v_smfmac_f32_16x16x64_bf16 v[72:75], v[68:71], a[40:47], v10
    ds_read_b128 v[32:35], v1 offset:6144
    v_smfmac_f32_16x16x64_bf16 v[76:79], v[68:71], a[136:143], v10
    ds_read_b128 v[36:39], v1 offset:7168
    v_smfmac_f32_16x16x64_bf16 v[80:83], v[48:51], a[48:55], v10
    s_add_u32 s41, s49, 1
    s_nop 1
    v_smfmac_f32_16x16x64_bf16 v[80:83], v[52:55], a[56:63], v10
    v_cmp_ne_u32 vcc, 0, v0
    s_or_b64 s[52:53], s[52:53], vcc
    v_smfmac_f32_16x16x64_bf16 v[80:83], v[56:59], a[64:71], v10
    v_add_f32 v72, v72, v74
    v_smfmac_f32_16x16x64_bf16 v[80:83], v[60:63], a[72:79], v10
Lkvo_102:
    s_bitcmp0_b64 s[52:53], s41
    s_cbranch_scc1 Lkvp_101
    v_add_f32 v73, v73, v75
    v_smfmac_f32_16x16x64_bf16 v[80:83], v[64:67], a[80:87], v10
    v_add_f32 v76, v76, v78
    v_smfmac_f32_16x16x64_bf16 v[80:83], v[68:71], a[88:95], v10
    v_add_f32 v77, v77, v79
    v_smfmac_f32_16x16x64_bf16 v[84:87], v[48:51], a[144:151], v10
    v_cvt_pk_bf16_f32 v79, v72, v73
    v_smfmac_f32_16x16x64_bf16 v[84:87], v[52:55], a[152:159], v10
    v_cvt_pk_bf16_f32 v78, v76, v77
    v_smfmac_f32_16x16x64_bf16 v[84:87], v[56:59], a[160:167], v10
    ds_write_b64 v5, v[78:79] offset:24576
    v_min_u32 v16, -2, v78
    v_smfmac_f32_16x16x64_bf16 v[84:87], v[60:63], a[168:175], v10
    ds_read_b128 v[72:75], v3 offset:8192
    v_add_f32 v80, v80, v82
    v_smfmac_f32_16x16x64_bf16 v[84:87], v[64:67], a[176:183], v10
    ds_read_b128 v[76:79], v3 offset:9216
    v_add_f32 v81, v81, v83
    v_smfmac_f32_16x16x64_bf16 v[84:87], v[68:71], a[184:191], v10
    v_cvt_pk_bf16_f32 v83, v80, v81
    v_smfmac_f32_16x16x64_bf16 v[88:91], v[48:51], v[144:151], v10
    s_nop 2
    v_smfmac_f32_16x16x64_bf16 v[92:95], v[48:51], v[208:215], v10
    s_nop 2
    v_add_f32 v84, v84, v86
    v_add_f32 v85, v85, v87
    v_cvt_pk_bf16_f32 v82, v84, v85
    ds_write_b64 v5, v[82:83] offset:25088
    v_smfmac_f32_16x16x64_bf16 v[88:91], v[52:55], v[152:159], v10
    v_mov_b32 v17, v82
    v_smfmac_f32_16x16x64_bf16 v[92:95], v[52:55], v[216:223], v10
    v_smfmac_f32_16x16x64_bf16 v[88:91], v[56:59], v[160:167], v10
    v_smfmac_f32_16x16x64_bf16 v[92:95], v[56:59], v[224:231], v10
    v_smfmac_f32_16x16x64_bf16 v[88:91], v[60:63], v[168:175], v10
    s_waitcnt lgkmcnt(0)
    s_barrier
    ds_read_b64_tr_b16 v[96:97], v4 offset:24576
    ds_read_b64_tr_b16 v[98:99], v4 offset:25088
    v_smfmac_f32_16x16x64_bf16 v[92:95], v[60:63], v[232:239], v10
    s_cmp_eq_u32 s49, 63
    s_cbranch_scc1 L_ch_last
    ds_read_b64_tr_b16 v[100:101], v4 offset:25600
    ds_read_b64_tr_b16 v[102:103], v4 offset:26112
    s_mov_b32 m0, s77
    s_nop 0
    global_load_lds_dwordx4 v3, s[64:65] sc1
    v_smfmac_f32_16x16x64_bf16 v[88:91], v[64:67], v[176:183], v10
    ds_read_b64_tr_b16 v[104:105], v4 offset:26624
    global_load_lds_dwordx4 v3, s[64:65] offset:1024 sc1
    s_mov_b32 m0, s51
    v_smfmac_f32_16x16x64_bf16 v[92:95], v[64:67], v[240:247], v10
    ds_read_b64_tr_b16 v[106:107], v4 offset:27136
    global_load_lds_dwordx4 v3, s[66:67] sc1
    v_smfmac_f32_16x16x64_bf16 v[88:91], v[68:71], v[184:191], v10
    ds_read_b64_tr_b16 v[108:109], v4 offset:27648
    global_load_lds_dwordx4 v3, s[66:67] offset:1024 sc1
    v_smfmac_f32_16x16x64_bf16 v[92:95], v[68:71], v[248:255], v10
    ds_read_b64_tr_b16 v[110:111], v4 offset:28160
    s_waitcnt lgkmcnt(6)
    v_mfma_f32_16x16x32_bf16 v[40:43], v[112:115], v[96:99], 0
    ds_read_b128 v[80:83], v7 offset:0
    v_mfma_f32_16x16x32_bf16 v[44:47], v[24:27], v[96:99], 0
    ds_read_b128 v[84:87], v7 offset:512
    v_mfma_f32_16x16x32_bf16 v[48:51], v[96:99], v[96:99], 0
    s_waitcnt lgkmcnt(6)
    v_mfma_f32_16x16x32_bf16 v[40:43], v[116:119], v[100:103], v[40:43]
    ds_read_b128 v[56:59], v7 offset:1024
    v_mfma_f32_16x16x32_bf16 v[44:47], v[28:31], v[100:103], v[44:47]
    ds_read_b128 v[60:63], v7 offset:1536
    v_mfma_f32_16x16x32_bf16 v[48:51], v[100:103], v[100:103], v[48:51]
    v_add_f32 v88, v88, v90
    s_waitcnt lgkmcnt(6)
    v_mfma_f32_16x16x32_bf16 v[40:43], v[120:123], v[104:107], v[40:43]
    ds_read_b128 v[64:67], v7 offset:2048
    v_add_f32 v89, v89, v91
    v_mfma_f32_16x16x32_bf16 v[44:47], v[32:35], v[104:107], v[44:47]
    ds_read_b128 v[68:71], v7 offset:2560
    v_add_f32 v92, v92, v94
    v_mfma_f32_16x16x32_bf16 v[48:51], v[104:107], v[104:107], v[48:51]
    v_add_f32 v93, v93, v95
    s_waitcnt lgkmcnt(6)
    v_mfma_f32_16x16x32_bf16 v[40:43], v[124:127], v[108:111], v[40:43]
    v_cvt_pk_bf16_f32 v18, v88, v89
    v_mfma_f32_16x16x32_bf16 v[44:47], v[36:39], v[108:111], v[44:47]
    v_cvt_pk_bf16_f32 v19, v92, v93
    v_min_u32 v18, -2, v18
    v_mfma_f32_16x16x32_bf16 v[48:51], v[108:111], v[108:111], v[48:51]
    s_nop 0
    global_load_dword v0, v2, s[72:73] sc1
    v_mov_b32 v100, 0x3f803f80
    v_mov_b32 v101, 0x3f803f80
    v_max3_f32 v52, v40, v41, v42
    v_mov_b32 v102, 0x3f803f80
    v_max3_f32 v53, v43, v44, v45
    v_max3_f32 v52, v52, v46, v47
    v_max3_f32 v53, v53, v48, v49
    v_max_f32 v54, v52, v53
    v_max_f32 v55, v52, v53
    v_mov_b32 v103, 0x3f803f80
    s_add_u32 s40, s50, 1
    v_permlane32_swap_b32 v54, v55
    v_max_f32 v52, v54, v55
    v_max_f32 v53, v54, v55
    s_and_b32 s40, s40, 3
    s_lshl_b32 s40, s40, 13
    v_permlane16_swap_b32 v52, v53
    v_max_f32 v52, v52, v53
    v_mul_f32 v52, s96, v52
    v_pk_fma_f32 v[48:49], v[48:49], s[96:97], v[52:53] op_sel_hi:[1,0,0] neg_lo:[0,0,1] neg_hi:[0,0,1]
    v_pk_fma_f32 v[40:41], v[40:41], s[96:97], v[52:53] op_sel_hi:[1,0,0] neg_lo:[0,0,1] neg_hi:[0,0,1]
    v_pk_fma_f32 v[42:43], v[42:43], s[96:97], v[52:53] op_sel_hi:[1,0,0] neg_lo:[0,0,1] neg_hi:[0,0,1]
    v_exp_f32 v48, v48
    v_exp_f32 v49, v49
    v_pk_fma_f32 v[44:45], v[44:45], s[96:97], v[52:53] op_sel_hi:[1,0,0] neg_lo:[0,0,1] neg_hi:[0,0,1]
    v_pk_fma_f32 v[46:47], v[46:47], s[96:97], v[52:53] op_sel_hi:[1,0,0] neg_lo:[0,0,1] neg_hi:[0,0,1]
    v_exp_f32 v40, v40
    v_cvt_pk_bf16_f32 v20, v48, v49
    v_cvt_pk_bf16_f32 v23, v48, v49
    v_exp_f32 v41, v41
    v_exp_f32 v42, v42
    v_mfma_f32_16x16x16_bf16 v[108:111], v[100:101], v[20:21], 0
    ds_read_b128 v[112:115], v7 offset:3072
    v_exp_f32 v43, v43
    v_cvt_pk_bf16_f32 v88, v40, v41
    v_mfma_f32_16x16x16_bf16 v[104:107], v[18:19], v[22:23], 0
    ds_read_b128 v[116:119], v7 offset:3584
    v_exp_f32 v44, v44
    v_cvt_pk_bf16_f32 v89, v42, v43
    v_mfma_f32_16x16x16_bf16 v[92:95], v[18:19], v[20:21], 0
    v_exp_f32 v45, v45
    v_exp_f32 v46, v46
    v_exp_f32 v47, v47
    v_cvt_pk_bf16_f32 v90, v44, v45
    v_cvt_pk_bf16_f32 v91, v46, v47
    s_add_u32 s40, s40, 0x180000
    v_mov_b32 v40, 0
    v_mfma_f32_16x16x32_bf16 v[108:111], v[100:103], v[88:91], v[108:111]
    ds_read_b128 v[120:123], v7 offset:4096
    v_mov_b32 v41, 0
    v_mfma_f32_16x16x32_bf16 v[104:107], v[76:79], v[88:91], v[104:107]
    ds_read_b128 v[124:127], v7 offset:4608
    v_mov_b32 v42, 0
    v_mfma_f32_16x16x32_bf16 v[92:95], v[72:75], v[88:91], v[92:95]
    v_mov_b32 v43, 0
    s_add_u32 s58, s4, s40
    s_addc_u32 s59, s5, 0
    v_mov_b64 v[44:45], 0
    v_mov_b64 v[46:47], 0
    v_rcp_f32 v108, v108
    v_mov_b64 v[48:49], 0
    v_pk_mul_f32 v[104:105], v[104:105], v[108:109] op_sel_hi:[1,0]
    v_pk_mul_f32 v[106:107], v[106:107], v[108:109] op_sel_hi:[1,0]
    v_mov_b64 v[50:51], 0
    v_pk_mul_f32 v[92:93], v[92:93], v[108:109] op_sel_hi:[1,0]
    v_pk_mul_f32 v[94:95], v[94:95], v[108:109] op_sel_hi:[1,0]
    v_cvt_pk_bf16_f32 v54, v104, v105
    v_cvt_pk_bf16_f32 v55, v106, v107
    v_cvt_pk_bf16_f32 v52, v92, v93
    v_cvt_pk_bf16_f32 v53, v94, v95
    ds_write_b128 v6, v[52:55]
    v_mov_b64 v[72:73], 0
    v_mov_b64 v[74:75], 0
    v_mov_b64 v[76:77], 0
    v_mov_b64 v[78:79], 0
    v_mov_b64 v[88:89], 0
    v_mov_b64 v[90:91], 0
    v_mov_b64 v[92:93], 0
    v_mov_b64 v[94:95], 0
    s_waitcnt lgkmcnt(0)
    s_barrier
    ds_read_b128 v[104:107], v1 offset:28672
    ds_read_b128 v[108:111], v1 offset:29696
    v_mov_b64 v[52:53], 0
    v_mov_b64 v[54:55], 0
    s_and_b32 s40, s50, 3
    s_lshl_b32 s40, s40, 13
    s_add_u32 s40, s40, 0x180000
    s_cmp_lg_u32 s35, 0
    s_waitcnt lgkmcnt(1)
    v_smfmac_f32_16x16x64_bf16 v[40:43], v[104:107], a[192:199], v10
    ds_read_b128 v[24:27], v7 offset:5120
    s_waitcnt lgkmcnt(1)
    v_smfmac_f32_16x16x64_bf16 v[40:43], v[108:111], a[224:231], v10
    ds_read_b128 v[28:31], v7 offset:5632
    v_smfmac_f32_16x16x64_bf16 v[44:47], v[104:107], a[200:207], v10
    ds_read_b128 v[32:35], v7 offset:6144
    v_smfmac_f32_16x16x64_bf16 v[44:47], v[108:111], a[232:239], v10
    ds_read_b128 v[36:39], v7 offset:6656
    s_nop 0
    v_smfmac_f32_16x16x64_bf16 v[48:51], v[104:107], a[208:215], v10
    ds_read_b128 v[96:99], v7 offset:7168
    v_add_f32 v40, v40, v42
    v_smfmac_f32_16x16x64_bf16 v[48:51], v[108:111], a[240:247], v10
    ds_read_b128 v[100:103], v7 offset:7680
    v_add_f32 v41, v41, v43
    v_smfmac_f32_16x16x64_bf16 v[52:55], v[104:107], a[216:223], v10
    v_add_f32 v44, v44, v46
    v_smfmac_f32_16x16x64_bf16 v[52:55], v[108:111], a[248:255], v10
    v_add_f32 v45, v45, v47
    v_smfmac_f32_16x16x64_bf16 v[72:75], v[104:107], v[80:87], v10
    v_cvt_pk_bf16_f32 v42, v40, v44
    v_add_f32 v48, v48, v50
    v_smfmac_f32_16x16x64_bf16 v[72:75], v[108:111], v[56:63], v10
    v_cvt_pk_bf16_f32 v43, v41, v45
    v_add_f32 v49, v49, v51
    v_smfmac_f32_16x16x64_bf16 v[76:79], v[104:107], v[64:71], v10
    s_nop 0
    v_add_f32 v52, v52, v54
    v_smfmac_f32_16x16x64_bf16 v[76:79], v[108:111], v[112:119], v10
    v_add_f32 v53, v53, v55
    v_cvt_pk_bf16_f32 v40, v48, v52
    v_smfmac_f32_16x16x64_bf16 v[88:91], v[104:107], v[120:127], v10
    v_cvt_pk_bf16_f32 v41, v49, v53
    v_bfi_b32 v40, 1, v13, v40
    s_cbranch_scc1 Lmx_103
    global_store_dwordx4 v8, v[40:43], s[54:55]
Lmy_104:
    s_waitcnt lgkmcnt(4)
    v_smfmac_f32_16x16x64_bf16 v[88:91], v[108:111], v[24:31], v10
    v_add_f32 v72, v72, v74
    s_waitcnt lgkmcnt(2)
    v_smfmac_f32_16x16x64_bf16 v[92:95], v[104:107], v[32:39], v10
    v_add_f32 v73, v73, v75
    v_add_f32 v76, v76, v78
    s_waitcnt lgkmcnt(0)
    v_smfmac_f32_16x16x64_bf16 v[92:95], v[108:111], v[96:103], v10
    v_add_f32 v77, v77, v79
    v_cvt_pk_bf16_f32 v74, v72, v76
    v_cvt_pk_bf16_f32 v75, v73, v77
    v_add_f32 v88, v88, v90
    v_add_f32 v89, v89, v91
    s_nop 3
    v_add_f32 v92, v92, v94
    v_add_f32 v93, v93, v95
    v_cvt_pk_bf16_f32 v72, v88, v92
    v_cvt_pk_bf16_f32 v73, v89, v93
    v_bfi_b32 v72, 1, v13, v72
    s_cbranch_scc1 Lmx_105
    global_store_dwordx4 v8, v[72:75], s[56:57]
Lmy_106:
    s_add_u32 s60, s4, s40
    s_addc_u32 s61, s5, 0
    s_add_u32 s49, s49, 1
    s_add_u32 s50, s50, 1
    v_mov_b64 v[76:77], 0
    v_mov_b64 v[78:79], 0
    v_mov_b64 v[92:93], 0
    v_mov_b64 v[94:95], 0
    s_cmp_lg_u32 s34, 0
    s_cbranch_scc1 L_ch_nored
    v_cndmask_b32 v88, 0, v12, s[88:89]
    v_cndmask_b32 v89, 0, v12, s[90:91]
    v_cndmask_b32 v90, 0, v12, s[92:93]
    v_cndmask_b32 v91, 0, v12, s[94:95]
    v_xor_b32 v24, 2048, v3
    v_xor_b32 v25, 4096, v3
    v_xor_b32 v26, 6144, v3
    ds_read_b128 v[48:51], v7 offset:16384
    ds_read_b128 v[52:55], v7 offset:16896
    ds_read_b128 v[56:59], v7 offset:20480
    ds_read_b128 v[60:63], v7 offset:20992
    ds_read_b128 v[64:67], v7 offset:18432
    ds_read_b128 v[68:71], v7 offset:18944
    ds_read_b128 v[32:35], v7 offset:23552
    ds_read_b128 v[36:39], v7 offset:24064
    s_nop 15
    s_nop 15
    s_nop 15
    s_nop 1
L_ch_rB:
    global_load_dwordx4 v[96:99], v1, s[74:75] offset:0 sc1
    global_load_dwordx4 v[100:103], v1, s[74:75] offset:1024 sc1
    global_load_dwordx4 v[104:107], v1, s[74:75] offset:2048 sc1
    global_load_dwordx4 v[108:111], v1, s[74:75] offset:3072 sc1
    global_load_dwordx4 v[112:115], v1, s[78:79] offset:0 sc1
    global_load_dwordx4 v[116:119], v1, s[78:79] offset:1024 sc1
    global_load_dwordx4 v[120:123], v1, s[78:79] offset:2048 sc1
    global_load_dwordx4 v[124:127], v1, s[78:79] offset:3072 sc1
    s_add_u32 s101, s101, 1
    s_cmp_gt_u32 s101, 0x40000
    s_cbranch_scc1 L_end
    s_cmp_lg_u32 s35, 0
    s_waitcnt vmcnt(7)
    v_bitop3_b32 v84, v96, v13, 1 bitop3:0x28
    v_cmp_ne_u32 vcc, 0, v84
    v_mfma_f32_16x16x32_bf16 v[80:83], v[88:91], v[96:99], 0
    s_cbranch_vccnz L_ch_rB
    s_waitcnt vmcnt(6)
    v_mfma_f32_16x16x32_bf16 v[80:83], v[88:91], v[100:103], v[80:83]
    v_bitop3_b32 v84, v100, v13, v84 bitop3:0xbe
    s_waitcnt vmcnt(5)
    v_mfma_f32_16x16x32_bf16 v[80:83], v[88:91], v[104:107], v[80:83]
    v_bitop3_b32 v84, v104, v13, v84 bitop3:0xbe
    s_waitcnt vmcnt(4)
    v_mfma_f32_16x16x32_bf16 v[80:83], v[88:91], v[108:111], v[80:83]
    v_bitop3_b32 v84, v108, v13, v84 bitop3:0xbe
    s_waitcnt vmcnt(3)
    v_mfma_f32_16x16x32_bf16 v[80:83], v[88:91], v[112:115], v[80:83]
    v_bitop3_b32 v84, v112, v13, v84 bitop3:0xbe
    s_waitcnt vmcnt(2)
    v_mfma_f32_16x16x32_bf16 v[80:83], v[88:91], v[116:119], v[80:83]
    v_bitop3_b32 v84, v116, v13, v84 bitop3:0xbe
    s_waitcnt vmcnt(1)
    v_mfma_f32_16x16x32_bf16 v[80:83], v[88:91], v[120:123], v[80:83]
    v_bitop3_b32 v84, v120, v13, v84 bitop3:0xbe
    s_waitcnt vmcnt(0)
    v_mfma_f32_16x16x32_bf16 v[80:83], v[88:91], v[124:127], v[80:83]
    v_bitop3_b32 v84, v124, v13, v84 bitop3:0xbe
    v_and_b32 v84, 1, v84
    v_cmp_ne_u32 vcc, 0, v84
    s_nop 4
    v_cvt_pk_bf16_f32 v84, v80, v81
    v_min_u32 v84, -2, v84
    s_cbranch_vccnz L_ch_rB
    s_cbranch_scc1 Lmx_107
    global_store_dword v9, v84, s[58:59]
    global_store_dword v9, v11, s[60:61]
Lmy_108:
    s_barrier
    s_add_u32 s64, s64, 0x40000
    s_addc_u32 s65, s65, 0
    s_add_u32 s66, s66, 0x40000
    s_addc_u32 s67, s67, 0
    s_add_u32 s68, s68, 0x40000
    s_addc_u32 s69, s69, 0
    s_add_u32 s70, s70, 0x4
    s_addc_u32 s71, s71, 0
    s_and_b32 s40, s50, 0
    v_mov_b32 v13, s50
    s_lshl_b32 s40, s40, 18
    s_add_u32 s41, s40, 0x100000
    s_add_u32 s54, s4, s41
    s_addc_u32 s55, s5, 0
    s_add_u32 s56, s54, 0x8000
    s_addc_u32 s57, s55, 0
    s_lshl_b32 s42, s33, 13
    s_add_u32 s74, s54, s42
    s_addc_u32 s75, s55, 0
    s_add_u32 s78, s74, 0x1000
    s_addc_u32 s79, s75, 0
    s_xor_b32 s41, s41, 0x40000
    s_add_u32 s41, s41, s42
    s_add_u32 s62, s4, s41
    s_addc_u32 s63, s5, 0
    global_load_dwordx4 v[40:43], v3, s[58:59] sc1
    global_load_dwordx4 v[44:47], v3, s[58:59] offset:1024 sc1
    ds_read_b128 v[96:99], v7 offset:22528
    ds_read_b128 v[100:103], v7 offset:23040
    ds_read_b128 v[104:107], v7 offset:17408
    ds_read_b128 v[108:111], v7 offset:17920
    ds_read_b128 v[112:115], v7 offset:21504
    ds_read_b128 v[116:119], v7 offset:22016
    ds_read_b128 v[120:123], v7 offset:19456
    ds_read_b128 v[124:127], v7 offset:19968
    v_mov_b64 v[72:73], 0
    v_mov_b64 v[74:75], 0
    v_mov_b64 v[80:81], 0
    v_mov_b64 v[82:83], 0
    v_mov_b64 v[84:85], 0
    v_mov_b64 v[86:87], 0
    v_mov_b64 v[88:89], 0
    v_mov_b64 v[90:91], 0
    global_load_dwordx4 v[40:43], v3, s[58:59] sc1
    global_load_dwordx4 v[44:47], v3, s[58:59] offset:1024 sc1
    s_branch L_ch_pollA
L_ch_firstA:
    global_load_dwordx4 v[40:43], v3, s[58:59] sc1
    global_load_dwordx4 v[44:47], v3, s[58:59] offset:1024 sc1
    s_nop 15
    s_nop 3
    global_load_dwordx4 v[40:43], v3, s[58:59] sc1
    global_load_dwordx4 v[44:47], v3, s[58:59] offset:1024 sc1
    s_branch L_ch_pollA
L_ch_nored:
    s_add_u32 s64, s64, 0x40000
    s_addc_u32 s65, s65, 0
    s_add_u32 s66, s66, 0x40000
    s_addc_u32 s67, s67, 0
    s_add_u32 s68, s68, 0x40000
    s_addc_u32 s69, s69, 0
    s_add_u32 s70, s70, 0x4
    s_addc_u32 s71, s71, 0
    s_and_b32 s40, s50, 0
    v_mov_b32 v13, s50
    s_lshl_b32 s40, s40, 18
    s_add_u32 s41, s40, 0x100000
    s_add_u32 s54, s4, s41
    s_addc_u32 s55, s5, 0
    s_add_u32 s56, s54, 0x8000
    s_addc_u32 s57, s55, 0
    s_lshl_b32 s42, s33, 13
    s_add_u32 s74, s54, s42
    s_addc_u32 s75, s55, 0
    s_add_u32 s78, s74, 0x1000
    s_addc_u32 s79, s75, 0
    s_xor_b32 s41, s41, 0x40000
    s_add_u32 s41, s41, s42
    s_add_u32 s62, s4, s41
    s_addc_u32 s63, s5, 0
    v_xor_b32 v24, 2048, v3
    v_xor_b32 v25, 4096, v3
    v_xor_b32 v26, 6144, v3
    ds_read_b128 v[48:51], v7 offset:16384
    ds_read_b128 v[52:55], v7 offset:16896
    ds_read_b128 v[56:59], v7 offset:20480
    ds_read_b128 v[60:63], v7 offset:20992
    ds_read_b128 v[64:67], v7 offset:18432
    ds_read_b128 v[68:71], v7 offset:18944
    ds_read_b128 v[96:99], v7 offset:22528
    ds_read_b128 v[100:103], v7 offset:23040
    ds_read_b128 v[104:107], v7 offset:17408
    ds_read_b128 v[108:111], v7 offset:17920
    ds_read_b128 v[112:115], v7 offset:21504
    ds_read_b128 v[116:119], v7 offset:22016
    ds_read_b128 v[120:123], v7 offset:19456
    ds_read_b128 v[124:127], v7 offset:19968
    ds_read_b128 v[32:35], v7 offset:23552
    ds_read_b128 v[36:39], v7 offset:24064
    v_mov_b64 v[72:73], 0
    v_mov_b64 v[74:75], 0
    v_mov_b64 v[80:81], 0
    v_mov_b64 v[82:83], 0
    v_mov_b64 v[84:85], 0
    v_mov_b64 v[86:87], 0
    v_mov_b64 v[88:89], 0
    v_mov_b64 v[90:91], 0
    s_barrier
    s_nop 15
    s_nop 11
    s_branch L_ch_firstA
L_ch_flag:
    s_mov_b64 exec, 1
    global_store_dword v21, v11, s[70:71] sc1
    s_mov_b64 exec, -1
    s_branch L_ch_noflag
L_ch_last:
    v_smfmac_f32_16x16x64_bf16 v[88:91], v[64:67], v[176:183], v10
    v_smfmac_f32_16x16x64_bf16 v[92:95], v[64:67], v[240:247], v10
    v_smfmac_f32_16x16x64_bf16 v[88:91], v[68:71], v[184:191], v10
    v_smfmac_f32_16x16x64_bf16 v[92:95], v[68:71], v[248:255], v10
    s_add_u32 s68, s68, 0x40000
    s_addc_u32 s69, s69, 0
    s_nop 7
    v_pk_add_f32 v[88:89], v[88:89], v[90:91]
    v_pk_add_f32 v[92:93], v[92:93], v[94:95]
    v_cvt_pk_bf16_f32 v18, v88, v89
    v_cvt_pk_bf16_f32 v19, v92, v93
    v_min_u32 v18, -2, v18
    global_store_dwordx4 v3, v[16:19], s[68:69] sc1
    s_waitcnt lgkmcnt(0)
    s_barrier
    s_add_u32 s48, s48, 1
    s_cmp_lt_u32 s48, 2
    s_cbranch_scc1 L_ch_layer
    s_branch L_end
Lkvp_101:
    global_load_dword v14, v2, s[72:73] sc1
    s_waitcnt vmcnt(0)
    v_cmp_ne_u32 s[52:53], 0, v14
    s_sleep 1
    s_add_u32 s101, s101, 1
    s_cmp_gt_u32 s101, 0x40000
    s_cbranch_scc1 L_end
    s_branch Lkvo_102
Lmx_103:
    global_store_dwordx4 v8, v[40:43], s[54:55] sc1
    s_branch Lmy_104
Lmx_105:
    global_store_dwordx4 v8, v[72:75], s[56:57] sc1
    s_branch Lmy_106
Lmx_107:
    global_store_dword v9, v84, s[58:59] sc1
    global_store_dword v9, v11, s[60:61] sc1
    s_branch Lmy_108
L_p1:
    v_and_b32 v40, 63, v0
    v_and_b32 v41, 15, v0
    v_bfe_u32 v42, v0, 4, 2
    v_lshlrev_b32 v1, 4, v40
    s_lshl_b32 s40, s34, 11
    v_add_u32 v2, s40, v1
    v_mov_b32 v3, v1
    v_and_b32 v43, 15, v0
    v_bfe_u32 v44, v0, 4, 2
    v_add_u32 v45, 0, v44
    v_xor_b32 v45, v45, v43
    v_lshlrev_b32 v45, 4, v45
    v_lshl_add_u32 v10, v43, 10, v45
    v_add_u32 v45, 4, v44
    v_xor_b32 v45, v45, v43
    v_lshlrev_b32 v45, 4, v45
    v_lshl_add_u32 v11, v43, 10, v45
    v_add_u32 v45, 8, v44
    v_xor_b32 v45, v45, v43
    v_lshlrev_b32 v45, 4, v45
    v_lshl_add_u32 v12, v43, 10, v45
    v_add_u32 v45, 12, v44
    v_xor_b32 v45, v45, v43
    v_lshlrev_b32 v45, 4, v45
    v_lshl_add_u32 v13, v43, 10, v45
    s_lshl_b32 s40, s34, 10
    v_add_u32 v4, s40, v1
    v_and_b32 v5, 31, v0
    v_lshlrev_b32 v5, 2, v5
    v_mov_b32 v6, 0
    v_mov_b32 v7, 1
    s_lshl_b32 s37, s32, 5
    s_add_u32 s37, s37, s33
    s_sub_u32 s37, s37, 32
    s_mul_i32 s37, s37, 2048
    v_lshl_add_u32 v52, v0, 4, s37
    v_mov_b64 v[68:69], 0
    v_mov_b64 v[70:71], 0
    s_cmp_ge_u32 s34, 2
    s_cbranch_scc1 Lz_109
    global_store_dwordx4 v52, v[68:71], s[4:5] sc1
Lz_109:
    s_lshl_b32 s37, s32, 5
    s_add_u32 s37, s37, s33
    s_sub_u32 s37, s37, 32
    s_and_b32 s38, s37, 1
    s_lshl_b32 s38, s38, 2
    s_add_u32 s38, s38, s34
    s_min_u32 s38, s38, 6
    s_lshr_b32 s37, s37, 1
    s_lshl_b32 s37, s37, 14
    s_cmp_ge_u32 s38, 5
    s_cselect_b32 s39, 514048, 0
    s_lshl_b32 s38, s38, 11
    s_add_u32 s37, s37, s38
    s_add_u32 s37, s37, s39
    s_add_u32 s37, s37, 0x1000000
    v_and_b32 v60, 63, v0
    v_lshl_add_u32 v60, v60, 4, s37
    v_mov_b64 v[64:65], -1
    v_mov_b64 v[66:67], -1
    global_store_dwordx4 v60, v[64:67], s[4:5] offset:0 sc1
    global_store_dwordx4 v60, v[64:67], s[4:5] offset:1024 sc1
    s_cmp_eq_u32 s34, 3
    s_cbranch_scc1 Lar_110
    s_lshl_b32 s37, s32, 5
    s_add_u32 s37, s37, s33
    s_sub_u32 s37, s37, 32
    s_mul_i32 s37, s37, 3
    s_add_u32 s37, s37, s34
    s_lshr_b32 s38, s37, 6
    s_and_b32 s37, s37, 63
    s_lshl_b32 s37, s37, 10
    s_lshl_b32 s39, s38, 21
    s_add_u32 s39, s39, 0x800000
    s_cmp_eq_u32 s38, 2
    s_cselect_b32 s39, 0xff0000, s39
    s_add_u32 s37, s37, s39
    v_and_b32 v61, 63, v0
    v_lshl_add_u32 v61, v61, 4, s37
    global_store_dwordx4 v61, v[64:67], s[4:5] sc1
Lar_110:
    s_lshl_b32 s37, s32, 5
    s_add_u32 s37, s37, s33
    s_sub_u32 s37, s37, 32
    s_mul_i32 s38, s37, 24576
    s_mul_i32 s39, s34, 6144
    s_add_u32 s38, s38, s39
    s_add_u32 s42, s10, s38
    s_addc_u32 s43, s11, 0
    s_add_u32 s44, s42, 0xc00
    s_addc_u32 s45, s43, 0
    v_and_b32 v53, 63, v0
    v_lshlrev_b32 v54, 4, v53
    s_mov_b32 m0, s39
    s_add_u32 s39, s39, 3072
    global_load_lds_dwordx4 v54, s[42:43] offset:0
    global_load_lds_dwordx4 v54, s[42:43] offset:1024
    global_load_lds_dwordx4 v54, s[42:43] offset:2048
    s_mov_b32 m0, s39
    s_nop 0
    global_load_lds_dwordx4 v54, s[44:45] offset:0
    global_load_lds_dwordx4 v54, s[44:45] offset:1024
    global_load_lds_dwordx4 v54, s[44:45] offset:2048
    v_bfe_u32 v55, v53, 1, 3
    v_lshrrev_b32 v56, 4, v53
    v_and_b32 v57, 1, v53
    v_lshlrev_b32 v57, 4, v57
    v_mul_u32_u24 v58, 3072, v55
    v_lshl_add_u32 v58, v56, 5, v58
    v_add_u32 v58, v58, v57
    s_lshl_b32 s39, s34, 8
    v_add_u32 v58, s39, v58
    v_mul_u32_u24 v59, 49152, v56
    s_and_b32 s39, s37, 1
    s_lshl_b32 s39, s39, 2
    v_xor_b32 v55, s39, v55
    v_lshl_add_u32 v59, v55, 5, v59
    v_add_u32 v59, v59, v57
    s_mul_i32 s38, s37, 768
    s_mul_i32 s39, s34, 393216
    s_add_u32 s38, s38, s39
    s_add_u32 s38, s38, 0x1800000
    s_add_u32 s42, s4, s38
    s_addc_u32 s43, s5, 0
    s_add_u32 s44, s42, 0x30000
    s_addc_u32 s45, s43, 0
    s_waitcnt vmcnt(0)
    s_barrier
    ds_read_b128 v[72:75], v58 offset:0
    ds_read_b128 v[76:79], v58 offset:1024
    ds_read_b128 v[80:83], v58 offset:2048
    ds_read_b128 v[84:87], v58 offset:128
    ds_read_b128 v[88:91], v58 offset:1152
    ds_read_b128 v[92:95], v58 offset:2176
    s_waitcnt lgkmcnt(5)
    global_store_dwordx4 v59, v[72:75], s[42:43] offset:0 sc1
    s_waitcnt lgkmcnt(4)
    global_store_dwordx4 v59, v[76:79], s[42:43] offset:256 sc1
    s_waitcnt lgkmcnt(3)
    global_store_dwordx4 v59, v[80:83], s[42:43] offset:512 sc1
    s_waitcnt lgkmcnt(2)
    global_store_dwordx4 v59, v[84:87], s[44:45] offset:0 sc1
    s_waitcnt lgkmcnt(1)
    global_store_dwordx4 v59, v[88:91], s[44:45] offset:256 sc1
    s_waitcnt lgkmcnt(0)
    global_store_dwordx4 v59, v[92:95], s[44:45] offset:512 sc1
    s_waitcnt vmcnt(0)
    s_barrier
    s_cmp_lg_u32 s34, 0
    s_cbranch_scc1 Larr_111
    s_mov_b32 s37, 96
    v_mov_b32 v40, s37
    v_mov_b32 v41, 1
    s_mov_b64 exec, 1
    global_atomic_add v42, v40, v41, s[30:31] sc0
    s_waitcnt vmcnt(0)
    v_readfirstlane_b32 s36, v42
    s_cmp_lg_u32 s36, 63
    s_cbranch_scc1 Larn_112
    global_store_dword v40, v41, s[30:31] offset:128 sc1
Larn_112:
    s_mov_b64 exec, -1
Larr_111:
    v_mov_b32 v41, 220
    s_cmp_lg_u32 s34, 0
    s_cbranch_scc1 Liwd_114
Liw_113:
    global_load_dword v40, v41, s[30:31] sc1
    s_waitcnt vmcnt(0)
    v_readfirstlane_b32 s36, v40
    s_cmp_ge_u32 s36, 1
    s_cbranch_scc1 Liwd_114
    s_sleep 2
    s_add_u32 s101, s101, 1
    s_cmp_gt_u32 s101, 0x40000
    s_cbranch_scc1 L_end
    s_branch Liw_113
Liwd_114:
    s_barrier
    v_and_b32 v47, 63, v0
    v_lshrrev_b32 v48, 4, v47
    v_bfe_u32 v49, v47, 2, 2
    v_and_b32 v50, 3, v47
    v_and_b32 v52, 15, v47
    s_lshl_b32 s40, s33, 8
    s_lshl_b32 s41, s34, 17
    s_add_u32 s40, s40, s41
    v_lshlrev_b32 v53, 1, v48
    v_xor_b32 v53, v53, v52
    v_lshlrev_b32 v53, 4, v53
    v_lshl_add_u32 v40, v48, 13, v53
    v_add_u32 v40, s40, v40
    v_lshlrev_b32 v53, 1, v48
    v_or_b32 v53, 8, v53
    v_xor_b32 v53, v53, v52
    v_lshlrev_b32 v53, 4, v53
    v_lshl_add_u32 v41, v48, 13, v53
    v_add_u32 v41, s40, v41
    s_lshl_b32 s41, s34, 2
    v_lshrrev_b32 v53, 1, v50
    v_add_u32 v53, s41, v53
    v_and_b32 v54, 1, v48
    v_lshlrev_b32 v54, 3, v54
    v_lshl_add_u32 v54, v49, 1, v54
    v_xor_b32 v53, v53, v54
    v_lshlrev_b32 v53, 4, v53
    v_and_b32 v54, 1, v50
    v_lshl_add_u32 v53, v54, 3, v53
    v_lshl_add_u32 v54, v48, 3, v49
    v_lshl_add_u32 v42, v54, 8, v53
    v_xor_b32 v43, 32, v42
    s_lshl_b32 s47, s34, 12
    s_add_u32 s42, s18, 0x0
    s_addc_u32 s43, s19, 0
    s_add_u32 s44, s47, 0
    s_mov_b32 m0, s44
    s_add_u32 s44, s44, 1024
    global_load_lds_dwordx4 v40, s[42:43]
    s_add_u32 s42, s42, 0x8000
    s_addc_u32 s43, s43, 0
    s_mov_b32 m0, s44
    s_add_u32 s44, s44, 1024
    global_load_lds_dwordx4 v40, s[42:43]
    s_add_u32 s42, s42, 0x8000
    s_addc_u32 s43, s43, 0
    s_mov_b32 m0, s44
    s_add_u32 s44, s44, 1024
    global_load_lds_dwordx4 v41, s[42:43]
    s_add_u32 s42, s42, 0x8000
    s_addc_u32 s43, s43, 0
    s_mov_b32 m0, s44
    s_add_u32 s44, s44, 1024
    global_load_lds_dwordx4 v41, s[42:43]
    s_add_u32 s42, s18, 0x80000
    s_addc_u32 s43, s19, 0
    s_add_u32 s44, s47, 16384
    s_mov_b32 m0, s44
    s_add_u32 s44, s44, 1024
    global_load_lds_dwordx4 v40, s[42:43]
    s_add_u32 s42, s42, 0x8000
    s_addc_u32 s43, s43, 0
    s_mov_b32 m0, s44
    s_add_u32 s44, s44, 1024
    global_load_lds_dwordx4 v40, s[42:43]
    s_add_u32 s42, s42, 0x8000
    s_addc_u32 s43, s43, 0
    s_mov_b32 m0, s44
    s_add_u32 s44, s44, 1024
    global_load_lds_dwordx4 v41, s[42:43]
    s_add_u32 s42, s42, 0x8000
    s_addc_u32 s43, s43, 0
    s_mov_b32 m0, s44
    s_add_u32 s44, s44, 1024
    global_load_lds_dwordx4 v41, s[42:43]
    s_add_u32 s42, s18, 0x100000
    s_addc_u32 s43, s19, 0
    s_add_u32 s44, s47, 49152
    s_mov_b32 m0, s44
    s_add_u32 s44, s44, 1024
    global_load_lds_dwordx4 v40, s[42:43]
    s_add_u32 s42, s42, 0x8000
    s_addc_u32 s43, s43, 0
    s_mov_b32 m0, s44
    s_add_u32 s44, s44, 1024
    global_load_lds_dwordx4 v40, s[42:43]
    s_add_u32 s42, s42, 0x8000
    s_addc_u32 s43, s43, 0
    s_mov_b32 m0, s44
    s_add_u32 s44, s44, 1024
    global_load_lds_dwordx4 v41, s[42:43]
    s_add_u32 s42, s42, 0x8000
    s_addc_u32 s43, s43, 0
    s_mov_b32 m0, s44
    s_add_u32 s44, s44, 1024
    global_load_lds_dwordx4 v41, s[42:43]
    s_add_u32 s42, s18, 0x180000
    s_addc_u32 s43, s19, 0
    s_add_u32 s44, s47, 81920
    s_mov_b32 m0, s44
    s_add_u32 s44, s44, 1024
    global_load_lds_dwordx4 v40, s[42:43]
    s_add_u32 s42, s42, 0x8000
    s_addc_u32 s43, s43, 0
    s_mov_b32 m0, s44
    s_add_u32 s44, s44, 1024
    global_load_lds_dwordx4 v40, s[42:43]
    s_add_u32 s42, s42, 0x8000
    s_addc_u32 s43, s43, 0
    s_mov_b32 m0, s44
    s_add_u32 s44, s44, 1024
    global_load_lds_dwordx4 v41, s[42:43]
    s_add_u32 s42, s42, 0x8000
    s_addc_u32 s43, s43, 0
    s_mov_b32 m0, s44
    s_add_u32 s44, s44, 1024
    global_load_lds_dwordx4 v41, s[42:43]
    s_add_u32 s42, s18, 0x200000
    s_addc_u32 s43, s19, 0
    s_add_u32 s44, s47, 114688
    s_mov_b32 m0, s44
    s_add_u32 s44, s44, 1024
    global_load_lds_dwordx4 v40, s[42:43]
    s_add_u32 s42, s42, 0x8000
    s_addc_u32 s43, s43, 0
    s_mov_b32 m0, s44
    s_add_u32 s44, s44, 1024
    global_load_lds_dwordx4 v40, s[42:43]
    s_add_u32 s42, s42, 0x8000
    s_addc_u32 s43, s43, 0
    s_mov_b32 m0, s44
    s_add_u32 s44, s44, 1024
    global_load_lds_dwordx4 v41, s[42:43]
    s_add_u32 s42, s42, 0x8000
    s_addc_u32 s43, s43, 0
    s_mov_b32 m0, s44
    s_add_u32 s44, s44, 1024
    global_load_lds_dwordx4 v41, s[42:43]
    s_add_u32 s42, s18, 0x280000
    s_addc_u32 s43, s19, 0
    s_add_u32 s44, s47, 147456
    s_mov_b32 m0, s44
    s_add_u32 s44, s44, 1024
    global_load_lds_dwordx4 v40, s[42:43]
    s_add_u32 s42, s42, 0x8000
    s_addc_u32 s43, s43, 0
    s_mov_b32 m0, s44
    s_add_u32 s44, s44, 1024
    global_load_lds_dwordx4 v40, s[42:43]
    s_add_u32 s42, s42, 0x8000
    s_addc_u32 s43, s43, 0
    s_mov_b32 m0, s44
    s_add_u32 s44, s44, 1024
    global_load_lds_dwordx4 v41, s[42:43]
    s_add_u32 s42, s42, 0x8000
    s_addc_u32 s43, s43, 0
    s_mov_b32 m0, s44
    s_add_u32 s44, s44, 1024
    global_load_lds_dwordx4 v41, s[42:43]
    s_waitcnt vmcnt(20) lgkmcnt(0)
    s_barrier
    v_add_u32 v47, 0, v42
    v_add_u32 v44, 0, v43
    ds_read_b64_tr_b16 a[0:1], v47 offset:0
    ds_read_b64_tr_b16 a[2:3], v47 offset:1024
    ds_read_b64_tr_b16 a[4:5], v47 offset:8192
    ds_read_b64_tr_b16 a[6:7], v47 offset:9216
    ds_read_b64_tr_b16 a[64:65], v44 offset:0
    ds_read_b64_tr_b16 a[66:67], v44 offset:1024
    ds_read_b64_tr_b16 a[68:69], v44 offset:8192
    ds_read_b64_tr_b16 a[70:71], v44 offset:9216
    s_waitcnt vmcnt(16) lgkmcnt(0)
    s_barrier
    s_add_u32 s42, s18, 0x300000
    s_addc_u32 s43, s19, 0
    s_add_u32 s44, s47, 0
    s_mov_b32 m0, s44
    s_add_u32 s44, s44, 1024
    global_load_lds_dwordx4 v40, s[42:43]
    s_add_u32 s42, s42, 0x8000
    s_addc_u32 s43, s43, 0
    s_mov_b32 m0, s44
    s_add_u32 s44, s44, 1024
    global_load_lds_dwordx4 v40, s[42:43]
    s_add_u32 s42, s42, 0x8000
    s_addc_u32 s43, s43, 0
    s_mov_b32 m0, s44
    s_add_u32 s44, s44, 1024
    global_load_lds_dwordx4 v41, s[42:43]
    s_add_u32 s42, s42, 0x8000
    s_addc_u32 s43, s43, 0
    s_mov_b32 m0, s44
    s_add_u32 s44, s44, 1024
    global_load_lds_dwordx4 v41, s[42:43]
    v_add_u32 v47, 16384, v42
    v_add_u32 v44, 16384, v43
    ds_read_b64_tr_b16 a[8:9], v47 offset:0
    ds_read_b64_tr_b16 a[10:11], v47 offset:1024
    ds_read_b64_tr_b16 a[12:13], v47 offset:8192
    ds_read_b64_tr_b16 a[14:15], v47 offset:9216
    ds_read_b64_tr_b16 a[72:73], v44 offset:0
    ds_read_b64_tr_b16 a[74:75], v44 offset:1024
    ds_read_b64_tr_b16 a[76:77], v44 offset:8192
    ds_read_b64_tr_b16 a[78:79], v44 offset:9216
    s_waitcnt vmcnt(16) lgkmcnt(0)
    s_barrier
    s_add_u32 s42, s18, 0x380000
    s_addc_u32 s43, s19, 0
    s_add_u32 s44, s47, 16384
    s_mov_b32 m0, s44
    s_add_u32 s44, s44, 1024
    global_load_lds_dwordx4 v40, s[42:43]
    s_add_u32 s42, s42, 0x8000
    s_addc_u32 s43, s43, 0
    s_mov_b32 m0, s44
    s_add_u32 s44, s44, 1024
    global_load_lds_dwordx4 v40, s[42:43]
    s_add_u32 s42, s42, 0x8000
    s_addc_u32 s43, s43, 0
    s_mov_b32 m0, s44
    s_add_u32 s44, s44, 1024
    global_load_lds_dwordx4 v41, s[42:43]
    s_add_u32 s42, s42, 0x8000
    s_addc_u32 s43, s43, 0
    s_mov_b32 m0, s44
    s_add_u32 s44, s44, 1024
    global_load_lds_dwordx4 v41, s[42:43]
    v_add_u32 v47, 49152, v42
    v_add_u32 v44, 49152, v43
    ds_read_b64_tr_b16 a[16:17], v47 offset:0
    ds_read_b64_tr_b16 a[18:19], v47 offset:1024
    ds_read_b64_tr_b16 a[20:21], v47 offset:8192
    ds_read_b64_tr_b16 a[22:23], v47 offset:9216
    ds_read_b64_tr_b16 a[80:81], v44 offset:0
    ds_read_b64_tr_b16 a[82:83], v44 offset:1024
    ds_read_b64_tr_b16 a[84:85], v44 offset:8192
    ds_read_b64_tr_b16 a[86:87], v44 offset:9216
    s_waitcnt vmcnt(16) lgkmcnt(0)
    s_barrier
    s_add_u32 s42, s20, 0x0
    s_addc_u32 s43, s21, 0
    s_add_u32 s44, s47, 49152
    s_mov_b32 m0, s44
    s_add_u32 s44, s44, 1024
    global_load_lds_dwordx4 v40, s[42:43]
    s_add_u32 s42, s42, 0x8000
    s_addc_u32 s43, s43, 0
    s_mov_b32 m0, s44
    s_add_u32 s44, s44, 1024
    global_load_lds_dwordx4 v40, s[42:43]
    s_add_u32 s42, s42, 0x8000
    s_addc_u32 s43, s43, 0
    s_mov_b32 m0, s44
    s_add_u32 s44, s44, 1024
    global_load_lds_dwordx4 v41, s[42:43]
    s_add_u32 s42, s42, 0x8000
    s_addc_u32 s43, s43, 0
    s_mov_b32 m0, s44
    s_add_u32 s44, s44, 1024
    global_load_lds_dwordx4 v41, s[42:43]
    v_add_u32 v47, 81920, v42
    v_add_u32 v44, 81920, v43
    ds_read_b64_tr_b16 a[24:25], v47 offset:0
    ds_read_b64_tr_b16 a[26:27], v47 offset:1024
    ds_read_b64_tr_b16 a[28:29], v47 offset:8192
    ds_read_b64_tr_b16 a[30:31], v47 offset:9216
    ds_read_b64_tr_b16 a[88:89], v44 offset:0
    ds_read_b64_tr_b16 a[90:91], v44 offset:1024
    ds_read_b64_tr_b16 a[92:93], v44 offset:8192
    ds_read_b64_tr_b16 a[94:95], v44 offset:9216
    s_waitcnt vmcnt(16) lgkmcnt(0)
    s_barrier
    s_add_u32 s42, s20, 0x80000
    s_addc_u32 s43, s21, 0
    s_add_u32 s44, s47, 81920
    s_mov_b32 m0, s44
    s_add_u32 s44, s44, 1024
    global_load_lds_dwordx4 v40, s[42:43]
    s_add_u32 s42, s42, 0x8000
    s_addc_u32 s43, s43, 0
    s_mov_b32 m0, s44
    s_add_u32 s44, s44, 1024
    global_load_lds_dwordx4 v40, s[42:43]
    s_add_u32 s42, s42, 0x8000
    s_addc_u32 s43, s43, 0
    s_mov_b32 m0, s44
    s_add_u32 s44, s44, 1024
    global_load_lds_dwordx4 v41, s[42:43]
    s_add_u32 s42, s42, 0x8000
    s_addc_u32 s43, s43, 0
    s_mov_b32 m0, s44
    s_add_u32 s44, s44, 1024
    global_load_lds_dwordx4 v41, s[42:43]
    v_add_u32 v47, 114688, v42
    v_add_u32 v44, 114688, v43
    ds_read_b64_tr_b16 a[32:33], v47 offset:0
    ds_read_b64_tr_b16 a[34:35], v47 offset:1024
    ds_read_b64_tr_b16 a[36:37], v47 offset:8192
    ds_read_b64_tr_b16 a[38:39], v47 offset:9216
    ds_read_b64_tr_b16 a[96:97], v44 offset:0
    ds_read_b64_tr_b16 a[98:99], v44 offset:1024
    ds_read_b64_tr_b16 a[100:101], v44 offset:8192
    ds_read_b64_tr_b16 a[102:103], v44 offset:9216
    s_waitcnt vmcnt(16) lgkmcnt(0)
    s_barrier
    s_add_u32 s42, s20, 0x100000
    s_addc_u32 s43, s21, 0
    s_add_u32 s44, s47, 114688
    s_mov_b32 m0, s44
    s_add_u32 s44, s44, 1024
    global_load_lds_dwordx4 v40, s[42:43]
    s_add_u32 s42, s42, 0x8000
    s_addc_u32 s43, s43, 0
    s_mov_b32 m0, s44
    s_add_u32 s44, s44, 1024
    global_load_lds_dwordx4 v40, s[42:43]
    s_add_u32 s42, s42, 0x8000
    s_addc_u32 s43, s43, 0
    s_mov_b32 m0, s44
    s_add_u32 s44, s44, 1024
    global_load_lds_dwordx4 v41, s[42:43]
    s_add_u32 s42, s42, 0x8000
    s_addc_u32 s43, s43, 0
    s_mov_b32 m0, s44
    s_add_u32 s44, s44, 1024
    global_load_lds_dwordx4 v41, s[42:43]
    v_add_u32 v47, 147456, v42
    v_add_u32 v44, 147456, v43
    ds_read_b64_tr_b16 a[40:41], v47 offset:0
    ds_read_b64_tr_b16 a[42:43], v47 offset:1024
    ds_read_b64_tr_b16 a[44:45], v47 offset:8192
    ds_read_b64_tr_b16 a[46:47], v47 offset:9216
    ds_read_b64_tr_b16 a[104:105], v44 offset:0
    ds_read_b64_tr_b16 a[106:107], v44 offset:1024
    ds_read_b64_tr_b16 a[108:109], v44 offset:8192
    ds_read_b64_tr_b16 a[110:111], v44 offset:9216
    s_waitcnt vmcnt(16) lgkmcnt(0)
    s_barrier
    s_add_u32 s42, s20, 0x180000
    s_addc_u32 s43, s21, 0
    s_add_u32 s44, s47, 147456
    s_mov_b32 m0, s44
    s_add_u32 s44, s44, 1024
    global_load_lds_dwordx4 v40, s[42:43]
    s_add_u32 s42, s42, 0x8000
    s_addc_u32 s43, s43, 0
    s_mov_b32 m0, s44
    s_add_u32 s44, s44, 1024
    global_load_lds_dwordx4 v40, s[42:43]
    s_add_u32 s42, s42, 0x8000
    s_addc_u32 s43, s43, 0
    s_mov_b32 m0, s44
    s_add_u32 s44, s44, 1024
    global_load_lds_dwordx4 v41, s[42:43]
    s_add_u32 s42, s42, 0x8000
    s_addc_u32 s43, s43, 0
    s_mov_b32 m0, s44
    s_add_u32 s44, s44, 1024
    global_load_lds_dwordx4 v41, s[42:43]
    v_add_u32 v47, 0, v42
    v_add_u32 v44, 0, v43
    ds_read_b64_tr_b16 a[48:49], v47 offset:0
    ds_read_b64_tr_b16 a[50:51], v47 offset:1024
    ds_read_b64_tr_b16 a[52:53], v47 offset:8192
    ds_read_b64_tr_b16 a[54:55], v47 offset:9216
    ds_read_b64_tr_b16 a[112:113], v44 offset:0
    ds_read_b64_tr_b16 a[114:115], v44 offset:1024
    ds_read_b64_tr_b16 a[116:117], v44 offset:8192
    ds_read_b64_tr_b16 a[118:119], v44 offset:9216
    s_waitcnt vmcnt(16) lgkmcnt(0)
    s_barrier
    s_add_u32 s42, s20, 0x200000
    s_addc_u32 s43, s21, 0
    s_add_u32 s44, s47, 0
    s_mov_b32 m0, s44
    s_add_u32 s44, s44, 1024
    global_load_lds_dwordx4 v40, s[42:43]
    s_add_u32 s42, s42, 0x8000
    s_addc_u32 s43, s43, 0
    s_mov_b32 m0, s44
    s_add_u32 s44, s44, 1024
    global_load_lds_dwordx4 v40, s[42:43]
    s_add_u32 s42, s42, 0x8000
    s_addc_u32 s43, s43, 0
    s_mov_b32 m0, s44
    s_add_u32 s44, s44, 1024
    global_load_lds_dwordx4 v41, s[42:43]
    s_add_u32 s42, s42, 0x8000
    s_addc_u32 s43, s43, 0
    s_mov_b32 m0, s44
    s_add_u32 s44, s44, 1024
    global_load_lds_dwordx4 v41, s[42:43]
    v_add_u32 v47, 16384, v42
    v_add_u32 v44, 16384, v43
    ds_read_b64_tr_b16 a[56:57], v47 offset:0
    ds_read_b64_tr_b16 a[58:59], v47 offset:1024
    ds_read_b64_tr_b16 a[60:61], v47 offset:8192
    ds_read_b64_tr_b16 a[62:63], v47 offset:9216
    ds_read_b64_tr_b16 a[120:121], v44 offset:0
    ds_read_b64_tr_b16 a[122:123], v44 offset:1024
    ds_read_b64_tr_b16 a[124:125], v44 offset:8192
    ds_read_b64_tr_b16 a[126:127], v44 offset:9216
    s_waitcnt vmcnt(16) lgkmcnt(0)
    s_barrier
    s_add_u32 s42, s20, 0x280000
    s_addc_u32 s43, s21, 0
    s_add_u32 s44, s47, 16384
    s_mov_b32 m0, s44
    s_add_u32 s44, s44, 1024
    global_load_lds_dwordx4 v40, s[42:43]
    s_add_u32 s42, s42, 0x8000
    s_addc_u32 s43, s43, 0
    s_mov_b32 m0, s44
    s_add_u32 s44, s44, 1024
    global_load_lds_dwordx4 v40, s[42:43]
    s_add_u32 s42, s42, 0x8000
    s_addc_u32 s43, s43, 0
    s_mov_b32 m0, s44
    s_add_u32 s44, s44, 1024
    global_load_lds_dwordx4 v41, s[42:43]
    s_add_u32 s42, s42, 0x8000
    s_addc_u32 s43, s43, 0
    s_mov_b32 m0, s44
    s_add_u32 s44, s44, 1024
    global_load_lds_dwordx4 v41, s[42:43]
    v_add_u32 v47, 49152, v42
    v_add_u32 v44, 49152, v43
    ds_read_b64_tr_b16 a[128:129], v47 offset:0
    ds_read_b64_tr_b16 a[130:131], v47 offset:1024
    ds_read_b64_tr_b16 a[132:133], v47 offset:8192
    ds_read_b64_tr_b16 a[134:135], v47 offset:9216
    ds_read_b64_tr_b16 a[192:193], v44 offset:0
    ds_read_b64_tr_b16 a[194:195], v44 offset:1024
    ds_read_b64_tr_b16 a[196:197], v44 offset:8192
    ds_read_b64_tr_b16 a[198:199], v44 offset:9216
    s_waitcnt vmcnt(16) lgkmcnt(0)
    s_barrier
    s_add_u32 s42, s20, 0x300000
    s_addc_u32 s43, s21, 0
    s_add_u32 s44, s47, 49152
    s_mov_b32 m0, s44
    s_add_u32 s44, s44, 1024
    global_load_lds_dwordx4 v40, s[42:43]
    s_add_u32 s42, s42, 0x8000
    s_addc_u32 s43, s43, 0
    s_mov_b32 m0, s44
    s_add_u32 s44, s44, 1024
    global_load_lds_dwordx4 v40, s[42:43]
    s_add_u32 s42, s42, 0x8000
    s_addc_u32 s43, s43, 0
    s_mov_b32 m0, s44
    s_add_u32 s44, s44, 1024
    global_load_lds_dwordx4 v41, s[42:43]
    s_add_u32 s42, s42, 0x8000
    s_addc_u32 s43, s43, 0
    s_mov_b32 m0, s44
    s_add_u32 s44, s44, 1024
    global_load_lds_dwordx4 v41, s[42:43]
    v_add_u32 v47, 81920, v42
    v_add_u32 v44, 81920, v43
    ds_read_b64_tr_b16 a[136:137], v47 offset:0
    ds_read_b64_tr_b16 a[138:139], v47 offset:1024
    ds_read_b64_tr_b16 a[140:141], v47 offset:8192
    ds_read_b64_tr_b16 a[142:143], v47 offset:9216
    ds_read_b64_tr_b16 a[200:201], v44 offset:0
    ds_read_b64_tr_b16 a[202:203], v44 offset:1024
    ds_read_b64_tr_b16 a[204:205], v44 offset:8192
    ds_read_b64_tr_b16 a[206:207], v44 offset:9216
    s_waitcnt vmcnt(16) lgkmcnt(0)
    s_barrier
    s_add_u32 s42, s20, 0x380000
    s_addc_u32 s43, s21, 0
    s_add_u32 s44, s47, 81920
    s_mov_b32 m0, s44
    s_add_u32 s44, s44, 1024
    global_load_lds_dwordx4 v40, s[42:43]
    s_add_u32 s42, s42, 0x8000
    s_addc_u32 s43, s43, 0
    s_mov_b32 m0, s44
    s_add_u32 s44, s44, 1024
    global_load_lds_dwordx4 v40, s[42:43]
    s_add_u32 s42, s42, 0x8000
    s_addc_u32 s43, s43, 0
    s_mov_b32 m0, s44
    s_add_u32 s44, s44, 1024
    global_load_lds_dwordx4 v41, s[42:43]
    s_add_u32 s42, s42, 0x8000
    s_addc_u32 s43, s43, 0
    s_mov_b32 m0, s44
    s_add_u32 s44, s44, 1024
    global_load_lds_dwordx4 v41, s[42:43]
    v_add_u32 v47, 114688, v42
    v_add_u32 v44, 114688, v43
    ds_read_b64_tr_b16 a[144:145], v47 offset:0
    ds_read_b64_tr_b16 a[146:147], v47 offset:1024
    ds_read_b64_tr_b16 a[148:149], v47 offset:8192
    ds_read_b64_tr_b16 a[150:151], v47 offset:9216
    ds_read_b64_tr_b16 a[208:209], v44 offset:0
    ds_read_b64_tr_b16 a[210:211], v44 offset:1024
    ds_read_b64_tr_b16 a[212:213], v44 offset:8192
    ds_read_b64_tr_b16 a[214:215], v44 offset:9216
    s_waitcnt vmcnt(16) lgkmcnt(0)
    s_barrier
    s_add_u32 s42, s22, 0x0
    s_addc_u32 s43, s23, 0
    s_add_u32 s44, s47, 114688
    s_mov_b32 m0, s44
    s_add_u32 s44, s44, 1024
    global_load_lds_dwordx4 v40, s[42:43]
    s_add_u32 s42, s42, 0x8000
    s_addc_u32 s43, s43, 0
    s_mov_b32 m0, s44
    s_add_u32 s44, s44, 1024
    global_load_lds_dwordx4 v40, s[42:43]
    s_add_u32 s42, s42, 0x8000
    s_addc_u32 s43, s43, 0
    s_mov_b32 m0, s44
    s_add_u32 s44, s44, 1024
    global_load_lds_dwordx4 v41, s[42:43]
    s_add_u32 s42, s42, 0x8000
    s_addc_u32 s43, s43, 0
    s_mov_b32 m0, s44
    s_add_u32 s44, s44, 1024
    global_load_lds_dwordx4 v41, s[42:43]
    v_add_u32 v47, 147456, v42
    v_add_u32 v44, 147456, v43
    ds_read_b64_tr_b16 a[152:153], v47 offset:0
    ds_read_b64_tr_b16 a[154:155], v47 offset:1024
    ds_read_b64_tr_b16 a[156:157], v47 offset:8192
    ds_read_b64_tr_b16 a[158:159], v47 offset:9216
    ds_read_b64_tr_b16 a[216:217], v44 offset:0
    ds_read_b64_tr_b16 a[218:219], v44 offset:1024
    ds_read_b64_tr_b16 a[220:221], v44 offset:8192
    ds_read_b64_tr_b16 a[222:223], v44 offset:9216
    s_waitcnt vmcnt(16) lgkmcnt(0)
    s_barrier
    s_add_u32 s42, s22, 0x80000
    s_addc_u32 s43, s23, 0
    s_add_u32 s44, s47, 147456
    s_mov_b32 m0, s44
    s_add_u32 s44, s44, 1024
    global_load_lds_dwordx4 v40, s[42:43]
    s_add_u32 s42, s42, 0x8000
    s_addc_u32 s43, s43, 0
    s_mov_b32 m0, s44
    s_add_u32 s44, s44, 1024
    global_load_lds_dwordx4 v40, s[42:43]
    s_add_u32 s42, s42, 0x8000
    s_addc_u32 s43, s43, 0
    s_mov_b32 m0, s44
    s_add_u32 s44, s44, 1024
    global_load_lds_dwordx4 v41, s[42:43]
    s_add_u32 s42, s42, 0x8000
    s_addc_u32 s43, s43, 0
    s_mov_b32 m0, s44
    s_add_u32 s44, s44, 1024
    global_load_lds_dwordx4 v41, s[42:43]
    v_add_u32 v47, 0, v42
    v_add_u32 v44, 0, v43
    ds_read_b64_tr_b16 a[160:161], v47 offset:0
    ds_read_b64_tr_b16 a[162:163], v47 offset:1024
    ds_read_b64_tr_b16 a[164:165], v47 offset:8192
    ds_read_b64_tr_b16 a[166:167], v47 offset:9216
    ds_read_b64_tr_b16 a[224:225], v44 offset:0
    ds_read_b64_tr_b16 a[226:227], v44 offset:1024
    ds_read_b64_tr_b16 a[228:229], v44 offset:8192
    ds_read_b64_tr_b16 a[230:231], v44 offset:9216
    s_waitcnt vmcnt(16) lgkmcnt(0)
    s_barrier
    s_add_u32 s42, s22, 0x100000
    s_addc_u32 s43, s23, 0
    s_add_u32 s44, s47, 0
    s_mov_b32 m0, s44
    s_add_u32 s44, s44, 1024
    global_load_lds_dwordx4 v40, s[42:43]
    s_add_u32 s42, s42, 0x8000
    s_addc_u32 s43, s43, 0
    s_mov_b32 m0, s44
    s_add_u32 s44, s44, 1024
    global_load_lds_dwordx4 v40, s[42:43]
    s_add_u32 s42, s42, 0x8000
    s_addc_u32 s43, s43, 0
    s_mov_b32 m0, s44
    s_add_u32 s44, s44, 1024
    global_load_lds_dwordx4 v41, s[42:43]
    s_add_u32 s42, s42, 0x8000
    s_addc_u32 s43, s43, 0
    s_mov_b32 m0, s44
    s_add_u32 s44, s44, 1024
    global_load_lds_dwordx4 v41, s[42:43]
    v_add_u32 v47, 16384, v42
    v_add_u32 v44, 16384, v43
    ds_read_b64_tr_b16 a[168:169], v47 offset:0
    ds_read_b64_tr_b16 a[170:171], v47 offset:1024
    ds_read_b64_tr_b16 a[172:173], v47 offset:8192
    ds_read_b64_tr_b16 a[174:175], v47 offset:9216
    ds_read_b64_tr_b16 a[232:233], v44 offset:0
    ds_read_b64_tr_b16 a[234:235], v44 offset:1024
    ds_read_b64_tr_b16 a[236:237], v44 offset:8192
    ds_read_b64_tr_b16 a[238:239], v44 offset:9216
    s_waitcnt vmcnt(16) lgkmcnt(0)
    s_barrier
    s_add_u32 s42, s22, 0x180000
    s_addc_u32 s43, s23, 0
    s_add_u32 s44, s47, 16384
    s_mov_b32 m0, s44
    s_add_u32 s44, s44, 1024
    global_load_lds_dwordx4 v40, s[42:43]
    s_add_u32 s42, s42, 0x8000
    s_addc_u32 s43, s43, 0
    s_mov_b32 m0, s44
    s_add_u32 s44, s44, 1024
    global_load_lds_dwordx4 v40, s[42:43]
    s_add_u32 s42, s42, 0x8000
    s_addc_u32 s43, s43, 0
    s_mov_b32 m0, s44
    s_add_u32 s44, s44, 1024
    global_load_lds_dwordx4 v41, s[42:43]
    s_add_u32 s42, s42, 0x8000
    s_addc_u32 s43, s43, 0
    s_mov_b32 m0, s44
    s_add_u32 s44, s44, 1024
    global_load_lds_dwordx4 v41, s[42:43]
    v_add_u32 v47, 49152, v42
    v_add_u32 v44, 49152, v43
    ds_read_b64_tr_b16 a[176:177], v47 offset:0
    ds_read_b64_tr_b16 a[178:179], v47 offset:1024
    ds_read_b64_tr_b16 a[180:181], v47 offset:8192
    ds_read_b64_tr_b16 a[182:183], v47 offset:9216
    ds_read_b64_tr_b16 a[240:241], v44 offset:0
    ds_read_b64_tr_b16 a[242:243], v44 offset:1024
    ds_read_b64_tr_b16 a[244:245], v44 offset:8192
    ds_read_b64_tr_b16 a[246:247], v44 offset:9216
    s_waitcnt vmcnt(16) lgkmcnt(0)
    s_barrier
    s_add_u32 s42, s22, 0x200000
    s_addc_u32 s43, s23, 0
    s_add_u32 s44, s47, 49152
    s_mov_b32 m0, s44
    s_add_u32 s44, s44, 1024
    global_load_lds_dwordx4 v40, s[42:43]
    s_add_u32 s42, s42, 0x8000
    s_addc_u32 s43, s43, 0
    s_mov_b32 m0, s44
    s_add_u32 s44, s44, 1024
    global_load_lds_dwordx4 v40, s[42:43]
    s_add_u32 s42, s42, 0x8000
    s_addc_u32 s43, s43, 0
    s_mov_b32 m0, s44
    s_add_u32 s44, s44, 1024
    global_load_lds_dwordx4 v41, s[42:43]
    s_add_u32 s42, s42, 0x8000
    s_addc_u32 s43, s43, 0
    s_mov_b32 m0, s44
    s_add_u32 s44, s44, 1024
    global_load_lds_dwordx4 v41, s[42:43]
    v_add_u32 v47, 81920, v42
    v_add_u32 v44, 81920, v43
    ds_read_b64_tr_b16 a[184:185], v47 offset:0
    ds_read_b64_tr_b16 a[186:187], v47 offset:1024
    ds_read_b64_tr_b16 a[188:189], v47 offset:8192
    ds_read_b64_tr_b16 a[190:191], v47 offset:9216
    ds_read_b64_tr_b16 a[248:249], v44 offset:0
    ds_read_b64_tr_b16 a[250:251], v44 offset:1024
    ds_read_b64_tr_b16 a[252:253], v44 offset:8192
    ds_read_b64_tr_b16 a[254:255], v44 offset:9216
    s_waitcnt vmcnt(16) lgkmcnt(0)
    s_barrier
    s_add_u32 s42, s22, 0x280000
    s_addc_u32 s43, s23, 0
    s_add_u32 s44, s47, 81920
    s_mov_b32 m0, s44
    s_add_u32 s44, s44, 1024
    global_load_lds_dwordx4 v40, s[42:43]
    s_add_u32 s42, s42, 0x8000
    s_addc_u32 s43, s43, 0
    s_mov_b32 m0, s44
    s_add_u32 s44, s44, 1024
    global_load_lds_dwordx4 v40, s[42:43]
    s_add_u32 s42, s42, 0x8000
    s_addc_u32 s43, s43, 0
    s_mov_b32 m0, s44
    s_add_u32 s44, s44, 1024
    global_load_lds_dwordx4 v41, s[42:43]
    s_add_u32 s42, s42, 0x8000
    s_addc_u32 s43, s43, 0
    s_mov_b32 m0, s44
    s_add_u32 s44, s44, 1024
    global_load_lds_dwordx4 v41, s[42:43]
    v_add_u32 v47, 114688, v42
    v_add_u32 v44, 114688, v43
    ds_read_b64_tr_b16 v[128:129], v47 offset:0
    ds_read_b64_tr_b16 v[130:131], v47 offset:1024
    ds_read_b64_tr_b16 v[132:133], v47 offset:8192
    ds_read_b64_tr_b16 v[134:135], v47 offset:9216
    ds_read_b64_tr_b16 v[192:193], v44 offset:0
    ds_read_b64_tr_b16 v[194:195], v44 offset:1024
    ds_read_b64_tr_b16 v[196:197], v44 offset:8192
    ds_read_b64_tr_b16 v[198:199], v44 offset:9216
    s_waitcnt vmcnt(16) lgkmcnt(0)
    s_barrier
    s_add_u32 s42, s22, 0x300000
    s_addc_u32 s43, s23, 0
    s_add_u32 s44, s47, 114688
    s_mov_b32 m0, s44
    s_add_u32 s44, s44, 1024
    global_load_lds_dwordx4 v40, s[42:43]
    s_add_u32 s42, s42, 0x8000
    s_addc_u32 s43, s43, 0
    s_mov_b32 m0, s44
    s_add_u32 s44, s44, 1024
    global_load_lds_dwordx4 v40, s[42:43]
    s_add_u32 s42, s42, 0x8000
    s_addc_u32 s43, s43, 0
    s_mov_b32 m0, s44
    s_add_u32 s44, s44, 1024
    global_load_lds_dwordx4 v41, s[42:43]
    s_add_u32 s42, s42, 0x8000
    s_addc_u32 s43, s43, 0
    s_mov_b32 m0, s44
    s_add_u32 s44, s44, 1024
    global_load_lds_dwordx4 v41, s[42:43]
    v_add_u32 v47, 147456, v42
    v_add_u32 v44, 147456, v43
    ds_read_b64_tr_b16 v[136:137], v47 offset:0
    ds_read_b64_tr_b16 v[138:139], v47 offset:1024
    ds_read_b64_tr_b16 v[140:141], v47 offset:8192
    ds_read_b64_tr_b16 v[142:143], v47 offset:9216
    ds_read_b64_tr_b16 v[200:201], v44 offset:0
    ds_read_b64_tr_b16 v[202:203], v44 offset:1024
    ds_read_b64_tr_b16 v[204:205], v44 offset:8192
    ds_read_b64_tr_b16 v[206:207], v44 offset:9216
    s_waitcnt vmcnt(16) lgkmcnt(0)
    s_barrier
    s_add_u32 s42, s22, 0x380000
    s_addc_u32 s43, s23, 0
    s_add_u32 s44, s47, 147456
    s_mov_b32 m0, s44
    s_add_u32 s44, s44, 1024
    global_load_lds_dwordx4 v40, s[42:43]
    s_add_u32 s42, s42, 0x8000
    s_addc_u32 s43, s43, 0
    s_mov_b32 m0, s44
    s_add_u32 s44, s44, 1024
    global_load_lds_dwordx4 v40, s[42:43]
    s_add_u32 s42, s42, 0x8000
    s_addc_u32 s43, s43, 0
    s_mov_b32 m0, s44
    s_add_u32 s44, s44, 1024
    global_load_lds_dwordx4 v41, s[42:43]
    s_add_u32 s42, s42, 0x8000
    s_addc_u32 s43, s43, 0
    s_mov_b32 m0, s44
    s_add_u32 s44, s44, 1024
    global_load_lds_dwordx4 v41, s[42:43]
    v_add_u32 v47, 0, v42
    v_add_u32 v44, 0, v43
    ds_read_b64_tr_b16 v[144:145], v47 offset:0
    ds_read_b64_tr_b16 v[146:147], v47 offset:1024
    ds_read_b64_tr_b16 v[148:149], v47 offset:8192
    ds_read_b64_tr_b16 v[150:151], v47 offset:9216
    ds_read_b64_tr_b16 v[208:209], v44 offset:0
    ds_read_b64_tr_b16 v[210:211], v44 offset:1024
    ds_read_b64_tr_b16 v[212:213], v44 offset:8192
    ds_read_b64_tr_b16 v[214:215], v44 offset:9216
    s_waitcnt vmcnt(16) lgkmcnt(0)
    s_barrier
    v_add_u32 v47, 16384, v42
    v_add_u32 v44, 16384, v43
    ds_read_b64_tr_b16 v[152:153], v47 offset:0
    ds_read_b64_tr_b16 v[154:155], v47 offset:1024
    ds_read_b64_tr_b16 v[156:157], v47 offset:8192
    ds_read_b64_tr_b16 v[158:159], v47 offset:9216
    ds_read_b64_tr_b16 v[216:217], v44 offset:0
    ds_read_b64_tr_b16 v[218:219], v44 offset:1024
    ds_read_b64_tr_b16 v[220:221], v44 offset:8192
    ds_read_b64_tr_b16 v[222:223], v44 offset:9216
    s_waitcnt vmcnt(12) lgkmcnt(0)
    s_barrier
    v_add_u32 v47, 49152, v42
    v_add_u32 v44, 49152, v43
    ds_read_b64_tr_b16 v[160:161], v47 offset:0
    ds_read_b64_tr_b16 v[162:163], v47 offset:1024
    ds_read_b64_tr_b16 v[164:165], v47 offset:8192
    ds_read_b64_tr_b16 v[166:167], v47 offset:9216
    ds_read_b64_tr_b16 v[224:225], v44 offset:0
    ds_read_b64_tr_b16 v[226:227], v44 offset:1024
    ds_read_b64_tr_b16 v[228:229], v44 offset:8192
    ds_read_b64_tr_b16 v[230:231], v44 offset:9216
    s_waitcnt vmcnt(8) lgkmcnt(0)
    s_barrier
    v_add_u32 v47, 81920, v42
    v_add_u32 v44, 81920, v43
    ds_read_b64_tr_b16 v[168:169], v47 offset:0
    ds_read_b64_tr_b16 v[170:171], v47 offset:1024
    ds_read_b64_tr_b16 v[172:173], v47 offset:8192
    ds_read_b64_tr_b16 v[174:175], v47 offset:9216
    ds_read_b64_tr_b16 v[232:233], v44 offset:0
    ds_read_b64_tr_b16 v[234:235], v44 offset:1024
    ds_read_b64_tr_b16 v[236:237], v44 offset:8192
    ds_read_b64_tr_b16 v[238:239], v44 offset:9216
    s_waitcnt vmcnt(4) lgkmcnt(0)
    s_barrier
    v_add_u32 v47, 114688, v42
    v_add_u32 v44, 114688, v43
    ds_read_b64_tr_b16 v[176:177], v47 offset:0
    ds_read_b64_tr_b16 v[178:179], v47 offset:1024
    ds_read_b64_tr_b16 v[180:181], v47 offset:8192
    ds_read_b64_tr_b16 v[182:183], v47 offset:9216
    ds_read_b64_tr_b16 v[240:241], v44 offset:0
    ds_read_b64_tr_b16 v[242:243], v44 offset:1024
    ds_read_b64_tr_b16 v[244:245], v44 offset:8192
    ds_read_b64_tr_b16 v[246:247], v44 offset:9216
    s_waitcnt vmcnt(0) lgkmcnt(0)
    s_barrier
    v_add_u32 v47, 147456, v42
    v_add_u32 v44, 147456, v43
    ds_read_b64_tr_b16 v[184:185], v47 offset:0
    ds_read_b64_tr_b16 v[186:187], v47 offset:1024
    ds_read_b64_tr_b16 v[188:189], v47 offset:8192
    ds_read_b64_tr_b16 v[190:191], v47 offset:9216
    ds_read_b64_tr_b16 v[248:249], v44 offset:0
    ds_read_b64_tr_b16 v[250:251], v44 offset:1024
    ds_read_b64_tr_b16 v[252:253], v44 offset:8192
    ds_read_b64_tr_b16 v[254:255], v44 offset:9216
    s_waitcnt lgkmcnt(0)
    s_barrier
    v_mov_b32 v41, 224
    s_cmp_lg_u32 s34, 0
    s_cbranch_scc1 Liwd_116
Liw_115:
    global_load_dword v40, v41, s[30:31] sc1
    s_waitcnt vmcnt(0)
    v_readfirstlane_b32 s36, v40
    s_cmp_ge_u32 s36, 1
    s_cbranch_scc1 Liwd_116
    s_sleep 2
    s_add_u32 s101, s101, 1
    s_cmp_gt_u32 s101, 0x40000
    s_cbranch_scc1 L_end
    s_branch Liw_115
Liwd_116:
    s_barrier
    v_mov_b32 v41, 32
    s_cmp_lg_u32 s34, 0
    s_cbranch_scc1 Liwd_118
Liw_117:
    global_load_dword v40, v41, s[30:31] sc1
    s_waitcnt vmcnt(0)
    v_readfirstlane_b32 s36, v40
    s_cmp_ge_u32 s36, 32
    s_cbranch_scc1 Liwd_118
    s_sleep 2
    s_add_u32 s101, s101, 1
    s_cmp_gt_u32 s101, 0x40000
    s_cbranch_scc1 L_end
    s_branch Liw_117
Liwd_118:
    s_barrier
    v_mov_b32 v16, 65536
    v_mov_b64 v[18:19], 0
    ds_write_b64 v16, v[18:19]
    s_waitcnt lgkmcnt(0)
    s_barrier
    s_mov_b32 s48, 0
    s_lshl_b32 s66, s34, 13
L_p1_layer:
    s_sub_u32 s49, s32, 1
    s_cmp_eq_u32 s48, 0
    s_cbranch_scc1 L_p1_near
    s_add_u32 s52, s4, 0x5e80
    s_addc_u32 s53, s5, 0
Lwf_119:
    global_load_dword v16, v5, s[52:53] sc1
    s_waitcnt vmcnt(0)
    v_cmp_eq_u32 vcc, 0, v16
    s_cbranch_vccz Lwo_120
    s_sleep 4
    s_add_u32 s101, s101, 1
    s_cmp_gt_u32 s101, 0x40000
    s_cbranch_scc1 L_end
    s_branch Lwf_119
Lwo_120:
L_p1_near:
    s_lshl_b32 s40, s48, 6
    s_add_u32 s40, s40, s49
    s_lshl_b32 s41, s40, 15
    s_lshl_b32 s42, s34, 13
    s_add_u32 s41, s41, s42
    s_add_u32 s41, s41, 0x800000
    s_add_u32 s54, s4, s41
    s_addc_u32 s55, s5, 0
    s_add_u32 s56, s54, 0x1000
    s_addc_u32 s57, s55, 0
    v_add_u32 v17, s66, v3
Lpt_121:
    global_load_dwordx4 v[96:99], v3, s[54:55] offset:0 sc1
    global_load_dwordx4 v[100:103], v3, s[54:55] offset:1024 sc1
    global_load_dwordx4 v[104:107], v3, s[54:55] offset:2048 sc1
    global_load_dwordx4 v[108:111], v3, s[54:55] offset:3072 sc1
    global_load_dwordx4 v[112:115], v3, s[56:57] offset:0 sc1
    global_load_dwordx4 v[116:119], v3, s[56:57] offset:1024 sc1
    global_load_dwordx4 v[120:123], v3, s[56:57] offset:2048 sc1
    global_load_dwordx4 v[124:127], v3, s[56:57] offset:3072 sc1
    s_add_u32 s101, s101, 1
    s_cmp_gt_u32 s101, 0x40000
    s_cbranch_scc1 L_end
    s_waitcnt vmcnt(0)
    v_max_u32 v16, v96, v100
    v_max3_u32 v16, v16, v104, v108
    v_max3_u32 v16, v16, v112, v116
    v_max3_u32 v16, v16, v120, v124
    v_cmp_eq_u32 vcc, -1, v16
    s_cbranch_vccnz Lpt_121
    ds_write_b128 v17, v[96:99] offset:0
    ds_write_b128 v17, v[100:103] offset:1024
    ds_write_b128 v17, v[104:107] offset:2048
    ds_write_b128 v17, v[108:111] offset:3072
    ds_write_b128 v17, v[112:115] offset:4096
    ds_write_b128 v17, v[116:119] offset:5120
    ds_write_b128 v17, v[120:123] offset:6144
    ds_write_b128 v17, v[124:127] offset:7168
    s_waitcnt lgkmcnt(0)
    s_xor_b32 s66, s66, 32768
    s_lshl_b32 s41, s48, 5
    s_add_u32 s41, s41, s33
    s_lshl_b32 s41, s41, 6
    s_add_u32 s41, s41, s49
    s_lshl_b32 s41, s41, 2
    s_add_u32 s41, s41, 0x10000
    s_add_u32 s68, s4, s41
    s_addc_u32 s69, s5, 0
L_p1_loop:
    s_barrier
    ds_read_b128 v[80:83], v10 offset:0
    ds_read_b128 v[84:87], v10 offset:16384
    s_add_u32 s50, s49, 2
    s_min_u32 s44, s50, 63
    s_lshl_b32 s40, s48, 6
    s_add_u32 s40, s40, s44
    s_lshl_b32 s41, s40, 7
    s_add_u32 s41, s41, 0x0
    s_add_u32 s52, s4, s41
    s_addc_u32 s53, s5, 0
    s_lshl_b32 s40, s48, 6
    s_add_u32 s40, s40, s49
    s_lshl_b32 s67, s40, 5
    s_add_u32 s67, s67, s33
    s_lshl_b32 s67, s67, 13
    s_add_u32 s41, s67, 0x4000000
    s_add_u32 s58, s4, s41
    s_addc_u32 s59, s5, 0
    s_add_u32 s41, s67, 0x6000000
    s_add_u32 s60, s4, s41
    s_addc_u32 s61, s5, 0
    s_add_u32 s41, s67, 0x8000000
    s_add_u32 s62, s4, s41
    s_addc_u32 s63, s5, 0
    s_lshl_b32 s41, s48, 5
    s_add_u32 s41, s41, s33
    s_lshl_b32 s41, s41, 6
    s_add_u32 s41, s41, s49
    s_lshl_b32 s41, s41, 2
    s_add_u32 s41, s41, 0x10000
    s_add_u32 s64, s4, s41
    s_addc_u32 s65, s5, 0
    ds_read_b128 v[88:91], v11 offset:0
    ds_read_b128 v[92:95], v11 offset:16384
    s_waitcnt lgkmcnt(2)
    v_mfma_f32_16x16x32_bf16 v[48:51], a[128:131], v[80:83], 0
    v_mfma_f32_16x16x32_bf16 v[52:55], a[128:131], v[84:87], 0
    v_mfma_f32_16x16x32_bf16 v[56:59], a[192:195], v[80:83], 0
    v_mfma_f32_16x16x32_bf16 v[60:63], a[192:195], v[84:87], 0
    v_mfma_f32_16x16x32_bf16 v[64:67], v[80:83], v[128:131], 0
    v_mfma_f32_16x16x32_bf16 v[68:71], v[84:87], v[128:131], 0
    v_mfma_f32_16x16x32_bf16 v[72:75], v[80:83], v[192:195], 0
    v_mfma_f32_16x16x32_bf16 v[76:79], v[84:87], v[192:195], 0
    ds_read_b128 v[80:83], v12 offset:0
    ds_read_b128 v[84:87], v12 offset:16384
    s_waitcnt lgkmcnt(2)
    v_mfma_f32_16x16x32_bf16 v[48:51], a[132:135], v[88:91], v[48:51]
    v_mfma_f32_16x16x32_bf16 v[52:55], a[132:135], v[92:95], v[52:55]
    v_mfma_f32_16x16x32_bf16 v[56:59], a[196:199], v[88:91], v[56:59]
    v_mfma_f32_16x16x32_bf16 v[60:63], a[196:199], v[92:95], v[60:63]
    v_mfma_f32_16x16x32_bf16 v[64:67], v[88:91], v[132:135], v[64:67]
    v_mfma_f32_16x16x32_bf16 v[68:71], v[92:95], v[132:135], v[68:71]
    v_mfma_f32_16x16x32_bf16 v[72:75], v[88:91], v[196:199], v[72:75]
    v_mfma_f32_16x16x32_bf16 v[76:79], v[92:95], v[196:199], v[76:79]
    ds_read_b128 v[88:91], v13 offset:0
    ds_read_b128 v[92:95], v13 offset:16384
    s_waitcnt lgkmcnt(2)
    v_mfma_f32_16x16x32_bf16 v[48:51], a[136:139], v[80:83], v[48:51]
    v_mfma_f32_16x16x32_bf16 v[52:55], a[136:139], v[84:87], v[52:55]
    v_mfma_f32_16x16x32_bf16 v[56:59], a[200:203], v[80:83], v[56:59]
    v_mfma_f32_16x16x32_bf16 v[60:63], a[200:203], v[84:87], v[60:63]
    v_mfma_f32_16x16x32_bf16 v[64:67], v[80:83], v[136:139], v[64:67]
    v_mfma_f32_16x16x32_bf16 v[68:71], v[84:87], v[136:139], v[68:71]
    v_mfma_f32_16x16x32_bf16 v[72:75], v[80:83], v[200:203], v[72:75]
    v_mfma_f32_16x16x32_bf16 v[76:79], v[84:87], v[200:203], v[76:79]
    ds_read_b128 v[80:83], v10 offset:256
    ds_read_b128 v[84:87], v10 offset:16640
    s_waitcnt lgkmcnt(2)
    v_mfma_f32_16x16x32_bf16 v[48:51], a[140:143], v[88:91], v[48:51]
    v_mfma_f32_16x16x32_bf16 v[52:55], a[140:143], v[92:95], v[52:55]
    v_mfma_f32_16x16x32_bf16 v[56:59], a[204:207], v[88:91], v[56:59]
    v_mfma_f32_16x16x32_bf16 v[60:63], a[204:207], v[92:95], v[60:63]
    v_mfma_f32_16x16x32_bf16 v[64:67], v[88:91], v[140:143], v[64:67]
    v_mfma_f32_16x16x32_bf16 v[68:71], v[92:95], v[140:143], v[68:71]
    v_mfma_f32_16x16x32_bf16 v[72:75], v[88:91], v[204:207], v[72:75]
    v_mfma_f32_16x16x32_bf16 v[76:79], v[92:95], v[204:207], v[76:79]
    ds_read_b128 v[88:91], v11 offset:256
    ds_read_b128 v[92:95], v11 offset:16640
    s_waitcnt lgkmcnt(2)
    v_mfma_f32_16x16x32_bf16 v[48:51], a[144:147], v[80:83], v[48:51]
    v_mfma_f32_16x16x32_bf16 v[52:55], a[144:147], v[84:87], v[52:55]
    v_mfma_f32_16x16x32_bf16 v[56:59], a[208:211], v[80:83], v[56:59]
    v_mfma_f32_16x16x32_bf16 v[60:63], a[208:211], v[84:87], v[60:63]
    v_mfma_f32_16x16x32_bf16 v[64:67], v[80:83], v[144:147], v[64:67]
    v_mfma_f32_16x16x32_bf16 v[68:71], v[84:87], v[144:147], v[68:71]
    v_mfma_f32_16x16x32_bf16 v[72:75], v[80:83], v[208:211], v[72:75]
    v_mfma_f32_16x16x32_bf16 v[76:79], v[84:87], v[208:211], v[76:79]
    ds_read_b128 v[80:83], v12 offset:256
    ds_read_b128 v[84:87], v12 offset:16640
    s_waitcnt lgkmcnt(2)
    v_mfma_f32_16x16x32_bf16 v[48:51], a[148:151], v[88:91], v[48:51]
    v_mfma_f32_16x16x32_bf16 v[52:55], a[148:151], v[92:95], v[52:55]
    v_mfma_f32_16x16x32_bf16 v[56:59], a[212:215], v[88:91], v[56:59]
    v_mfma_f32_16x16x32_bf16 v[60:63], a[212:215], v[92:95], v[60:63]
    v_mfma_f32_16x16x32_bf16 v[64:67], v[88:91], v[148:151], v[64:67]
    v_mfma_f32_16x16x32_bf16 v[68:71], v[92:95], v[148:151], v[68:71]
    v_mfma_f32_16x16x32_bf16 v[72:75], v[88:91], v[212:215], v[72:75]
    v_mfma_f32_16x16x32_bf16 v[76:79], v[92:95], v[212:215], v[76:79]
    ds_read_b128 v[88:91], v13 offset:256
    ds_read_b128 v[92:95], v13 offset:16640
    s_waitcnt lgkmcnt(2)
    v_mfma_f32_16x16x32_bf16 v[48:51], a[152:155], v[80:83], v[48:51]
    v_mfma_f32_16x16x32_bf16 v[52:55], a[152:155], v[84:87], v[52:55]
    v_mfma_f32_16x16x32_bf16 v[56:59], a[216:219], v[80:83], v[56:59]
    v_mfma_f32_16x16x32_bf16 v[60:63], a[216:219], v[84:87], v[60:63]
    v_mfma_f32_16x16x32_bf16 v[64:67], v[80:83], v[152:155], v[64:67]
    v_mfma_f32_16x16x32_bf16 v[68:71], v[84:87], v[152:155], v[68:71]
    v_mfma_f32_16x16x32_bf16 v[72:75], v[80:83], v[216:219], v[72:75]
    v_mfma_f32_16x16x32_bf16 v[76:79], v[84:87], v[216:219], v[76:79]
    ds_read_b128 v[80:83], v10 offset:512
    ds_read_b128 v[84:87], v10 offset:16896
    s_waitcnt lgkmcnt(2)
    v_mfma_f32_16x16x32_bf16 v[48:51], a[156:159], v[88:91], v[48:51]
    v_mfma_f32_16x16x32_bf16 v[52:55], a[156:159], v[92:95], v[52:55]
    v_mfma_f32_16x16x32_bf16 v[56:59], a[220:223], v[88:91], v[56:59]
    v_mfma_f32_16x16x32_bf16 v[60:63], a[220:223], v[92:95], v[60:63]
    v_mfma_f32_16x16x32_bf16 v[64:67], v[88:91], v[156:159], v[64:67]
    v_mfma_f32_16x16x32_bf16 v[68:71], v[92:95], v[156:159], v[68:71]
    v_mfma_f32_16x16x32_bf16 v[72:75], v[88:91], v[220:223], v[72:75]
    v_mfma_f32_16x16x32_bf16 v[76:79], v[92:95], v[220:223], v[76:79]
    ds_read_b128 v[88:91], v11 offset:512
    ds_read_b128 v[92:95], v11 offset:16896
    s_waitcnt lgkmcnt(2)
    v_mfma_f32_16x16x32_bf16 v[48:51], a[160:163], v[80:83], v[48:51]
    v_mfma_f32_16x16x32_bf16 v[52:55], a[160:163], v[84:87], v[52:55]
    v_mfma_f32_16x16x32_bf16 v[56:59], a[224:227], v[80:83], v[56:59]
    v_mfma_f32_16x16x32_bf16 v[60:63], a[224:227], v[84:87], v[60:63]
    v_mfma_f32_16x16x32_bf16 v[64:67], v[80:83], v[160:163], v[64:67]
    v_mfma_f32_16x16x32_bf16 v[68:71], v[84:87], v[160:163], v[68:71]
    v_mfma_f32_16x16x32_bf16 v[72:75], v[80:83], v[224:227], v[72:75]
    v_mfma_f32_16x16x32_bf16 v[76:79], v[84:87], v[224:227], v[76:79]
    ds_read_b128 v[80:83], v12 offset:512
    ds_read_b128 v[84:87], v12 offset:16896
    s_waitcnt lgkmcnt(2)
    v_mfma_f32_16x16x32_bf16 v[48:51], a[164:167], v[88:91], v[48:51]
    v_mfma_f32_16x16x32_bf16 v[52:55], a[164:167], v[92:95], v[52:55]
    v_mfma_f32_16x16x32_bf16 v[56:59], a[228:231], v[88:91], v[56:59]
    v_mfma_f32_16x16x32_bf16 v[60:63], a[228:231], v[92:95], v[60:63]
    v_mfma_f32_16x16x32_bf16 v[64:67], v[88:91], v[164:167], v[64:67]
    v_mfma_f32_16x16x32_bf16 v[68:71], v[92:95], v[164:167], v[68:71]
    v_mfma_f32_16x16x32_bf16 v[72:75], v[88:91], v[228:231], v[72:75]
    v_mfma_f32_16x16x32_bf16 v[76:79], v[92:95], v[228:231], v[76:79]
    ds_read_b128 v[88:91], v13 offset:512
    ds_read_b128 v[92:95], v13 offset:16896
    s_waitcnt lgkmcnt(2)
    v_mfma_f32_16x16x32_bf16 v[48:51], a[168:171], v[80:83], v[48:51]
    v_mfma_f32_16x16x32_bf16 v[52:55], a[168:171], v[84:87], v[52:55]
    v_mfma_f32_16x16x32_bf16 v[56:59], a[232:235], v[80:83], v[56:59]
    v_mfma_f32_16x16x32_bf16 v[60:63], a[232:235], v[84:87], v[60:63]
    v_mfma_f32_16x16x32_bf16 v[64:67], v[80:83], v[168:171], v[64:67]
    v_mfma_f32_16x16x32_bf16 v[68:71], v[84:87], v[168:171], v[68:71]
    v_mfma_f32_16x16x32_bf16 v[72:75], v[80:83], v[232:235], v[72:75]
    v_mfma_f32_16x16x32_bf16 v[76:79], v[84:87], v[232:235], v[76:79]
    ds_read_b128 v[80:83], v10 offset:768
    ds_read_b128 v[84:87], v10 offset:17152
    s_waitcnt lgkmcnt(2)
    v_mfma_f32_16x16x32_bf16 v[48:51], a[172:175], v[88:91], v[48:51]
    v_mfma_f32_16x16x32_bf16 v[52:55], a[172:175], v[92:95], v[52:55]
    v_mfma_f32_16x16x32_bf16 v[56:59], a[236:239], v[88:91], v[56:59]
    v_mfma_f32_16x16x32_bf16 v[60:63], a[236:239], v[92:95], v[60:63]
    v_mfma_f32_16x16x32_bf16 v[64:67], v[88:91], v[172:175], v[64:67]
    v_mfma_f32_16x16x32_bf16 v[68:71], v[92:95], v[172:175], v[68:71]
    v_mfma_f32_16x16x32_bf16 v[72:75], v[88:91], v[236:239], v[72:75]
    v_mfma_f32_16x16x32_bf16 v[76:79], v[92:95], v[236:239], v[76:79]
    ds_read_b128 v[88:91], v11 offset:768
    ds_read_b128 v[92:95], v11 offset:17152
    s_waitcnt lgkmcnt(2)
    v_mfma_f32_16x16x32_bf16 v[48:51], a[176:179], v[80:83], v[48:51]
    v_mfma_f32_16x16x32_bf16 v[52:55], a[176:179], v[84:87], v[52:55]
    v_mfma_f32_16x16x32_bf16 v[56:59], a[240:243], v[80:83], v[56:59]
    v_mfma_f32_16x16x32_bf16 v[60:63], a[240:243], v[84:87], v[60:63]
    v_mfma_f32_16x16x32_bf16 v[64:67], v[80:83], v[176:179], v[64:67]
    v_mfma_f32_16x16x32_bf16 v[68:71], v[84:87], v[176:179], v[68:71]
    v_mfma_f32_16x16x32_bf16 v[72:75], v[80:83], v[240:243], v[72:75]
    v_mfma_f32_16x16x32_bf16 v[76:79], v[84:87], v[240:243], v[76:79]
    global_load_dword v8, v5, s[52:53] sc1
    ds_read_b128 v[80:83], v12 offset:768
    ds_read_b128 v[84:87], v12 offset:17152
    s_waitcnt lgkmcnt(2)
    v_mfma_f32_16x16x32_bf16 v[48:51], a[180:183], v[88:91], v[48:51]
    v_mfma_f32_16x16x32_bf16 v[52:55], a[180:183], v[92:95], v[52:55]
    v_mfma_f32_16x16x32_bf16 v[56:59], a[244:247], v[88:91], v[56:59]
    v_mfma_f32_16x16x32_bf16 v[60:63], a[244:247], v[92:95], v[60:63]
    v_mfma_f32_16x16x32_bf16 v[64:67], v[88:91], v[180:183], v[64:67]
    v_mfma_f32_16x16x32_bf16 v[68:71], v[92:95], v[180:183], v[68:71]
    v_mfma_f32_16x16x32_bf16 v[72:75], v[88:91], v[244:247], v[72:75]
    v_mfma_f32_16x16x32_bf16 v[76:79], v[92:95], v[244:247], v[76:79]
    ds_read_b128 v[88:91], v13 offset:768
    ds_read_b128 v[92:95], v13 offset:17152
    s_waitcnt lgkmcnt(2)
    v_mfma_f32_16x16x32_bf16 v[48:51], a[184:187], v[80:83], v[48:51]
    v_mfma_f32_16x16x32_bf16 v[52:55], a[184:187], v[84:87], v[52:55]
    v_mfma_f32_16x16x32_bf16 v[56:59], a[248:251], v[80:83], v[56:59]
    v_mfma_f32_16x16x32_bf16 v[60:63], a[248:251], v[84:87], v[60:63]
    v_mfma_f32_16x16x32_bf16 v[64:67], v[80:83], v[184:187], v[64:67]
    v_mfma_f32_16x16x32_bf16 v[68:71], v[84:87], v[184:187], v[68:71]
    v_mfma_f32_16x16x32_bf16 v[72:75], v[80:83], v[248:251], v[72:75]
    v_mfma_f32_16x16x32_bf16 v[76:79], v[84:87], v[248:251], v[76:79]
    ds_read_b128 v[80:83], v10 offset:0
    ds_read_b128 v[84:87], v10 offset:16384
    s_waitcnt lgkmcnt(2)
    v_mfma_f32_16x16x32_bf16 v[48:51], a[188:191], v[88:91], v[48:51]
    v_mfma_f32_16x16x32_bf16 v[52:55], a[188:191], v[92:95], v[52:55]
    v_mfma_f32_16x16x32_bf16 v[56:59], a[252:255], v[88:91], v[56:59]
    v_mfma_f32_16x16x32_bf16 v[60:63], a[252:255], v[92:95], v[60:63]
    v_mfma_f32_16x16x32_bf16 v[64:67], v[88:91], v[188:191], v[64:67]
    v_mfma_f32_16x16x32_bf16 v[68:71], v[92:95], v[188:191], v[68:71]
    v_mfma_f32_16x16x32_bf16 v[72:75], v[88:91], v[252:255], v[72:75]
    v_mfma_f32_16x16x32_bf16 v[76:79], v[92:95], v[252:255], v[76:79]
    ds_read_b128 v[88:91], v11 offset:0
    ds_read_b128 v[92:95], v11 offset:16384
    s_waitcnt lgkmcnt(2)
    v_mfma_f32_16x16x32_bf16 v[32:35], a[0:3], v[80:83], 0
    v_mfma_f32_16x16x32_bf16 v[36:39], a[0:3], v[84:87], 0
    v_mfma_f32_16x16x32_bf16 v[40:43], a[64:67], v[80:83], 0
    v_mfma_f32_16x16x32_bf16 v[44:47], a[64:67], v[84:87], 0
    ds_read_b128 v[80:83], v12 offset:0
    ds_read_b128 v[84:87], v12 offset:16384
    s_waitcnt lgkmcnt(2)
    v_mfma_f32_16x16x32_bf16 v[32:35], a[4:7], v[88:91], v[32:35]
    v_mfma_f32_16x16x32_bf16 v[36:39], a[4:7], v[92:95], v[36:39]
    v_mfma_f32_16x16x32_bf16 v[40:43], a[68:71], v[88:91], v[40:43]
    v_mfma_f32_16x16x32_bf16 v[44:47], a[68:71], v[92:95], v[44:47]
    v_cvt_pk_bf16_f32 v96, v48, v49
    v_cvt_pk_bf16_f32 v97, v50, v51
    v_cvt_pk_bf16_f32 v98, v56, v57
    v_cvt_pk_bf16_f32 v99, v58, v59
    v_min_u32 v96, -2, v96
    global_store_dwordx4 v4, v[96:99], s[58:59] sc1
    ds_read_b128 v[88:91], v13 offset:0
    ds_read_b128 v[92:95], v13 offset:16384
    s_waitcnt lgkmcnt(2)
    v_mfma_f32_16x16x32_bf16 v[32:35], a[8:11], v[80:83], v[32:35]
    v_mfma_f32_16x16x32_bf16 v[36:39], a[8:11], v[84:87], v[36:39]
    v_mfma_f32_16x16x32_bf16 v[40:43], a[72:75], v[80:83], v[40:43]
    v_mfma_f32_16x16x32_bf16 v[44:47], a[72:75], v[84:87], v[44:47]
    v_cvt_pk_bf16_f32 v100, v52, v53
    v_cvt_pk_bf16_f32 v101, v54, v55
    v_cvt_pk_bf16_f32 v102, v60, v61
    v_cvt_pk_bf16_f32 v103, v62, v63
    v_min_u32 v100, -2, v100
    s_add_u32 s58, s58, 0x1000
    s_addc_u32 s59, s59, 0
    global_store_dwordx4 v4, v[100:103], s[58:59] sc1
    ds_read_b128 v[80:83], v10 offset:256
    ds_read_b128 v[84:87], v10 offset:16640
    s_waitcnt lgkmcnt(2)
    v_mfma_f32_16x16x32_bf16 v[32:35], a[12:15], v[88:91], v[32:35]
    v_mfma_f32_16x16x32_bf16 v[36:39], a[12:15], v[92:95], v[36:39]
    v_mfma_f32_16x16x32_bf16 v[40:43], a[76:79], v[88:91], v[40:43]
    v_mfma_f32_16x16x32_bf16 v[44:47], a[76:79], v[92:95], v[44:47]
    v_cvt_pk_bf16_f32 v104, v64, v65
    v_cvt_pk_bf16_f32 v105, v66, v67
    v_cvt_pk_bf16_f32 v106, v68, v69
    v_cvt_pk_bf16_f32 v107, v70, v71
    v_min_u32 v104, -2, v104
    global_store_dwordx4 v2, v[104:107], s[60:61] offset:0 sc1
    ds_read_b128 v[88:91], v11 offset:256
    ds_read_b128 v[92:95], v11 offset:16640
    s_waitcnt lgkmcnt(2)
    v_mfma_f32_16x16x32_bf16 v[32:35], a[16:19], v[80:83], v[32:35]
    v_mfma_f32_16x16x32_bf16 v[36:39], a[16:19], v[84:87], v[36:39]
    v_mfma_f32_16x16x32_bf16 v[40:43], a[80:83], v[80:83], v[40:43]
    v_mfma_f32_16x16x32_bf16 v[44:47], a[80:83], v[84:87], v[44:47]
    v_cvt_pk_bf16_f32 v108, v72, v73
    v_cvt_pk_bf16_f32 v109, v74, v75
    v_cvt_pk_bf16_f32 v110, v76, v77
    v_cvt_pk_bf16_f32 v111, v78, v79
    v_min_u32 v108, -2, v108
    global_store_dwordx4 v2, v[108:111], s[60:61] offset:1024 sc1
    ds_read_b128 v[80:83], v12 offset:256
    ds_read_b128 v[84:87], v12 offset:16640
    s_waitcnt lgkmcnt(2)
    v_mfma_f32_16x16x32_bf16 v[32:35], a[20:23], v[88:91], v[32:35]
    v_mfma_f32_16x16x32_bf16 v[36:39], a[20:23], v[92:95], v[36:39]
    v_mfma_f32_16x16x32_bf16 v[40:43], a[84:87], v[88:91], v[40:43]
    v_mfma_f32_16x16x32_bf16 v[44:47], a[84:87], v[92:95], v[44:47]
    s_waitcnt vmcnt(4)
    v_cmp_eq_u32 vcc, 0, v8
    s_mov_b32 s51, 0
    s_cmp_ge_u32 s50, 64
    s_cbranch_scc1 L_p1_nopre
    s_cbranch_vccnz L_p1_nopre
    s_lshl_b32 s40, s48, 6
    s_add_u32 s40, s40, s50
    s_lshl_b32 s41, s40, 15
    s_lshl_b32 s42, s34, 13
    s_add_u32 s41, s41, s42
    s_add_u32 s41, s41, 0x800000
    s_add_u32 s54, s4, s41
    s_addc_u32 s55, s5, 0
    s_add_u32 s56, s54, 0x1000
    s_addc_u32 s57, s55, 0
    s_add_u32 s43, s66, 0
    s_mov_b32 m0, s43
    s_nop 0
    global_load_lds_dwordx4 v3, s[54:55] offset:0 sc1
    global_load_lds_dwordx4 v3, s[54:55] offset:1024 sc1
    global_load_lds_dwordx4 v3, s[54:55] offset:2048 sc1
    global_load_lds_dwordx4 v3, s[54:55] offset:3072 sc1
    s_add_u32 s43, s66, 4096
    s_mov_b32 m0, s43
    s_nop 0
    global_load_lds_dwordx4 v3, s[56:57] offset:0 sc1
    global_load_lds_dwordx4 v3, s[56:57] offset:1024 sc1
    global_load_lds_dwordx4 v3, s[56:57] offset:2048 sc1
    global_load_lds_dwordx4 v3, s[56:57] offset:3072 sc1
    s_xor_b32 s66, s66, 32768
    s_mov_b32 s51, 1
L_p1_nopre:
    ds_read_b128 v[88:91], v13 offset:256
    ds_read_b128 v[92:95], v13 offset:16640
    s_waitcnt lgkmcnt(2)
    v_mfma_f32_16x16x32_bf16 v[32:35], a[24:27], v[80:83], v[32:35]
    v_mfma_f32_16x16x32_bf16 v[36:39], a[24:27], v[84:87], v[36:39]
    v_mfma_f32_16x16x32_bf16 v[40:43], a[88:91], v[80:83], v[40:43]
    v_mfma_f32_16x16x32_bf16 v[44:47], a[88:91], v[84:87], v[44:47]
    ds_read_b128 v[80:83], v10 offset:512
    ds_read_b128 v[84:87], v10 offset:16896
    s_waitcnt lgkmcnt(2)
    v_mfma_f32_16x16x32_bf16 v[32:35], a[28:31], v[88:91], v[32:35]
    v_mfma_f32_16x16x32_bf16 v[36:39], a[28:31], v[92:95], v[36:39]
    v_mfma_f32_16x16x32_bf16 v[40:43], a[92:95], v[88:91], v[40:43]
    v_mfma_f32_16x16x32_bf16 v[44:47], a[92:95], v[92:95], v[44:47]
    ds_read_b128 v[88:91], v11 offset:512
    ds_read_b128 v[92:95], v11 offset:16896
    s_waitcnt lgkmcnt(2)
    v_mfma_f32_16x16x32_bf16 v[32:35], a[32:35], v[80:83], v[32:35]
    v_mfma_f32_16x16x32_bf16 v[36:39], a[32:35], v[84:87], v[36:39]
    v_mfma_f32_16x16x32_bf16 v[40:43], a[96:99], v[80:83], v[40:43]
    v_mfma_f32_16x16x32_bf16 v[44:47], a[96:99], v[84:87], v[44:47]
    ds_read_b128 v[80:83], v12 offset:512
    ds_read_b128 v[84:87], v12 offset:16896
    s_waitcnt lgkmcnt(2)
    v_mfma_f32_16x16x32_bf16 v[32:35], a[36:39], v[88:91], v[32:35]
    v_mfma_f32_16x16x32_bf16 v[36:39], a[36:39], v[92:95], v[36:39]
    v_mfma_f32_16x16x32_bf16 v[40:43], a[100:103], v[88:91], v[40:43]
    v_mfma_f32_16x16x32_bf16 v[44:47], a[100:103], v[92:95], v[44:47]
    ds_read_b128 v[88:91], v13 offset:512
    ds_read_b128 v[92:95], v13 offset:16896
    s_waitcnt lgkmcnt(2)
    v_mfma_f32_16x16x32_bf16 v[32:35], a[40:43], v[80:83], v[32:35]
    v_mfma_f32_16x16x32_bf16 v[36:39], a[40:43], v[84:87], v[36:39]
    v_mfma_f32_16x16x32_bf16 v[40:43], a[104:107], v[80:83], v[40:43]
    v_mfma_f32_16x16x32_bf16 v[44:47], a[104:107], v[84:87], v[44:47]
    ds_read_b128 v[80:83], v10 offset:768
    ds_read_b128 v[84:87], v10 offset:17152
    s_waitcnt lgkmcnt(2)
    v_mfma_f32_16x16x32_bf16 v[32:35], a[44:47], v[88:91], v[32:35]
    v_mfma_f32_16x16x32_bf16 v[36:39], a[44:47], v[92:95], v[36:39]
    v_mfma_f32_16x16x32_bf16 v[40:43], a[108:111], v[88:91], v[40:43]
    v_mfma_f32_16x16x32_bf16 v[44:47], a[108:111], v[92:95], v[44:47]
    ds_read_b128 v[88:91], v11 offset:768
    ds_read_b128 v[92:95], v11 offset:17152
    s_waitcnt lgkmcnt(2)
    v_mfma_f32_16x16x32_bf16 v[32:35], a[48:51], v[80:83], v[32:35]
    v_mfma_f32_16x16x32_bf16 v[36:39], a[48:51], v[84:87], v[36:39]
    v_mfma_f32_16x16x32_bf16 v[40:43], a[112:115], v[80:83], v[40:43]
    v_mfma_f32_16x16x32_bf16 v[44:47], a[112:115], v[84:87], v[44:47]
    ds_read_b128 v[80:83], v12 offset:768
    ds_read_b128 v[84:87], v12 offset:17152
    s_waitcnt lgkmcnt(2)
    v_mfma_f32_16x16x32_bf16 v[32:35], a[52:55], v[88:91], v[32:35]
    v_mfma_f32_16x16x32_bf16 v[36:39], a[52:55], v[92:95], v[36:39]
    v_mfma_f32_16x16x32_bf16 v[40:43], a[116:119], v[88:91], v[40:43]
    v_mfma_f32_16x16x32_bf16 v[44:47], a[116:119], v[92:95], v[44:47]
    ds_read_b128 v[88:91], v13 offset:768
    ds_read_b128 v[92:95], v13 offset:17152
    s_waitcnt lgkmcnt(2)
    v_mfma_f32_16x16x32_bf16 v[32:35], a[56:59], v[80:83], v[32:35]
    v_mfma_f32_16x16x32_bf16 v[36:39], a[56:59], v[84:87], v[36:39]
    v_mfma_f32_16x16x32_bf16 v[40:43], a[120:123], v[80:83], v[40:43]
    v_mfma_f32_16x16x32_bf16 v[44:47], a[120:123], v[84:87], v[44:47]
    s_waitcnt lgkmcnt(0)
    v_mfma_f32_16x16x32_bf16 v[32:35], a[60:63], v[88:91], v[32:35]
    v_mfma_f32_16x16x32_bf16 v[36:39], a[60:63], v[92:95], v[36:39]
    v_mfma_f32_16x16x32_bf16 v[40:43], a[124:127], v[88:91], v[40:43]
    v_mfma_f32_16x16x32_bf16 v[44:47], a[124:127], v[92:95], v[44:47]
    v_xor_b32 v10, 32768, v10
    v_xor_b32 v11, 32768, v11
    v_xor_b32 v12, 32768, v12
    v_xor_b32 v13, 32768, v13
    s_nop 3
    v_cvt_pk_bf16_f32 v112, v32, v33
    v_cvt_pk_bf16_f32 v113, v34, v35
    v_cvt_pk_bf16_f32 v114, v40, v41
    v_cvt_pk_bf16_f32 v115, v42, v43
    v_cvt_pk_bf16_f32 v116, v36, v37
    v_cvt_pk_bf16_f32 v117, v38, v39
    v_cvt_pk_bf16_f32 v118, v44, v45
    v_cvt_pk_bf16_f32 v119, v46, v47
    s_waitcnt vmcnt(0)
    v_mov_b32 v16, 65536
    v_mov_b32 v17, 1
    s_mov_b64 exec, 1
    ds_add_rtn_u32 v16, v16, v17
    s_waitcnt lgkmcnt(0)
    v_readfirstlane_b32 s40, v16
    s_and_b32 s40, s40, 3
    s_cmp_lg_u32 s40, 3
    s_cbranch_scc1 Lsg_122
    global_store_dword v6, v7, s[64:65] sc1
    global_store_dword v6, v7, s[68:69] sc1
Lsg_122:
    s_mov_b64 exec, -1
    global_store_dwordx4 v4, v[112:115], s[62:63] sc1
    s_add_u32 s62, s62, 0x1000
    s_addc_u32 s63, s63, 0
    global_store_dwordx4 v4, v[116:119], s[62:63] sc1
    s_add_u32 s68, s64, 0xc000
    s_addc_u32 s69, s65, 0
    s_mov_b32 s49, s50
    s_cmp_eq_u32 s51, 1
    s_cbranch_scc1 L_p1_loop
    s_cmp_ge_u32 s49, 64
    s_cbranch_scc1 L_p1_flush
Lwf_123:
    global_load_dword v16, v5, s[52:53] sc1
    s_waitcnt vmcnt(0)
    v_cmp_eq_u32 vcc, 0, v16
    s_cbranch_vccz Lwo_124
    s_sleep 1
    s_add_u32 s101, s101, 1
    s_cmp_gt_u32 s101, 0x40000
    s_cbranch_scc1 L_end
    s_branch Lwf_123
Lwo_124:
    s_lshl_b32 s40, s48, 6
    s_add_u32 s40, s40, s49
    s_lshl_b32 s41, s40, 15
    s_lshl_b32 s42, s34, 13
    s_add_u32 s41, s41, s42
    s_add_u32 s41, s41, 0x800000
    s_add_u32 s54, s4, s41
    s_addc_u32 s55, s5, 0
    s_add_u32 s56, s54, 0x1000
    s_addc_u32 s57, s55, 0
    s_add_u32 s43, s66, 0
    s_mov_b32 m0, s43
    s_nop 0
    global_load_lds_dwordx4 v3, s[54:55] offset:0 sc1
    global_load_lds_dwordx4 v3, s[54:55] offset:1024 sc1
    global_load_lds_dwordx4 v3, s[54:55] offset:2048 sc1
    global_load_lds_dwordx4 v3, s[54:55] offset:3072 sc1
    s_add_u32 s43, s66, 4096
    s_mov_b32 m0, s43
    s_nop 0
    global_load_lds_dwordx4 v3, s[56:57] offset:0 sc1
    global_load_lds_dwordx4 v3, s[56:57] offset:1024 sc1
    global_load_lds_dwordx4 v3, s[56:57] offset:2048 sc1
    global_load_lds_dwordx4 v3, s[56:57] offset:3072 sc1
    s_xor_b32 s66, s66, 32768
    s_waitcnt vmcnt(0)
    s_branch L_p1_loop
L_p1_flush:
    s_waitcnt vmcnt(0)
    v_mov_b32 v16, 65540
    v_mov_b32 v17, 1
    s_mov_b64 exec, 1
    ds_add_rtn_u32 v16, v16, v17
    s_waitcnt lgkmcnt(0)
    v_readfirstlane_b32 s40, v16
    s_and_b32 s40, s40, 3
    s_cmp_lg_u32 s40, 3
    s_cbranch_scc1 Lsg_125
    global_store_dword v6, v7, s[68:69] sc1
Lsg_125:
    s_mov_b64 exec, -1
L_p1_next:
    s_add_u32 s48, s48, 1
    s_cmp_lt_u32 s48, 2
    s_cbranch_scc1 L_p1_layer
    s_branch L_end
L_p2:
    s_barrier
    v_and_b32 v40, 63, v0
    v_and_b32 v41, 15, v0
    v_bfe_u32 v42, v0, 4, 2
    v_lshlrev_b32 v1, 4, v40
    v_mov_b32 v3, v1
    s_lshl_b32 s40, s34, 11
    v_add_u32 v2, s40, v1
    s_mov_b32 s75, s40
    s_lshl_b32 s41, s34, 8
    v_lshlrev_b32 v8, 15, v42
    v_lshl_add_u32 v8, v41, 4, v8
    v_add_u32 v8, s41, v8
    s_lshl_b32 s41, s34, 13
    s_add_u32 s41, s41, 65536
    v_add_u32 v43, 0, v42
    v_xor_b32 v43, v43, v41
    v_lshlrev_b32 v43, 4, v43
    v_lshl_add_u32 v43, v41, 8, v43
    v_add_u32 v208, s41, v43
    v_lshlrev_b32 v44, 8, v42
    v_lshl_add_u32 v43, v43, 0, v44
    v_lshlrev_b32 v44, 8, v41
    v_sub_u32 v43, v43, v44
    v_add_u32 v212, s41, v43
    v_add_u32 v43, 4, v42
    v_xor_b32 v43, v43, v41
    v_lshlrev_b32 v43, 4, v43
    v_lshl_add_u32 v43, v41, 8, v43
    v_add_u32 v209, s41, v43
    v_lshlrev_b32 v44, 8, v42
    v_lshl_add_u32 v43, v43, 0, v44
    v_lshlrev_b32 v44, 8, v41
    v_sub_u32 v43, v43, v44
    v_add_u32 v213, s41, v43
    v_add_u32 v43, 8, v42
    v_xor_b32 v43, v43, v41
    v_lshlrev_b32 v43, 4, v43
    v_lshl_add_u32 v43, v41, 8, v43
    v_add_u32 v210, s41, v43
    v_lshlrev_b32 v44, 8, v42
    v_lshl_add_u32 v43, v43, 0, v44
    v_lshlrev_b32 v44, 8, v41
    v_sub_u32 v43, v43, v44
    v_add_u32 v214, s41, v43
    v_add_u32 v43, 12, v42
    v_xor_b32 v43, v43, v41
    v_lshlrev_b32 v43, 4, v43
    v_lshl_add_u32 v43, v41, 8, v43
    v_add_u32 v211, s41, v43
    v_lshlrev_b32 v44, 8, v42
    v_lshl_add_u32 v43, v43, 0, v44
    v_lshlrev_b32 v44, 8, v41
    v_sub_u32 v43, v43, v44
    v_add_u32 v215, s41, v43
    s_lshl_b32 s40, s34, 10
    v_lshlrev_b32 v5, 3, v40
    v_lshlrev_b32 v6, 5, v41
    v_lshl_add_u32 v6, v42, 3, v6
    v_add_u32 v6, s40, v6
    v_and_b32 v4, 1, v0
    v_mul_u32_u24 v4, 0xc000, v4
    s_and_b32 s42, s34, 1
    s_lshr_b32 s43, s34, 1
    s_lshl_b32 s40, s42, 12
    v_add_u32 v24, s40, v1
    s_lshl_b32 s41, s43, 11
    v_add_u32 v26, s41, v24
    s_lshl_b32 s41, s43, 12
    v_add_u32 v25, s41, v1
    v_add_u32 v27, 8, v25
    s_lshl_b32 s40, s42, 4
    v_add_u32 v43, s40, v41
    v_lshlrev_b32 v44, 2, v42
    v_mov_b32 v46, 0xf149f2ca
    v_add_u32 v45, 0, v44
    v_cmp_gt_u32 vcc, v45, v43
    s_nop 1
    v_cndmask_b32 v16, 0, v46, vcc
    v_add_u32 v45, 1, v44
    v_cmp_gt_u32 vcc, v45, v43
    s_nop 1
    v_cndmask_b32 v17, 0, v46, vcc
    v_add_u32 v45, 2, v44
    v_cmp_gt_u32 vcc, v45, v43
    s_nop 1
    v_cndmask_b32 v18, 0, v46, vcc
    v_add_u32 v45, 3, v44
    v_cmp_gt_u32 vcc, v45, v43
    s_nop 1
    v_cndmask_b32 v19, 0, v46, vcc
    v_add_u32 v45, 16, v44
    v_cmp_gt_u32 vcc, v45, v43
    s_nop 1
    v_cndmask_b32 v20, 0, v46, vcc
    v_add_u32 v45, 17, v44
    v_cmp_gt_u32 vcc, v45, v43
    s_nop 1
    v_cndmask_b32 v21, 0, v46, vcc
    v_add_u32 v45, 18, v44
    v_cmp_gt_u32 vcc, v45, v43
    s_nop 1
    v_cndmask_b32 v22, 0, v46, vcc
    v_add_u32 v45, 19, v44
    v_cmp_gt_u32 vcc, v45, v43
    s_nop 1
    v_cndmask_b32 v23, 0, v46, vcc
    v_mov_b64 v[28:29], 0
    v_mov_b64 v[30:31], 0
    v_and_b32 v45, 1, v0
    v_lshlrev_b32 v45, 4, v45
    v_mov_b32 v46, 0x3f80
    v_lshlrev_b32 v46, v45, v46
    v_bfe_u32 v45, v0, 1, 2
    v_cmp_eq_u32 vcc, 0, v45
    s_nop 1
    v_cndmask_b32 v12, 0, v46, vcc
    v_cmp_eq_u32 vcc, 1, v45
    s_nop 1
    v_cndmask_b32 v13, 0, v46, vcc
    v_cmp_eq_u32 vcc, 2, v45
    s_nop 1
    v_cndmask_b32 v14, 0, v46, vcc
    v_cmp_eq_u32 vcc, 3, v45
    s_nop 1
    v_cndmask_b32 v15, 0, v46, vcc
    v_and_b32 v45, 15, v0
    v_bfe_u32 v46, v0, 4, 2
    s_lshl_b32 s40, s34, 8
    v_lshlrev_b32 v9, 10, v46
    v_lshl_add_u32 v9, v45, 4, v9
    v_add_u32 v9, s40, v9
    v_and_b32 v46, 1, v46
    v_lshlrev_b32 v10, 3, v46
    v_lshl_add_u32 v10, v45, 4, v10
    v_add_u32 v10, s40, v10
    v_and_b32 v11, 31, v0
    v_lshlrev_b32 v11, 2, v11
    s_mov_b32 s51, 0x3e0293ee
    v_lshrrev_b32 v45, 2, v40
    v_lshlrev_b32 v45, 10, v45
    v_and_b32 v46, 3, v40
    v_lshl_add_u32 v45, v46, 4, v45
    s_lshl_b32 s40, s33, 17
    s_lshl_b32 s41, s34, 8
    s_add_u32 s40, s40, s41
    v_add_u32 v45, s40, v45
    s_lshl_b32 s46, s34, 15
    s_add_u32 s52, s24, 0x0
    s_addc_u32 s53, s25, 0
    s_add_u32 s44, s46, 0
    s_mov_b32 m0, s44
    s_nop 0
    global_load_lds_dwordx4 v45, s[52:53]
    s_add_u32 s52, s24, 0x4000
    s_addc_u32 s53, s25, 0
    s_add_u32 s44, s46, 1024
    s_mov_b32 m0, s44
    s_nop 0
    global_load_lds_dwordx4 v45, s[52:53]
    s_add_u32 s52, s24, 0x8000
    s_addc_u32 s53, s25, 0
    s_add_u32 s44, s46, 2048
    s_mov_b32 m0, s44
    s_nop 0
    global_load_lds_dwordx4 v45, s[52:53]
    s_add_u32 s52, s24, 0xc000
    s_addc_u32 s53, s25, 0
    s_add_u32 s44, s46, 3072
    s_mov_b32 m0, s44
    s_nop 0
    global_load_lds_dwordx4 v45, s[52:53]
    s_add_u32 s52, s24, 0x10000
    s_addc_u32 s53, s25, 0
    s_add_u32 s44, s46, 4096
    s_mov_b32 m0, s44
    s_nop 0
    global_load_lds_dwordx4 v45, s[52:53]
    s_add_u32 s52, s24, 0x14000
    s_addc_u32 s53, s25, 0
    s_add_u32 s44, s46, 5120
    s_mov_b32 m0, s44
    s_nop 0
    global_load_lds_dwordx4 v45, s[52:53]
    s_add_u32 s52, s24, 0x18000
    s_addc_u32 s53, s25, 0
    s_add_u32 s44, s46, 6144
    s_mov_b32 m0, s44
    s_nop 0
    global_load_lds_dwordx4 v45, s[52:53]
    s_add_u32 s52, s24, 0x1c000
    s_addc_u32 s53, s25, 0
    s_add_u32 s44, s46, 7168
    s_mov_b32 m0, s44
    s_nop 0
    global_load_lds_dwordx4 v45, s[52:53]
    s_add_u32 s52, s24, 0x40
    s_addc_u32 s53, s25, 0
    s_add_u32 s44, s46, 8192
    s_mov_b32 m0, s44
    s_nop 0
    global_load_lds_dwordx4 v45, s[52:53]
    s_add_u32 s52, s24, 0x4040
    s_addc_u32 s53, s25, 0
    s_add_u32 s44, s46, 9216
    s_mov_b32 m0, s44
    s_nop 0
    global_load_lds_dwordx4 v45, s[52:53]
    s_add_u32 s52, s24, 0x8040
    s_addc_u32 s53, s25, 0
    s_add_u32 s44, s46, 10240
    s_mov_b32 m0, s44
    s_nop 0
    global_load_lds_dwordx4 v45, s[52:53]
    s_add_u32 s52, s24, 0xc040
    s_addc_u32 s53, s25, 0
    s_add_u32 s44, s46, 11264
    s_mov_b32 m0, s44
    s_nop 0
    global_load_lds_dwordx4 v45, s[52:53]
    s_add_u32 s52, s24, 0x10040
    s_addc_u32 s53, s25, 0
    s_add_u32 s44, s46, 12288
    s_mov_b32 m0, s44
    s_nop 0
    global_load_lds_dwordx4 v45, s[52:53]
    s_add_u32 s52, s24, 0x14040
    s_addc_u32 s53, s25, 0
    s_add_u32 s44, s46, 13312
    s_mov_b32 m0, s44
    s_nop 0
    global_load_lds_dwordx4 v45, s[52:53]
    s_add_u32 s52, s24, 0x18040
    s_addc_u32 s53, s25, 0
    s_add_u32 s44, s46, 14336
    s_mov_b32 m0, s44
    s_nop 0
    global_load_lds_dwordx4 v45, s[52:53]
    s_add_u32 s52, s24, 0x1c040
    s_addc_u32 s53, s25, 0
    s_add_u32 s44, s46, 15360
    s_mov_b32 m0, s44
    s_nop 0
    global_load_lds_dwordx4 v45, s[52:53]
    s_add_u32 s52, s24, 0x80
    s_addc_u32 s53, s25, 0
    s_add_u32 s44, s46, 16384
    s_mov_b32 m0, s44
    s_nop 0
    global_load_lds_dwordx4 v45, s[52:53]
    s_add_u32 s52, s24, 0x4080
    s_addc_u32 s53, s25, 0
    s_add_u32 s44, s46, 17408
    s_mov_b32 m0, s44
    s_nop 0
    global_load_lds_dwordx4 v45, s[52:53]
    s_add_u32 s52, s24, 0x8080
    s_addc_u32 s53, s25, 0
    s_add_u32 s44, s46, 18432
    s_mov_b32 m0, s44
    s_nop 0
    global_load_lds_dwordx4 v45, s[52:53]
    s_add_u32 s52, s24, 0xc080
    s_addc_u32 s53, s25, 0
    s_add_u32 s44, s46, 19456
    s_mov_b32 m0, s44
    s_nop 0
    global_load_lds_dwordx4 v45, s[52:53]
    s_add_u32 s52, s24, 0x10080
    s_addc_u32 s53, s25, 0
    s_add_u32 s44, s46, 20480
    s_mov_b32 m0, s44
    s_nop 0
    global_load_lds_dwordx4 v45, s[52:53]
    s_add_u32 s52, s24, 0x14080
    s_addc_u32 s53, s25, 0
    s_add_u32 s44, s46, 21504
    s_mov_b32 m0, s44
    s_nop 0
    global_load_lds_dwordx4 v45, s[52:53]
    s_add_u32 s52, s24, 0x18080
    s_addc_u32 s53, s25, 0
    s_add_u32 s44, s46, 22528
    s_mov_b32 m0, s44
    s_nop 0
    global_load_lds_dwordx4 v45, s[52:53]
    s_add_u32 s52, s24, 0x1c080
    s_addc_u32 s53, s25, 0
    s_add_u32 s44, s46, 23552
    s_mov_b32 m0, s44
    s_nop 0
    global_load_lds_dwordx4 v45, s[52:53]
    s_add_u32 s52, s24, 0xc0
    s_addc_u32 s53, s25, 0
    s_add_u32 s44, s46, 24576
    s_mov_b32 m0, s44
    s_nop 0
    global_load_lds_dwordx4 v45, s[52:53]
    s_add_u32 s52, s24, 0x40c0
    s_addc_u32 s53, s25, 0
    s_add_u32 s44, s46, 25600
    s_mov_b32 m0, s44
    s_nop 0
    global_load_lds_dwordx4 v45, s[52:53]
    s_add_u32 s52, s24, 0x80c0
    s_addc_u32 s53, s25, 0
    s_add_u32 s44, s46, 26624
    s_mov_b32 m0, s44
    s_nop 0
    global_load_lds_dwordx4 v45, s[52:53]
    s_add_u32 s52, s24, 0xc0c0
    s_addc_u32 s53, s25, 0
    s_add_u32 s44, s46, 27648
    s_mov_b32 m0, s44
    s_nop 0
    global_load_lds_dwordx4 v45, s[52:53]
    s_add_u32 s52, s24, 0x100c0
    s_addc_u32 s53, s25, 0
    s_add_u32 s44, s46, 28672
    s_mov_b32 m0, s44
    s_nop 0
    global_load_lds_dwordx4 v45, s[52:53]
    s_add_u32 s52, s24, 0x140c0
    s_addc_u32 s53, s25, 0
    s_add_u32 s44, s46, 29696
    s_mov_b32 m0, s44
    s_nop 0
    global_load_lds_dwordx4 v45, s[52:53]
    s_add_u32 s52, s24, 0x180c0
    s_addc_u32 s53, s25, 0
    s_add_u32 s44, s46, 30720
    s_mov_b32 m0, s44
    s_nop 0
    global_load_lds_dwordx4 v45, s[52:53]
    s_add_u32 s52, s24, 0x1c0c0
    s_addc_u32 s53, s25, 0
    s_add_u32 s44, s46, 31744
    s_mov_b32 m0, s44
    s_nop 0
    global_load_lds_dwordx4 v45, s[52:53]
    v_bfe_u32 v47, v0, 2, 2
    v_add_u32 v47, v47, v44
    v_lshlrev_b32 v47, 6, v47
    v_lshl_add_u32 v47, v46, 4, v47
    v_add_u32 v47, s46, v47
    s_waitcnt vmcnt(24)
    ds_read_b64_tr_b16 a[0:1], v47 offset:0
    ds_read_b64_tr_b16 a[2:3], v47 offset:1024
    ds_read_b64_tr_b16 a[4:5], v47 offset:2048
    ds_read_b64_tr_b16 a[6:7], v47 offset:3072
    ds_read_b64_tr_b16 a[8:9], v47 offset:4096
    ds_read_b64_tr_b16 a[10:11], v47 offset:5120
    ds_read_b64_tr_b16 a[12:13], v47 offset:6144
    ds_read_b64_tr_b16 a[14:15], v47 offset:7168
    ds_read_b64_tr_b16 a[16:17], v47 offset:8
    ds_read_b64_tr_b16 a[18:19], v47 offset:1032
    ds_read_b64_tr_b16 a[20:21], v47 offset:2056
    ds_read_b64_tr_b16 a[22:23], v47 offset:3080
    ds_read_b64_tr_b16 a[24:25], v47 offset:4104
    ds_read_b64_tr_b16 a[26:27], v47 offset:5128
    ds_read_b64_tr_b16 a[28:29], v47 offset:6152
    ds_read_b64_tr_b16 a[30:31], v47 offset:7176
    s_waitcnt lgkmcnt(0)
    s_waitcnt vmcnt(16)
    ds_read_b64_tr_b16 a[32:33], v47 offset:8192
    ds_read_b64_tr_b16 a[34:35], v47 offset:9216
    ds_read_b64_tr_b16 a[36:37], v47 offset:10240
    ds_read_b64_tr_b16 a[38:39], v47 offset:11264
    ds_read_b64_tr_b16 a[40:41], v47 offset:12288
    ds_read_b64_tr_b16 a[42:43], v47 offset:13312
    ds_read_b64_tr_b16 a[44:45], v47 offset:14336
    ds_read_b64_tr_b16 a[46:47], v47 offset:15360
    ds_read_b64_tr_b16 a[48:49], v47 offset:8200
    ds_read_b64_tr_b16 a[50:51], v47 offset:9224
    ds_read_b64_tr_b16 a[52:53], v47 offset:10248
    ds_read_b64_tr_b16 a[54:55], v47 offset:11272
    ds_read_b64_tr_b16 a[56:57], v47 offset:12296
    ds_read_b64_tr_b16 a[58:59], v47 offset:13320
    ds_read_b64_tr_b16 a[60:61], v47 offset:14344
    ds_read_b64_tr_b16 a[62:63], v47 offset:15368
    s_waitcnt lgkmcnt(0)
    s_waitcnt vmcnt(8)
    ds_read_b64_tr_b16 a[64:65], v47 offset:16384
    ds_read_b64_tr_b16 a[66:67], v47 offset:17408
    ds_read_b64_tr_b16 a[68:69], v47 offset:18432
    ds_read_b64_tr_b16 a[70:71], v47 offset:19456
    ds_read_b64_tr_b16 a[72:73], v47 offset:20480
    ds_read_b64_tr_b16 a[74:75], v47 offset:21504
    ds_read_b64_tr_b16 a[76:77], v47 offset:22528
    ds_read_b64_tr_b16 a[78:79], v47 offset:23552
    ds_read_b64_tr_b16 a[80:81], v47 offset:16392
    ds_read_b64_tr_b16 a[82:83], v47 offset:17416
    ds_read_b64_tr_b16 a[84:85], v47 offset:18440
    ds_read_b64_tr_b16 a[86:87], v47 offset:19464
    ds_read_b64_tr_b16 a[88:89], v47 offset:20488
    ds_read_b64_tr_b16 a[90:91], v47 offset:21512
    ds_read_b64_tr_b16 a[92:93], v47 offset:22536
    ds_read_b64_tr_b16 a[94:95], v47 offset:23560
    s_waitcnt lgkmcnt(0)
    s_waitcnt vmcnt(0)
    ds_read_b64_tr_b16 a[96:97], v47 offset:24576
    ds_read_b64_tr_b16 a[98:99], v47 offset:25600
    ds_read_b64_tr_b16 a[100:101], v47 offset:26624
    ds_read_b64_tr_b16 a[102:103], v47 offset:27648
    ds_read_b64_tr_b16 a[104:105], v47 offset:28672
    ds_read_b64_tr_b16 a[106:107], v47 offset:29696
    ds_read_b64_tr_b16 a[108:109], v47 offset:30720
    ds_read_b64_tr_b16 a[110:111], v47 offset:31744
    ds_read_b64_tr_b16 a[112:113], v47 offset:24584
    ds_read_b64_tr_b16 a[114:115], v47 offset:25608
    ds_read_b64_tr_b16 a[116:117], v47 offset:26632
    ds_read_b64_tr_b16 a[118:119], v47 offset:27656
    ds_read_b64_tr_b16 a[120:121], v47 offset:28680
    ds_read_b64_tr_b16 a[122:123], v47 offset:29704
    ds_read_b64_tr_b16 a[124:125], v47 offset:30728
    ds_read_b64_tr_b16 a[126:127], v47 offset:31752
    s_waitcnt lgkmcnt(0)
    s_barrier
    s_mov_b32 s48, 0
    s_mov_b32 s77, 0
    s_mov_b64 s[78:79], s[4:5]
    v_lshrrev_b32 v217, 2, v1
    v_mov_b32 v218, 1
L_p2_layer:
    s_sub_u32 s49, s32, 3
    s_lshl_b32 s41, s48, 5
    s_add_u32 s41, s41, s33
    s_lshl_b32 s41, s41, 6
    s_add_u32 s41, s41, s49
    s_lshl_b32 s41, s41, 2
    s_add_u32 s41, s41, 0x10000
    s_add_u32 s68, s4, s41
    s_addc_u32 s69, s5, 0
    s_mov_b64 s[80:81], 0
    s_mov_b32 s76, 0
    s_mov_b32 s44, 0
    s_lshl_b32 s41, s48, 5
    s_add_u32 s41, s41, s33
    s_lshl_b32 s41, s41, 6
    s_add_u32 s41, s41, s44
    s_lshl_b32 s41, s41, 2
    s_add_u32 s41, s41, 0x14000
    s_add_u32 s64, s4, s41
    s_addc_u32 s65, s5, 0
Lwf_126:
    global_load_dword v32, v4, s[68:69] sc1
    s_waitcnt vmcnt(0)
    v_cmp_eq_u32 vcc, 0, v32
    s_cbranch_vccz Lwo_127
    s_sleep 2
    s_add_u32 s101, s101, 1
    s_cmp_gt_u32 s101, 0x40000
    s_cbranch_scc1 L_end
    s_branch Lwf_126
Lwo_127:
    s_lshl_b32 s40, s48, 6
    s_add_u32 s40, s40, s49
    s_lshl_b32 s45, s40, 5
    s_add_u32 s45, s45, s33
    s_lshl_b32 s45, s45, 13
    s_add_u32 s41, s45, 0x8000000
    s_add_u32 s42, s4, s41
    s_addc_u32 s43, s5, 0
    s_add_u32 s44, s75, 0
    s_mov_b32 m0, s44
    s_nop 0
    global_load_lds_dwordx4 v2, s[42:43] sc1
    global_load_lds_dwordx4 v2, s[42:43] offset:1024 sc1
    s_add_u32 s41, s45, 0x4000000
    s_add_u32 s42, s4, s41
    s_addc_u32 s43, s5, 0
    s_add_u32 s44, s75, 8192
    s_mov_b32 m0, s44
    s_nop 0
    global_load_lds_dwordx4 v2, s[42:43] sc1
    global_load_lds_dwordx4 v2, s[42:43] offset:1024 sc1
    s_add_u32 s41, s45, 0x6000000
    s_add_u32 s42, s4, s41
    s_addc_u32 s43, s5, 0
    s_add_u32 s44, s75, 16384
    s_mov_b32 m0, s44
    s_nop 0
    global_load_lds_dwordx4 v2, s[42:43] sc1
    global_load_lds_dwordx4 v2, s[42:43] offset:1024 sc1
    s_cmp_ge_u32 s75, 24576
    s_mov_b32 s44, 24576
    s_cselect_b32 s44, -24576, s44
    s_add_u32 s75, s75, s44
    s_waitcnt vmcnt(0)
L_p2_loop:
    s_lshl_b32 s40, s48, 6
    s_add_u32 s40, s40, s49
    s_lshl_b32 s66, s40, 5
    s_add_u32 s66, s66, s33
    s_lshl_b32 s66, s66, 13
    s_mov_b32 s47, s40
    s_add_u32 s67, s49, 3
    s_cmp_eq_u32 s49, 60
    s_cselect_b32 s67, 62, s67
    s_cmp_eq_u32 s49, 59
    s_cselect_b32 s67, 63, s67
    s_min_u32 s44, s67, 63
    s_lshl_b32 s41, s48, 5
    s_add_u32 s41, s41, s33
    s_lshl_b32 s41, s41, 6
    s_add_u32 s41, s41, s44
    s_lshl_b32 s41, s41, 2
    s_add_u32 s41, s41, 0x10000
    s_add_u32 s68, s4, s41
    s_addc_u32 s69, s5, 0
    s_add_u32 s41, s66, 0xa040000
    s_add_u32 s52, s4, s41
    s_addc_u32 s53, s5, 0
    s_sub_u32 s41, s67, s49
    s_lshl_b32 s41, s41, 18
    s_add_u32 s82, s52, s41
    s_addc_u32 s83, s53, 0
    s_lshl_b32 s41, s32, 22
    s_add_u32 s41, s41, s84
    s_add_u32 s41, s41, 0x2000000
    s_add_u32 s54, s4, s41
    s_addc_u32 s55, s5, 0
    s_add_u32 s84, s84, 0x100000
    s_cmp_eq_u32 s84, 0x200000
    s_cselect_b32 s84, 0, s84
    s_lshl_b32 s41, s33, 10
    s_add_u32 s56, s54, s41
    s_addc_u32 s57, s55, 0
    s_lshl_b32 s41, s33, 15
    s_add_u32 s54, s54, s41
    s_addc_u32 s55, s55, 0
    s_lshl_b32 s41, s47, 7
    s_add_u32 s41, s41, 0x8000
    s_add_u32 s60, s4, s41
    s_addc_u32 s61, s5, 0
    s_lshl_b32 s41, s49, 5
    s_add_u32 s41, s41, s33
    s_lshl_b32 s42, s41, 10
    s_lshl_b32 s43, s48, 21
    s_add_u32 s43, s43, s42
    s_add_u32 s43, s43, 0x400000
    s_add_u32 s44, s4, s43
    s_addc_u32 s45, s5, 0
    global_load_dwordx2 v[180:181], v10, s[44:45] sc1
    s_add_u32 s43, s42, 0xe00000
    s_add_u32 s72, s4, s43
    s_addc_u32 s73, s5, 0
    s_lshl_b32 s41, s41, 2
    s_add_u32 s41, s41, 0x4000
    s_add_u32 s62, s4, s41
    s_addc_u32 s63, s5, 0
    s_add_u32 s43, s42, 0xc00000
    s_add_u32 s70, s4, s43
    s_addc_u32 s71, s5, 0
    s_cmp_eq_u32 s48, 0
    s_cbranch_scc1 L_p2_x2
    s_add_u32 s70, s28, s42
    s_addc_u32 s71, s29, 0
L_p2_x2:
    global_load_dword v7, v4, s[68:69] sc1
    s_barrier
    v_add_u32 v116, v3, v24
    v_sub_u32 v116, v116, v1
    v_add_u32 v117, v3, v25
    v_sub_u32 v117, v117, v1
    ds_read_b128 v[32:35], v116 offset:0
    ds_read_b128 v[36:39], v116 offset:1024
    ds_read_b128 v[40:43], v116 offset:2048
    ds_read_b128 v[44:47], v116 offset:3072
    ds_read_b128 v[64:67], v3 offset:8192
    ds_read_b128 v[68:71], v3 offset:9216
    ds_read_b128 v[72:75], v3 offset:10240
    ds_read_b128 v[76:79], v3 offset:11264
    ds_read_b128 v[80:83], v3 offset:12288
    ds_read_b128 v[84:87], v3 offset:13312
    ds_read_b128 v[88:91], v3 offset:14336
    ds_read_b128 v[92:95], v3 offset:15360
    v_mov_b32 v99, 0
    s_waitcnt lgkmcnt(4)
    v_mfma_f32_16x16x32_bf16 v[108:111], v[64:67], v[32:35], v[16:19]
    v_mfma_f32_16x16x32_bf16 v[108:111], v[68:71], v[36:39], v[108:111]
    v_mfma_f32_16x16x32_bf16 v[108:111], v[72:75], v[40:43], v[108:111]
    v_mfma_f32_16x16x32_bf16 v[108:111], v[76:79], v[44:47], v[108:111]
    s_waitcnt lgkmcnt(0)
    ds_read_b128 v[128:131], v117 offset:16384
    ds_read_b128 v[132:135], v117 offset:17408
    ds_read_b128 v[136:139], v117 offset:18432
    ds_read_b128 v[140:143], v117 offset:19456
    v_mfma_f32_16x16x32_bf16 v[112:115], v[80:83], v[32:35], v[20:23]
    v_mfma_f32_16x16x32_bf16 v[112:115], v[84:87], v[36:39], v[112:115]
    v_mfma_f32_16x16x32_bf16 v[112:115], v[88:91], v[40:43], v[112:115]
    v_mfma_f32_16x16x32_bf16 v[112:115], v[92:95], v[44:47], v[112:115]
    s_cmp_eq_u32 s76, 0
    s_cbranch_scc1 L_p2_kmwait
    v_mov_b64 v[96:97], v[220:221]
    v_mov_b64 v[100:101], v[222:223]
    v_mov_b64 v[102:103], v[224:225]
    global_load_dword v216, v217, s[64:65] sc1
L_p2_kmok:
    v_mov_b32 v98, v97
    v_mov_b32 v97, 0
    ds_write_b64 v6, v[96:97] offset:49152
    ds_write_b64 v6, v[98:99] offset:49664
    s_waitcnt lgkmcnt(0)
    s_barrier
    ds_read_b64_tr_b16 v[48:49], v5 offset:49152
    ds_read_b64_tr_b16 v[50:51], v5 offset:49664
    ds_read_b64_tr_b16 v[52:53], v5 offset:50176
    ds_read_b64_tr_b16 v[54:55], v5 offset:50688
    ds_read_b64_tr_b16 v[56:57], v5 offset:51200
    ds_read_b64_tr_b16 v[58:59], v5 offset:51712
    ds_read_b64_tr_b16 v[60:61], v5 offset:52224
    ds_read_b64_tr_b16 v[62:63], v5 offset:52736
    s_waitcnt lgkmcnt(0)
    v_mfma_f32_16x16x32_bf16 v[104:107], v[48:51], v[32:35], 0
    v_mfma_f32_16x16x32_bf16 v[104:107], v[52:55], v[36:39], v[104:107]
    v_mfma_f32_16x16x32_bf16 v[104:107], v[56:59], v[40:43], v[104:107]
    v_mfma_f32_16x16x32_bf16 v[104:107], v[60:63], v[44:47], v[104:107]
    v_max3_f32 v116, v108, v109, v110
    v_max3_f32 v117, v111, v112, v113
    v_max3_f32 v116, v116, v114, v115
    v_xor_b32 v3, 24576, v3
    s_nop 3
    v_max3_f32 v117, v117, v104, v105
    v_max_f32 v118, v116, v117
    v_max_f32 v119, v116, v117
    s_nop 1
    v_permlane32_swap_b32 v118, v119
    v_max_f32 v116, v118, v119
    v_max_f32 v117, v118, v119
    s_nop 1
    v_permlane16_swap_b32 v116, v117
    v_max_f32 v116, v116, v117
    v_mul_f32 v116, s51, v116
    v_fma_f32 v108, v108, s51, -v116
    v_fma_f32 v109, v109, s51, -v116
    v_fma_f32 v110, v110, s51, -v116
    v_fma_f32 v111, v111, s51, -v116
    v_fma_f32 v112, v112, s51, -v116
    v_fma_f32 v113, v113, s51, -v116
    v_fma_f32 v114, v114, s51, -v116
    v_fma_f32 v115, v115, s51, -v116
    v_fma_f32 v104, v104, s51, -v116
    v_fma_f32 v105, v105, s51, -v116
    v_exp_f32 v108, v108
    v_exp_f32 v109, v109
    v_exp_f32 v110, v110
    v_exp_f32 v111, v111
    v_exp_f32 v112, v112
    v_exp_f32 v113, v113
    v_exp_f32 v114, v114
    v_exp_f32 v115, v115
    v_exp_f32 v104, v104
    v_exp_f32 v105, v105
    v_cvt_pk_bf16_f32 v124, v108, v109
    v_cvt_pk_bf16_f32 v125, v110, v111
    v_cvt_pk_bf16_f32 v126, v112, v113
    v_cvt_pk_bf16_f32 v127, v114, v115
    v_cvt_pk_bf16_f32 v28, v104, v105
    v_cvt_pk_bf16_f32 v31, v104, v105
    v_mfma_f32_16x16x32_bf16 v[64:67], v[128:131], v[124:127], 0
    v_mfma_f32_16x16x32_bf16 v[68:71], v[132:135], v[124:127], 0
    v_mfma_f32_16x16x32_bf16 v[72:75], v[136:139], v[124:127], 0
    v_mfma_f32_16x16x32_bf16 v[76:79], v[140:143], v[124:127], 0
    v_add_f32 v120, v108, v109
    v_add_f32 v121, v110, v111
    v_add_f32 v120, v120, v112
    v_add_f32 v121, v121, v113
    v_add_f32 v120, v120, v114
    v_add_f32 v121, v121, v115
    v_add_f32 v120, v120, v104
    v_add_f32 v121, v121, v105
    v_mfma_f32_16x16x16_bf16 v[64:67], v[100:101], v[28:29], v[64:67]
    v_mfma_f32_16x16x16_bf16 v[68:71], v[100:101], v[30:31], v[68:71]
    v_mfma_f32_16x16x16_bf16 v[72:75], v[102:103], v[28:29], v[72:75]
    v_mfma_f32_16x16x16_bf16 v[76:79], v[102:103], v[30:31], v[76:79]
    v_add_f32 v120, v120, v121
    v_mov_b32 v121, v120
    s_nop 1
    v_permlane32_swap_b32 v120, v121
    v_add_f32 v120, v120, v121
    v_mov_b32 v121, v120
    s_nop 1
    v_permlane16_swap_b32 v120, v121
    v_add_f32 v120, v120, v121
    v_rcp_f32 v120, v120
    s_nop 0
    v_pk_mul_f32 v[64:65], v[64:65], v[120:121] op_sel_hi:[1,0]
    v_pk_mul_f32 v[66:67], v[66:67], v[120:121] op_sel_hi:[1,0]
    v_pk_mul_f32 v[68:69], v[68:69], v[120:121] op_sel_hi:[1,0]
    v_pk_mul_f32 v[70:71], v[70:71], v[120:121] op_sel_hi:[1,0]
    v_pk_mul_f32 v[72:73], v[72:73], v[120:121] op_sel_hi:[1,0]
    v_pk_mul_f32 v[74:75], v[74:75], v[120:121] op_sel_hi:[1,0]
    v_pk_mul_f32 v[76:77], v[76:77], v[120:121] op_sel_hi:[1,0]
    v_pk_mul_f32 v[78:79], v[78:79], v[120:121] op_sel_hi:[1,0]
    v_cvt_pk_bf16_f32 v32, v64, v65
    v_cvt_pk_bf16_f32 v33, v66, v67
    v_cvt_pk_bf16_f32 v34, v68, v69
    v_cvt_pk_bf16_f32 v35, v70, v71
    ds_write_b128 v26, v[32:35] offset:53248
    v_cvt_pk_bf16_f32 v36, v72, v73
    v_cvt_pk_bf16_f32 v37, v74, v75
    v_cvt_pk_bf16_f32 v38, v76, v77
    v_cvt_pk_bf16_f32 v39, v78, v79
    ds_write_b128 v26, v[36:39] offset:54272
    s_mov_b32 s74, 0
    s_mov_b32 s76, 0
    s_waitcnt vmcnt(0)
    v_cmp_eq_u32 vcc, 0, v7
    s_cmp_eq_u32 s77, 0
    s_cbranch_scc1 Lfd_128
    s_mov_b64 exec, 1
    global_store_dword v1, v218, s[78:79] sc1
    s_mov_b64 exec, -1
    s_mov_b32 s77, 0
Lfd_128:
    v_cmp_ne_u32 s[80:81], 0, v216
    s_cmp_ge_u32 s67, 64
    s_cbranch_scc1 L_p2_nopre
    s_cbranch_vccnz L_p2_nopre
    s_lshl_b32 s40, s48, 6
    s_add_u32 s40, s40, s67
    s_lshl_b32 s45, s40, 5
    s_add_u32 s45, s45, s33
    s_lshl_b32 s45, s45, 13
    s_add_u32 s41, s45, 0x8000000
    s_add_u32 s42, s4, s41
    s_addc_u32 s43, s5, 0
    s_add_u32 s44, s75, 0
    s_mov_b32 m0, s44
    s_nop 0
    global_load_lds_dwordx4 v2, s[42:43] sc1
    global_load_lds_dwordx4 v2, s[42:43] offset:1024 sc1
    s_add_u32 s41, s45, 0x4000000
    s_add_u32 s42, s4, s41
    s_addc_u32 s43, s5, 0
    s_add_u32 s44, s75, 8192
    s_mov_b32 m0, s44
    s_nop 0
    global_load_lds_dwordx4 v2, s[42:43] sc1
    global_load_lds_dwordx4 v2, s[42:43] offset:1024 sc1
    s_add_u32 s41, s45, 0x6000000
    s_add_u32 s42, s4, s41
    s_addc_u32 s43, s5, 0
    s_add_u32 s44, s75, 16384
    s_mov_b32 m0, s44
    s_nop 0
    global_load_lds_dwordx4 v2, s[42:43] sc1
    global_load_lds_dwordx4 v2, s[42:43] offset:1024 sc1
    s_cmp_ge_u32 s75, 24576
    s_mov_b32 s44, 24576
    s_cselect_b32 s44, -24576, s44
    s_add_u32 s75, s75, s44
    s_mov_b32 s74, 1
    s_bitcmp0_b64 s[80:81], s67
    s_cbranch_scc1 L_p2_nopre
    global_load_dwordx2 v[220:221], v2, s[82:83] sc1
    global_load_dwordx2 v[222:223], v27, s[82:83] sc1
    global_load_dwordx2 v[224:225], v27, s[82:83] offset:2048 sc1
    s_mov_b32 s76, 1
L_p2_nopre:
    s_waitcnt lgkmcnt(0)
    s_barrier
    ds_read_b128 v[32:35], v1 offset:53248
    ds_read_b128 v[48:51], v1 offset:57344
    ds_read_b128 v[36:39], v1 offset:54272
    ds_read_b128 v[52:55], v1 offset:58368
    ds_read_b128 v[40:43], v1 offset:55296
    ds_read_b128 v[56:59], v1 offset:59392
    ds_read_b128 v[44:47], v1 offset:56320
    ds_read_b128 v[60:63], v1 offset:60416
    s_waitcnt lgkmcnt(6)
    v_mfma_f32_16x16x32_bf16 v[64:67], a[0:3], v[32:35], 0
    v_mfma_f32_16x16x32_bf16 v[72:75], a[0:3], v[48:51], 0
    v_mfma_f32_16x16x32_bf16 v[68:71], a[16:19], v[32:35], 0
    v_mfma_f32_16x16x32_bf16 v[76:79], a[16:19], v[48:51], 0
    s_waitcnt lgkmcnt(4)
    v_mfma_f32_16x16x32_bf16 v[64:67], a[4:7], v[36:39], v[64:67]
    v_mfma_f32_16x16x32_bf16 v[72:75], a[4:7], v[52:55], v[72:75]
    v_mfma_f32_16x16x32_bf16 v[68:71], a[20:23], v[36:39], v[68:71]
    v_mfma_f32_16x16x32_bf16 v[76:79], a[20:23], v[52:55], v[76:79]
    s_waitcnt lgkmcnt(2)
    v_mfma_f32_16x16x32_bf16 v[64:67], a[8:11], v[40:43], v[64:67]
    v_mfma_f32_16x16x32_bf16 v[72:75], a[8:11], v[56:59], v[72:75]
    v_mfma_f32_16x16x32_bf16 v[68:71], a[24:27], v[40:43], v[68:71]
    v_mfma_f32_16x16x32_bf16 v[76:79], a[24:27], v[56:59], v[76:79]
    s_waitcnt lgkmcnt(0)
    v_mfma_f32_16x16x32_bf16 v[64:67], a[12:15], v[44:47], v[64:67]
    v_mfma_f32_16x16x32_bf16 v[72:75], a[12:15], v[60:63], v[72:75]
    v_mfma_f32_16x16x32_bf16 v[68:71], a[28:31], v[44:47], v[68:71]
    v_mfma_f32_16x16x32_bf16 v[76:79], a[28:31], v[60:63], v[76:79]
    v_mfma_f32_16x16x32_bf16 v[80:83], a[32:35], v[32:35], 0
    v_mfma_f32_16x16x32_bf16 v[88:91], a[32:35], v[48:51], 0
    v_mfma_f32_16x16x32_bf16 v[84:87], a[48:51], v[32:35], 0
    v_mfma_f32_16x16x32_bf16 v[92:95], a[48:51], v[48:51], 0
    v_mfma_f32_16x16x32_bf16 v[80:83], a[36:39], v[36:39], v[80:83]
    v_mfma_f32_16x16x32_bf16 v[88:91], a[36:39], v[52:55], v[88:91]
    v_cvt_pk_bf16_f32 v64, v64, v65
    v_mfma_f32_16x16x32_bf16 v[84:87], a[52:55], v[36:39], v[84:87]
    v_cvt_pk_bf16_f32 v65, v66, v67
    v_mfma_f32_16x16x32_bf16 v[92:95], a[52:55], v[52:55], v[92:95]
    v_cvt_pk_bf16_f32 v66, v68, v69
    v_mfma_f32_16x16x32_bf16 v[80:83], a[40:43], v[40:43], v[80:83]
    v_cvt_pk_bf16_f32 v67, v70, v71
    v_mfma_f32_16x16x32_bf16 v[88:91], a[40:43], v[56:59], v[88:91]
    ds_write_b128 v208, v[64:67] offset:0
    v_mfma_f32_16x16x32_bf16 v[84:87], a[56:59], v[40:43], v[84:87]
    v_cvt_pk_bf16_f32 v72, v72, v73
    v_mfma_f32_16x16x32_bf16 v[92:95], a[56:59], v[56:59], v[92:95]
    v_cvt_pk_bf16_f32 v73, v74, v75
    v_mfma_f32_16x16x32_bf16 v[80:83], a[44:47], v[44:47], v[80:83]
    v_cvt_pk_bf16_f32 v74, v76, v77
    v_mfma_f32_16x16x32_bf16 v[88:91], a[44:47], v[60:63], v[88:91]
    v_cvt_pk_bf16_f32 v75, v78, v79
    v_mfma_f32_16x16x32_bf16 v[84:87], a[60:63], v[44:47], v[84:87]
    ds_write_b128 v208, v[72:75] offset:4096
    v_mfma_f32_16x16x32_bf16 v[92:95], a[60:63], v[60:63], v[92:95]
    v_mfma_f32_16x16x32_bf16 v[96:99], a[64:67], v[32:35], 0
    v_mfma_f32_16x16x32_bf16 v[104:107], a[64:67], v[48:51], 0
    v_mfma_f32_16x16x32_bf16 v[100:103], a[80:83], v[32:35], 0
    v_mfma_f32_16x16x32_bf16 v[108:111], a[80:83], v[48:51], 0
    v_mfma_f32_16x16x32_bf16 v[96:99], a[68:71], v[36:39], v[96:99]
    v_mfma_f32_16x16x32_bf16 v[104:107], a[68:71], v[52:55], v[104:107]
    v_cvt_pk_bf16_f32 v80, v80, v81
    v_mfma_f32_16x16x32_bf16 v[100:103], a[84:87], v[36:39], v[100:103]
    v_cvt_pk_bf16_f32 v81, v82, v83
    v_mfma_f32_16x16x32_bf16 v[108:111], a[84:87], v[52:55], v[108:111]
    v_cvt_pk_bf16_f32 v82, v84, v85
    v_mfma_f32_16x16x32_bf16 v[96:99], a[72:75], v[40:43], v[96:99]
    v_cvt_pk_bf16_f32 v83, v86, v87
    v_mfma_f32_16x16x32_bf16 v[104:107], a[72:75], v[56:59], v[104:107]
    ds_write_b128 v209, v[80:83] offset:0
    v_mfma_f32_16x16x32_bf16 v[100:103], a[88:91], v[40:43], v[100:103]
    v_cvt_pk_bf16_f32 v88, v88, v89
    v_mfma_f32_16x16x32_bf16 v[108:111], a[88:91], v[56:59], v[108:111]
    v_cvt_pk_bf16_f32 v89, v90, v91
    v_mfma_f32_16x16x32_bf16 v[96:99], a[76:79], v[44:47], v[96:99]
    v_cvt_pk_bf16_f32 v90, v92, v93
    v_mfma_f32_16x16x32_bf16 v[104:107], a[76:79], v[60:63], v[104:107]
    v_cvt_pk_bf16_f32 v91, v94, v95
    v_mfma_f32_16x16x32_bf16 v[100:103], a[92:95], v[44:47], v[100:103]
    ds_write_b128 v209, v[88:91] offset:4096
    v_mfma_f32_16x16x32_bf16 v[108:111], a[92:95], v[60:63], v[108:111]
    v_mfma_f32_16x16x32_bf16 v[112:115], a[96:99], v[32:35], 0
    v_mfma_f32_16x16x32_bf16 v[120:123], a[96:99], v[48:51], 0
    v_mfma_f32_16x16x32_bf16 v[116:119], a[112:115], v[32:35], 0
    v_mfma_f32_16x16x32_bf16 v[124:127], a[112:115], v[48:51], 0
    v_mfma_f32_16x16x32_bf16 v[112:115], a[100:103], v[36:39], v[112:115]
    v_mfma_f32_16x16x32_bf16 v[120:123], a[100:103], v[52:55], v[120:123]
    v_cvt_pk_bf16_f32 v96, v96, v97
    v_mfma_f32_16x16x32_bf16 v[116:119], a[116:119], v[36:39], v[116:119]
    v_cvt_pk_bf16_f32 v97, v98, v99
    v_mfma_f32_16x16x32_bf16 v[124:127], a[116:119], v[52:55], v[124:127]
    v_cvt_pk_bf16_f32 v98, v100, v101
    v_mfma_f32_16x16x32_bf16 v[112:115], a[104:107], v[40:43], v[112:115]
    v_cvt_pk_bf16_f32 v99, v102, v103
    v_mfma_f32_16x16x32_bf16 v[120:123], a[104:107], v[56:59], v[120:123]
    ds_write_b128 v210, v[96:99] offset:0
    v_mfma_f32_16x16x32_bf16 v[116:119], a[120:123], v[40:43], v[116:119]
    v_cvt_pk_bf16_f32 v104, v104, v105
    v_mfma_f32_16x16x32_bf16 v[124:127], a[120:123], v[56:59], v[124:127]
    v_cvt_pk_bf16_f32 v105, v106, v107
    v_mfma_f32_16x16x32_bf16 v[112:115], a[108:111], v[44:47], v[112:115]
    v_cvt_pk_bf16_f32 v106, v108, v109
    v_mfma_f32_16x16x32_bf16 v[120:123], a[108:111], v[60:63], v[120:123]
    v_cvt_pk_bf16_f32 v107, v110, v111
    v_mfma_f32_16x16x32_bf16 v[116:119], a[124:127], v[44:47], v[116:119]
    ds_write_b128 v210, v[104:107] offset:4096
    v_mfma_f32_16x16x32_bf16 v[124:127], a[124:127], v[60:63], v[124:127]
    s_nop 7
    v_cvt_pk_bf16_f32 v112, v112, v113
    v_cvt_pk_bf16_f32 v113, v114, v115
    v_cvt_pk_bf16_f32 v114, v116, v117
    v_cvt_pk_bf16_f32 v115, v118, v119
    ds_write_b128 v211, v[112:115] offset:0
    v_cvt_pk_bf16_f32 v120, v120, v121
    v_cvt_pk_bf16_f32 v121, v122, v123
    v_cvt_pk_bf16_f32 v122, v124, v125
    v_cvt_pk_bf16_f32 v123, v126, v127
    ds_write_b128 v211, v[120:123] offset:4096
    ds_read_b128 v[32:35], v212 offset:0
    ds_read_b128 v[36:39], v213 offset:1024
    ds_read_b128 v[40:43], v214 offset:2048
    ds_read_b128 v[44:47], v215 offset:3072
    ds_read_b128 v[48:51], v212 offset:4096
    ds_read_b128 v[52:55], v213 offset:5120
    ds_read_b128 v[56:59], v214 offset:6144
    ds_read_b128 v[60:63], v215 offset:7168
    s_waitcnt lgkmcnt(7)
    s_cmp_lg_u32 s35, 0
    s_cbranch_scc1 Lmx_129
    global_store_dwordx4 v8, v[32:35], s[56:57]
Lmy_130:
    s_add_u32 s56, s56, 0x20000
    s_addc_u32 s57, s57, 0
    s_waitcnt lgkmcnt(6)
    s_cmp_lg_u32 s35, 0
    s_cbranch_scc1 Lmx_131
    global_store_dwordx4 v8, v[36:39], s[56:57]
Lmy_132:
    s_add_u32 s56, s56, 0x20000
    s_addc_u32 s57, s57, 0
    s_waitcnt lgkmcnt(5)
    s_cmp_lg_u32 s35, 0
    s_cbranch_scc1 Lmx_133
    global_store_dwordx4 v8, v[40:43], s[56:57]
Lmy_134:
    s_add_u32 s56, s56, 0x20000
    s_addc_u32 s57, s57, 0
    s_waitcnt lgkmcnt(4)
    s_cmp_lg_u32 s35, 0
    s_cbranch_scc1 Lmx_135
    global_store_dwordx4 v8, v[44:47], s[56:57]
Lmy_136:
    s_add_u32 s56, s56, 0x20000
    s_addc_u32 s57, s57, 0
    s_waitcnt lgkmcnt(3)
    s_cmp_lg_u32 s35, 0
    s_cbranch_scc1 Lmx_137
    global_store_dwordx4 v8, v[48:51], s[56:57]
Lmy_138:
    s_add_u32 s56, s56, 0x20000
    s_addc_u32 s57, s57, 0
    s_waitcnt lgkmcnt(2)
    s_cmp_lg_u32 s35, 0
    s_cbranch_scc1 Lmx_139
    global_store_dwordx4 v8, v[52:55], s[56:57]
Lmy_140:
    s_add_u32 s56, s56, 0x20000
    s_addc_u32 s57, s57, 0
    s_waitcnt lgkmcnt(1)
    s_cmp_lg_u32 s35, 0
    s_cbranch_scc1 Lmx_141
    global_store_dwordx4 v8, v[56:59], s[56:57]
Lmy_142:
    s_add_u32 s56, s56, 0x20000
    s_addc_u32 s57, s57, 0
    s_waitcnt lgkmcnt(0)
    s_cmp_lg_u32 s35, 0
    s_cbranch_scc1 Lmx_143
    global_store_dwordx4 v8, v[60:63], s[56:57]
Lmy_144:
    s_lshl_b32 s40, s33, 2
    v_mov_b32 v64, s40
    v_mov_b32 v65, 1
    s_waitcnt vmcnt(0)
    s_barrier
    s_cmp_lg_u32 s34, 1
    s_cbranch_scc1 Lpp_145
    s_mov_b64 exec, 1
    s_cmp_lg_u32 s35, 0
    s_cbranch_scc1 Lmx_146
    global_store_dword v64, v65, s[60:61]
Lmy_147:
    s_mov_b64 exec, -1
Lpp_145:
    v_add_u32 v193, 4096, v9
    v_add_u32 v194, 8192, v9
    v_add_u32 v195, 12288, v9
    v_add_u32 v196, 16384, v9
    v_add_u32 v197, 20480, v9
    v_add_u32 v198, 24576, v9
    v_add_u32 v199, 28672, v9
    s_and_b32 s41, s50, 1
    s_lshl_b32 s41, s41, 11
    s_add_u32 s41, s41, 61440
Lwf_148:
    global_load_dword v184, v11, s[60:61] sc1
    s_waitcnt vmcnt(0)
    v_cmp_eq_u32 vcc, 0, v184
    s_cbranch_vccz Lwo_149
    s_add_u32 s101, s101, 1
    s_cmp_gt_u32 s101, 0x40000
    s_cbranch_scc1 L_end
    s_branch Lwf_148
Lwo_149:
    global_load_dwordx4 v[144:147], v9, s[54:55] sc1
    global_load_dwordx4 v[148:151], v193, s[54:55] sc1
    global_load_dwordx4 v[152:155], v194, s[54:55] sc1
    global_load_dwordx4 v[156:159], v195, s[54:55] sc1
    global_load_dwordx4 v[160:163], v196, s[54:55] sc1
    global_load_dwordx4 v[164:167], v197, s[54:55] sc1
    global_load_dwordx4 v[168:171], v198, s[54:55] sc1
    global_load_dwordx4 v[172:175], v199, s[54:55] sc1
    v_lshlrev_b32 v184, 16, v180
    v_and_b32 v185, 0xffff0000, v180
    v_lshlrev_b32 v186, 16, v181
    v_and_b32 v187, 0xffff0000, v181
    s_add_u32 s42, s41, 32
    v_add_u32 v188, s42, v10
    v_add_u32 v190, s42, v1
    s_lshl_b32 s40, s34, 3
    s_add_u32 s40, s40, s41
    v_mov_b32 v189, s40
    v_mov_b32 v191, s41
    s_waitcnt vmcnt(7)
    v_mfma_f32_16x16x32_bf16 v[176:179], v[12:15], v[144:147], 0
    s_waitcnt vmcnt(6)
    v_mfma_f32_16x16x32_bf16 v[176:179], v[12:15], v[148:151], v[176:179]
    s_waitcnt vmcnt(5)
    v_mfma_f32_16x16x32_bf16 v[176:179], v[12:15], v[152:155], v[176:179]
    s_waitcnt vmcnt(4)
    v_mfma_f32_16x16x32_bf16 v[176:179], v[12:15], v[156:159], v[176:179]
    s_waitcnt vmcnt(3)
    v_mfma_f32_16x16x32_bf16 v[176:179], v[12:15], v[160:163], v[176:179]
    s_waitcnt vmcnt(2)
    v_mfma_f32_16x16x32_bf16 v[176:179], v[12:15], v[164:167], v[176:179]
    s_waitcnt vmcnt(1)
    v_mfma_f32_16x16x32_bf16 v[176:179], v[12:15], v[168:171], v[176:179]
    s_waitcnt vmcnt(0)
    v_mfma_f32_16x16x32_bf16 v[176:179], v[12:15], v[172:175], v[176:179]
    s_nop 7
    v_cvt_pk_bf16_f32 v180, v176, v177
    v_cvt_pk_bf16_f32 v181, v178, v179
    v_lshlrev_b32 v176, 16, v180
    v_and_b32 v177, 0xffff0000, v180
    v_lshlrev_b32 v178, 16, v181
    v_and_b32 v179, 0xffff0000, v181
    v_add_f32 v176, v176, v184
    v_add_f32 v177, v177, v185
    v_add_f32 v178, v178, v186
    v_add_f32 v179, v179, v187
    v_cvt_pk_bf16_f32 v180, v176, v177
    v_cvt_pk_bf16_f32 v181, v178, v179
    s_cmp_eq_u32 s48, 1
    s_cbranch_scc1 Lfin_151
    ds_write_b64 v188, v[180:181]
    v_lshlrev_b32 v176, 16, v180
    v_and_b32 v177, 0xffff0000, v180
    v_lshlrev_b32 v178, 16, v181
    v_and_b32 v179, 0xffff0000, v181
    v_add_f32 v184, v176, v177
    v_mul_f32 v185, v176, v176
    v_add_f32 v184, v184, v178
    v_fmac_f32 v185, v177, v177
    v_add_f32 v184, v184, v179
    v_fmac_f32 v185, v178, v178
    v_fmac_f32 v185, v179, v179
    s_nop 0
    s_nop 0
    v_add_f32_dpp v186, v184, v184 row_ror:8 row_mask:0xf bank_mask:0xf
    v_add_f32_dpp v187, v185, v185 row_ror:8 row_mask:0xf bank_mask:0xf
    s_nop 0
    v_add_f32_dpp v184, v186, v186 row_ror:4 row_mask:0xf bank_mask:0xf
    v_add_f32_dpp v185, v187, v187 row_ror:4 row_mask:0xf bank_mask:0xf
    s_nop 0
    v_add_f32_dpp v186, v184, v184 row_ror:2 row_mask:0xf bank_mask:0xf
    v_add_f32_dpp v187, v185, v185 row_ror:2 row_mask:0xf bank_mask:0xf
    s_nop 0
    v_add_f32_dpp v184, v186, v186 row_ror:1 row_mask:0xf bank_mask:0xf
    v_add_f32_dpp v185, v187, v187 row_ror:1 row_mask:0xf bank_mask:0xf
    v_mov_b64 v[186:187], v[184:185]
    s_nop 1
    v_permlane16_swap_b32 v184, v186
    v_permlane16_swap_b32 v185, v187
    v_pk_add_f32 v[184:185], v[184:185], v[186:187]
    ds_write_b64 v189, v[184:185]
    s_waitcnt lgkmcnt(0)
    s_barrier
    s_cmp_lg_u32 s34, 0
    s_cbranch_scc1 Lrdone_150
    ds_read_b128 v[152:155], v190 offset:0
    ds_read_b128 v[144:147], v191 offset:0
    ds_read_b128 v[148:151], v191 offset:16
    s_waitcnt lgkmcnt(2)
    global_store_dwordx4 v1, v[152:155], s[70:71] sc1
    v_lshlrev_b32 v160, 16, v152
    v_and_b32 v161, 0xffff0000, v152
    v_lshlrev_b32 v162, 16, v153
    v_and_b32 v163, 0xffff0000, v153
    v_lshlrev_b32 v164, 16, v154
    v_and_b32 v165, 0xffff0000, v154
    v_lshlrev_b32 v166, 16, v155
    v_and_b32 v167, 0xffff0000, v155
    s_waitcnt lgkmcnt(0)
    v_pk_add_f32 v[144:145], v[144:145], v[146:147]
    v_pk_add_f32 v[148:149], v[148:149], v[150:151]
    v_pk_add_f32 v[144:145], v[144:145], v[148:149]
    v_mul_f32 v184, 0x3b000000, v144
    v_mul_f32 v185, 0x3b000000, v145
    v_fma_f32 v185, -v184, v184, v185
    v_max_f32 v185, 0, v185
    v_cvt_pk_bf16_f32 v185, v185, v185
    v_and_b32 v185, 0xffff0000, v185
    v_add_f32 v185, 0x3727c5ac, v185
    v_cvt_pk_bf16_f32 v185, v185, v185
    v_and_b32 v185, 0xffff0000, v185
    v_sqrt_f32 v185, v185
    v_cvt_pk_bf16_f32 v184, v184, v184
    v_and_b32 v184, 0xffff0000, v184
    v_cvt_pk_bf16_f32 v185, v185, v185
    v_and_b32 v185, 0xffff0000, v185
    v_rcp_f32 v185, v185
    v_sub_f32 v160, v160, v184
    v_sub_f32 v161, v161, v184
    v_sub_f32 v162, v162, v184
    v_sub_f32 v163, v163, v184
    v_sub_f32 v164, v164, v184
    v_sub_f32 v165, v165, v184
    v_sub_f32 v166, v166, v184
    v_sub_f32 v167, v167, v184
    v_cvt_pk_bf16_f32 v156, v160, v161
    v_cvt_pk_bf16_f32 v157, v162, v163
    v_cvt_pk_bf16_f32 v158, v164, v165
    v_cvt_pk_bf16_f32 v159, v166, v167
    v_lshlrev_b32 v160, 16, v156
    v_and_b32 v161, 0xffff0000, v156
    v_lshlrev_b32 v162, 16, v157
    v_and_b32 v163, 0xffff0000, v157
    v_lshlrev_b32 v164, 16, v158
    v_and_b32 v165, 0xffff0000, v158
    v_lshlrev_b32 v166, 16, v159
    v_and_b32 v167, 0xffff0000, v159
    v_pk_mul_f32 v[160:161], v[160:161], v[184:185] op_sel:[0,1] op_sel_hi:[1,1]
    v_pk_mul_f32 v[162:163], v[162:163], v[184:185] op_sel:[0,1] op_sel_hi:[1,1]
    v_pk_mul_f32 v[164:165], v[164:165], v[184:185] op_sel:[0,1] op_sel_hi:[1,1]
    v_pk_mul_f32 v[166:167], v[166:167], v[184:185] op_sel:[0,1] op_sel_hi:[1,1]
    v_cvt_pk_bf16_f32 v156, v160, v161
    v_cvt_pk_bf16_f32 v157, v162, v163
    v_cvt_pk_bf16_f32 v158, v164, v165
    v_cvt_pk_bf16_f32 v159, v166, v167
    v_min_u32 v156, -2, v156
    s_and_b32 s40, s33, 15
    s_lshl_b32 s40, s40, 4
    v_xor_b32 v186, s40, v1
    global_store_dwordx4 v186, v[156:159], s[72:73] sc1
    s_mov_b64 s[78:79], s[62:63]
    s_mov_b32 s77, 1
Lrdone_150:
    s_add_u32 s50, s50, 1
    s_mov_b32 s49, s67
    s_cmp_eq_u32 s74, 1
    s_cbranch_scc1 L_p2_loop
    s_waitcnt vmcnt(0)
    s_cmp_eq_u32 s77, 0
    s_cbranch_scc1 Lfd_152
    s_mov_b64 exec, 1
    global_store_dword v1, v218, s[78:79] sc1
    s_mov_b64 exec, -1
    s_mov_b32 s77, 0
Lfd_152:
    s_cmp_ge_u32 s49, 64
    s_cbranch_scc1 L_p2_next
Lwf_153:
    global_load_dword v32, v4, s[68:69] sc1
    s_waitcnt vmcnt(0)
    v_cmp_eq_u32 vcc, 0, v32
    s_cbranch_vccz Lwo_154
    s_sleep 2
    s_add_u32 s101, s101, 1
    s_cmp_gt_u32 s101, 0x40000
    s_cbranch_scc1 L_end
    s_branch Lwf_153
Lwo_154:
    s_lshl_b32 s40, s48, 6
    s_add_u32 s40, s40, s49
    s_lshl_b32 s45, s40, 5
    s_add_u32 s45, s45, s33
    s_lshl_b32 s45, s45, 13
    s_add_u32 s41, s45, 0x8000000
    s_add_u32 s42, s4, s41
    s_addc_u32 s43, s5, 0
    s_add_u32 s44, s75, 0
    s_mov_b32 m0, s44
    s_nop 0
    global_load_lds_dwordx4 v2, s[42:43] sc1
    global_load_lds_dwordx4 v2, s[42:43] offset:1024 sc1
    s_add_u32 s41, s45, 0x4000000
    s_add_u32 s42, s4, s41
    s_addc_u32 s43, s5, 0
    s_add_u32 s44, s75, 8192
    s_mov_b32 m0, s44
    s_nop 0
    global_load_lds_dwordx4 v2, s[42:43] sc1
    global_load_lds_dwordx4 v2, s[42:43] offset:1024 sc1
    s_add_u32 s41, s45, 0x6000000
    s_add_u32 s42, s4, s41
    s_addc_u32 s43, s5, 0
    s_add_u32 s44, s75, 16384
    s_mov_b32 m0, s44
    s_nop 0
    global_load_lds_dwordx4 v2, s[42:43] sc1
    global_load_lds_dwordx4 v2, s[42:43] offset:1024 sc1
    s_cmp_ge_u32 s75, 24576
    s_mov_b32 s44, 24576
    s_cselect_b32 s44, -24576, s44
    s_add_u32 s75, s75, s44
    s_waitcnt vmcnt(0)
    s_branch L_p2_loop
L_p2_next:
    s_add_u32 s48, s48, 1
    s_cmp_lt_u32 s48, 2
    s_cbranch_scc1 L_p2_layer
    s_branch L_end
L_p2_kmlast:
    global_load_dwordx2 v[96:97], v2, s[52:53] sc1
    global_load_dwordx2 v[100:101], v27, s[52:53] sc1
    global_load_dwordx2 v[102:103], v27, s[52:53] offset:2048 sc1
    s_waitcnt vmcnt(0)
    s_cmp_eq_u32 s77, 0
    s_cbranch_scc1 Lfd_155
    s_mov_b64 exec, 1
    global_store_dword v1, v218, s[78:79] sc1
    s_mov_b64 exec, -1
    s_mov_b32 s77, 0
Lfd_155:
    v_max3_u32 v118, v96, v100, v102
    v_cmp_eq_u32 vcc, -1, v118
    s_cbranch_vccz L_p2_kmok
    s_sleep 1
    s_add_u32 s101, s101, 1
    s_cmp_gt_u32 s101, 0x40000
    s_cbranch_scc1 L_end
    s_branch L_p2_kmlast
L_p2_kmwait:
    s_cmp_ge_u32 s49, 55
    s_cbranch_scc1 L_p2_kmlast
    global_load_dword v216, v217, s[64:65] sc1
    s_waitcnt vmcnt(0)
    s_cmp_eq_u32 s77, 0
    s_cbranch_scc1 Lfd_156
    s_mov_b64 exec, 1
    global_store_dword v1, v218, s[78:79] sc1
    s_mov_b64 exec, -1
    s_mov_b32 s77, 0
Lfd_156:
    v_cmp_ne_u32 s[80:81], 0, v216
    s_bitcmp1_b64 s[80:81], s49
    s_cbranch_scc1 L_p2_kmgo
    s_sleep 8
    s_add_u32 s101, s101, 1
    s_cmp_gt_u32 s101, 0x40000
    s_cbranch_scc1 L_end
    s_branch L_p2_kmwait
L_p2_kmgo:
    global_load_dwordx2 v[96:97], v2, s[52:53] sc1
    global_load_dwordx2 v[100:101], v27, s[52:53] sc1
    global_load_dwordx2 v[102:103], v27, s[52:53] offset:2048 sc1
    s_waitcnt vmcnt(0)
    s_branch L_p2_kmok
Lmx_129:
    global_store_dwordx4 v8, v[32:35], s[56:57] sc1
    s_branch Lmy_130
Lmx_131:
    global_store_dwordx4 v8, v[36:39], s[56:57] sc1
    s_branch Lmy_132
Lmx_133:
    global_store_dwordx4 v8, v[40:43], s[56:57] sc1
    s_branch Lmy_134
Lmx_135:
    global_store_dwordx4 v8, v[44:47], s[56:57] sc1
    s_branch Lmy_136
Lmx_137:
    global_store_dwordx4 v8, v[48:51], s[56:57] sc1
    s_branch Lmy_138
Lmx_139:
    global_store_dwordx4 v8, v[52:55], s[56:57] sc1
    s_branch Lmy_140
Lmx_141:
    global_store_dwordx4 v8, v[56:59], s[56:57] sc1
    s_branch Lmy_142
Lmx_143:
    global_store_dwordx4 v8, v[60:63], s[56:57] sc1
    s_branch Lmy_144
Lmx_146:
    global_store_dword v64, v65, s[60:61] sc1
    s_branch Lmy_147
Lfin_151:
    global_store_dwordx2 v10, v[180:181], s[70:71]
    s_branch Lrdone_150
L_aworker:
    s_sub_u32 s66, 7, s32
    s_mov_b32 s68, 5
    s_lshl_b32 s38, s33, 2
    s_add_u32 s38, s38, s34
    v_and_b32 v52, 63, v0
    v_lshlrev_b32 v52, 4, v52
    s_lshr_b32 s39, s38, 5
    s_and_b32 s38, s38, 31
    s_add_u32 s40, s39, 0
    s_mul_i32 s40, s40, 5
    s_add_u32 s40, s40, s66
    s_mov_b32 s41, s40
    s_cmp_lt_u32 s40, 64
    s_cselect_b32 s40, s40, s41
    s_lshl_b32 s40, s40, 5
    s_add_u32 s40, s40, s38
    s_lshl_b32 s40, s40, 10
    v_add_u32 v112, s40, v52
    global_load_dwordx4 v[56:59], v112, s[8:9]
    s_add_u32 s40, s39, 4
    s_mul_i32 s40, s40, 5
    s_add_u32 s40, s40, s66
    s_cmp_lt_u32 s40, 64
    s_cselect_b32 s40, s40, s41
    s_lshl_b32 s40, s40, 5
    s_add_u32 s40, s40, s38
    s_lshl_b32 s40, s40, 10
    v_add_u32 v113, s40, v52
    global_load_dwordx4 v[60:63], v113, s[8:9]
    s_add_u32 s40, s39, 8
    s_mul_i32 s40, s40, 5
    s_add_u32 s40, s40, s66
    s_cmp_lt_u32 s40, 64
    s_cselect_b32 s40, s40, s41
    s_lshl_b32 s40, s40, 5
    s_add_u32 s40, s40, s38
    s_lshl_b32 s40, s40, 10
    v_add_u32 v114, s40, v52
    global_load_dwordx4 v[64:67], v114, s[8:9]
    s_add_u32 s40, s39, 12
    s_mul_i32 s40, s40, 5
    s_add_u32 s40, s40, s66
    s_cmp_lt_u32 s40, 64
    s_cselect_b32 s40, s40, s41
    s_lshl_b32 s40, s40, 5
    s_add_u32 s40, s40, s38
    s_lshl_b32 s40, s40, 10
    v_add_u32 v115, s40, v52
    global_load_dwordx4 v[68:71], v115, s[8:9]
    s_and_b32 s38, s38, 15
    s_lshl_b32 s38, s38, 4
    v_and_b32 v40, 63, v0
    v_and_b32 v41, 15, v0
    v_bfe_u32 v42, v0, 4, 2
    v_lshlrev_b32 v1, 4, v40
    v_lshlrev_b32 v2, 3, v40
    s_and_b32 s42, s34, 1
    s_lshr_b32 s43, s34, 1
    v_and_b32 v43, 15, v0
    v_bfe_u32 v44, v0, 4, 2
    v_add_u32 v45, 0, v44
    v_xor_b32 v45, v45, v43
    v_lshlrev_b32 v45, 4, v45
    v_lshl_add_u32 v216, v43, 10, v45
    v_add_u32 v45, 4, v44
    v_xor_b32 v45, v45, v43
    v_lshlrev_b32 v45, 4, v45
    v_lshl_add_u32 v217, v43, 10, v45
    v_add_u32 v45, 8, v44
    v_xor_b32 v45, v45, v43
    v_lshlrev_b32 v45, 4, v45
    v_lshl_add_u32 v218, v43, 10, v45
    v_add_u32 v45, 12, v44
    v_xor_b32 v45, v45, v43
    v_lshlrev_b32 v45, 4, v45
    v_lshl_add_u32 v219, v43, 10, v45
    s_lshl_b32 s69, s42, 14
    s_lshl_b32 s70, s34, 15
    s_lshl_b32 s40, s34, 15
    v_add_u32 v216, s40, v216
    v_add_u32 v217, s40, v217
    v_add_u32 v218, s40, v218
    v_add_u32 v219, s40, v219
    v_lshrrev_b32 v43, 5, v40
    v_and_b32 v44, 31, v40
    s_lshl_b32 s40, s42, 19
    s_lshl_b32 s41, s43, 9
    s_add_u32 s40, s40, s41
    v_lshlrev_b32 v4, 15, v43
    v_lshl_add_u32 v4, v44, 4, v4
    v_add_u32 v4, s40, v4
    s_lshl_b32 s41, s34, 13
    v_add_u32 v45, 0, v42
    v_xor_b32 v45, v45, v41
    v_lshlrev_b32 v45, 4, v45
    v_lshl_add_u32 v45, v41, 9, v45
    v_add_u32 v220, s41, v45
    v_add_u32 v45, 4, v42
    v_xor_b32 v45, v45, v41
    v_lshlrev_b32 v45, 4, v45
    v_lshl_add_u32 v45, v41, 9, v45
    v_add_u32 v221, s41, v45
    v_add_u32 v45, 8, v42
    v_xor_b32 v45, v45, v41
    v_lshlrev_b32 v45, 4, v45
    v_lshl_add_u32 v45, v41, 9, v45
    v_add_u32 v222, s41, v45
    v_add_u32 v45, 12, v42
    v_xor_b32 v45, v45, v41
    v_lshlrev_b32 v45, 4, v45
    v_lshl_add_u32 v45, v41, 9, v45
    v_add_u32 v223, s41, v45
    v_add_u32 v45, 16, v42
    v_xor_b32 v45, v45, v41
    v_lshlrev_b32 v45, 4, v45
    v_lshl_add_u32 v45, v41, 9, v45
    v_add_u32 v224, s41, v45
    v_add_u32 v45, 20, v42
    v_xor_b32 v45, v45, v41
    v_lshlrev_b32 v45, 4, v45
    v_lshl_add_u32 v45, v41, 9, v45
    v_add_u32 v225, s41, v45
    v_add_u32 v45, 24, v42
    v_xor_b32 v45, v45, v41
    v_lshlrev_b32 v45, 4, v45
    v_lshl_add_u32 v45, v41, 9, v45
    v_add_u32 v226, s41, v45
    v_add_u32 v45, 28, v42
    v_xor_b32 v45, v45, v41
    v_lshlrev_b32 v45, 4, v45
    v_lshl_add_u32 v45, v41, 9, v45
    v_add_u32 v227, s41, v45
    v_add_u32 v45, 0, v43
    v_xor_b32 v46, v45, v44
    v_lshlrev_b32 v46, 4, v46
    v_lshl_add_u32 v46, v45, 9, v46
    v_add_u32 v228, s41, v46
    v_add_u32 v45, 2, v43
    v_xor_b32 v46, v45, v44
    v_lshlrev_b32 v46, 4, v46
    v_lshl_add_u32 v46, v45, 9, v46
    v_add_u32 v229, s41, v46
    v_add_u32 v45, 4, v43
    v_xor_b32 v46, v45, v44
    v_lshlrev_b32 v46, 4, v46
    v_lshl_add_u32 v46, v45, 9, v46
    v_add_u32 v230, s41, v46
    v_add_u32 v45, 6, v43
    v_xor_b32 v46, v45, v44
    v_lshlrev_b32 v46, 4, v46
    v_lshl_add_u32 v46, v45, 9, v46
    v_add_u32 v231, s41, v46
    v_add_u32 v45, 8, v43
    v_xor_b32 v46, v45, v44
    v_lshlrev_b32 v46, 4, v46
    v_lshl_add_u32 v46, v45, 9, v46
    v_add_u32 v232, s41, v46
    v_add_u32 v45, 10, v43
    v_xor_b32 v46, v45, v44
    v_lshlrev_b32 v46, 4, v46
    v_lshl_add_u32 v46, v45, 9, v46
    v_add_u32 v233, s41, v46
    v_add_u32 v45, 12, v43
    v_xor_b32 v46, v45, v44
    v_lshlrev_b32 v46, 4, v46
    v_lshl_add_u32 v46, v45, 9, v46
    v_add_u32 v234, s41, v46
    v_add_u32 v45, 14, v43
    v_xor_b32 v46, v45, v44
    v_lshlrev_b32 v46, 4, v46
    v_lshl_add_u32 v46, v45, 9, v46
    v_add_u32 v235, s41, v46
    s_lshl_b32 s40, s42, 9
    s_add_u32 s40, s40, 131072
    v_add_u32 v10, s40, v2
    v_mov_b32 v9, 0
    v_mov_b32 v16, 0x3f803f80
    v_mov_b32 v17, 0x3f803f80
    s_mov_b32 s67, 0x3fb8aa3b
    v_and_b32 v43, 1, v0
    v_lshlrev_b32 v43, 4, v43
    v_mov_b32 v44, 0x3f80
    v_lshlrev_b32 v44, v43, v44
    v_bfe_u32 v43, v0, 1, 2
    v_cmp_eq_u32 vcc, 0, v43
    s_nop 1
    v_cndmask_b32 v12, 0, v44, vcc
    v_cmp_eq_u32 vcc, 1, v43
    s_nop 1
    v_cndmask_b32 v13, 0, v44, vcc
    v_cmp_eq_u32 vcc, 2, v43
    s_nop 1
    v_cndmask_b32 v14, 0, v44, vcc
    v_cmp_eq_u32 vcc, 3, v43
    s_nop 1
    v_cndmask_b32 v15, 0, v44, vcc
    v_and_b32 v43, 15, v0
    v_bfe_u32 v44, v0, 4, 2
    s_lshl_b32 s40, s34, 8
    v_lshlrev_b32 v5, 10, v44
    v_lshl_add_u32 v5, v43, 4, v5
    v_add_u32 v5, s40, v5
    v_and_b32 v44, 1, v44
    v_lshlrev_b32 v6, 3, v44
    v_lshl_add_u32 v6, v43, 4, v6
    v_add_u32 v6, s40, v6
    v_and_b32 v7, 31, v0
    v_lshlrev_b32 v7, 2, v7
    s_lshl_b32 s44, s34, 12
    s_lshl_b32 s40, s33, 14
    s_add_u32 s40, s40, s44
    s_add_u32 s52, s12, s40
    s_addc_u32 s53, s13, 0
    s_add_u32 s45, s44, 49152
    s_mov_b32 m0, s45
    s_nop 0
    global_load_lds_dwordx4 v1, s[52:53] offset:0
    global_load_lds_dwordx4 v1, s[52:53] offset:1024
    global_load_lds_dwordx4 v1, s[52:53] offset:2048
    global_load_lds_dwordx4 v1, s[52:53] offset:3072
    v_bfe_u32 v44, v0, 2, 2
    v_and_b32 v45, 3, v0
    v_mul_u32_u24 v46, 768, v42
    v_lshl_add_u32 v46, v44, 5, v46
    v_lshl_add_u32 v46, v45, 3, v46
    v_and_b32 v43, 1, v42
    v_lshl_add_u32 v46, v43, 7, v46
    v_lshlrev_b32 v43, 8, v43
    v_sub_u32 v43, v46, v43
    v_add_u32 v43, 128, v43
    v_lshl_add_u32 v47, v42, 2, v44
    v_lshlrev_b32 v47, 10, v47
    v_lshl_add_u32 v47, v45, 4, v47
    s_lshl_b32 s41, s43, 9
    s_add_u32 s41, s41, 49152
    v_add_u32 v47, s41, v47
    s_add_u32 s42, s4, 0x200000
    s_addc_u32 s43, s5, 0
    s_waitcnt vmcnt(4)
    v_lshlrev_b32 v72, 16, v56
    v_and_b32 v73, 0xffff0000, v56
    v_lshlrev_b32 v74, 16, v57
    v_and_b32 v75, 0xffff0000, v57
    v_lshlrev_b32 v76, 16, v58
    v_and_b32 v77, 0xffff0000, v58
    v_lshlrev_b32 v78, 16, v59
    v_and_b32 v79, 0xffff0000, v59
    v_add_f32 v160, v72, v73
    v_mul_f32 v161, v72, v72
    v_fmac_f32 v161, v73, v73
    v_add_f32 v160, v160, v74
    v_fmac_f32 v161, v74, v74
    v_add_f32 v160, v160, v75
    v_fmac_f32 v161, v75, v75
    v_add_f32 v160, v160, v76
    v_fmac_f32 v161, v76, v76
    v_add_f32 v160, v160, v77
    v_fmac_f32 v161, v77, v77
    v_add_f32 v160, v160, v78
    v_fmac_f32 v161, v78, v78
    v_add_f32 v160, v160, v79
    v_fmac_f32 v161, v79, v79
    v_lshlrev_b32 v80, 16, v60
    v_and_b32 v81, 0xffff0000, v60
    v_lshlrev_b32 v82, 16, v61
    v_and_b32 v83, 0xffff0000, v61
    v_lshlrev_b32 v84, 16, v62
    v_and_b32 v85, 0xffff0000, v62
    v_lshlrev_b32 v86, 16, v63
    v_and_b32 v87, 0xffff0000, v63
    v_add_f32 v162, v80, v81
    v_mul_f32 v163, v80, v80
    v_fmac_f32 v163, v81, v81
    v_add_f32 v162, v162, v82
    v_fmac_f32 v163, v82, v82
    v_add_f32 v162, v162, v83
    v_fmac_f32 v163, v83, v83
    v_add_f32 v162, v162, v84
    v_fmac_f32 v163, v84, v84
    v_add_f32 v162, v162, v85
    v_fmac_f32 v163, v85, v85
    v_add_f32 v162, v162, v86
    v_fmac_f32 v163, v86, v86
    v_add_f32 v162, v162, v87
    v_fmac_f32 v163, v87, v87
    v_lshlrev_b32 v88, 16, v64
    v_and_b32 v89, 0xffff0000, v64
    v_lshlrev_b32 v90, 16, v65
    v_and_b32 v91, 0xffff0000, v65
    v_lshlrev_b32 v92, 16, v66
    v_and_b32 v93, 0xffff0000, v66
    v_lshlrev_b32 v94, 16, v67
    v_and_b32 v95, 0xffff0000, v67
    v_add_f32 v164, v88, v89
    v_mul_f32 v165, v88, v88
    v_fmac_f32 v165, v89, v89
    v_add_f32 v164, v164, v90
    v_fmac_f32 v165, v90, v90
    v_add_f32 v164, v164, v91
    v_fmac_f32 v165, v91, v91
    v_add_f32 v164, v164, v92
    v_fmac_f32 v165, v92, v92
    v_add_f32 v164, v164, v93
    v_fmac_f32 v165, v93, v93
    v_add_f32 v164, v164, v94
    v_fmac_f32 v165, v94, v94
    v_add_f32 v164, v164, v95
    v_fmac_f32 v165, v95, v95
    v_lshlrev_b32 v96, 16, v68
    v_and_b32 v97, 0xffff0000, v68
    v_lshlrev_b32 v98, 16, v69
    v_and_b32 v99, 0xffff0000, v69
    v_lshlrev_b32 v100, 16, v70
    v_and_b32 v101, 0xffff0000, v70
    v_lshlrev_b32 v102, 16, v71
    v_and_b32 v103, 0xffff0000, v71
    v_add_f32 v166, v96, v97
    v_mul_f32 v167, v96, v96
    v_fmac_f32 v167, v97, v97
    v_add_f32 v166, v166, v98
    v_fmac_f32 v167, v98, v98
    v_add_f32 v166, v166, v99
    v_fmac_f32 v167, v99, v99
    v_add_f32 v166, v166, v100
    v_fmac_f32 v167, v100, v100
    v_add_f32 v166, v166, v101
    v_fmac_f32 v167, v101, v101
    v_add_f32 v166, v166, v102
    v_fmac_f32 v167, v102, v102
    v_add_f32 v166, v166, v103
    v_fmac_f32 v167, v103, v103
    s_nop 0
    v_add_f32_dpp v168, v160, v160 row_ror:8 row_mask:0xf bank_mask:0xf
    v_add_f32_dpp v169, v161, v161 row_ror:8 row_mask:0xf bank_mask:0xf
    v_add_f32_dpp v170, v162, v162 row_ror:8 row_mask:0xf bank_mask:0xf
    v_add_f32_dpp v171, v163, v163 row_ror:8 row_mask:0xf bank_mask:0xf
    v_add_f32_dpp v172, v164, v164 row_ror:8 row_mask:0xf bank_mask:0xf
    v_add_f32_dpp v173, v165, v165 row_ror:8 row_mask:0xf bank_mask:0xf
    v_add_f32_dpp v174, v166, v166 row_ror:8 row_mask:0xf bank_mask:0xf
    v_add_f32_dpp v175, v167, v167 row_ror:8 row_mask:0xf bank_mask:0xf
    v_add_f32_dpp v160, v168, v168 row_ror:4 row_mask:0xf bank_mask:0xf
    v_add_f32_dpp v161, v169, v169 row_ror:4 row_mask:0xf bank_mask:0xf
    v_add_f32_dpp v162, v170, v170 row_ror:4 row_mask:0xf bank_mask:0xf
    v_add_f32_dpp v163, v171, v171 row_ror:4 row_mask:0xf bank_mask:0xf
    v_add_f32_dpp v164, v172, v172 row_ror:4 row_mask:0xf bank_mask:0xf
    v_add_f32_dpp v165, v173, v173 row_ror:4 row_mask:0xf bank_mask:0xf
    v_add_f32_dpp v166, v174, v174 row_ror:4 row_mask:0xf bank_mask:0xf
    v_add_f32_dpp v167, v175, v175 row_ror:4 row_mask:0xf bank_mask:0xf
    v_add_f32_dpp v168, v160, v160 row_ror:2 row_mask:0xf bank_mask:0xf
    v_add_f32_dpp v169, v161, v161 row_ror:2 row_mask:0xf bank_mask:0xf
    v_add_f32_dpp v170, v162, v162 row_ror:2 row_mask:0xf bank_mask:0xf
    v_add_f32_dpp v171, v163, v163 row_ror:2 row_mask:0xf bank_mask:0xf
    v_add_f32_dpp v172, v164, v164 row_ror:2 row_mask:0xf bank_mask:0xf
    v_add_f32_dpp v173, v165, v165 row_ror:2 row_mask:0xf bank_mask:0xf
    v_add_f32_dpp v174, v166, v166 row_ror:2 row_mask:0xf bank_mask:0xf
    v_add_f32_dpp v175, v167, v167 row_ror:2 row_mask:0xf bank_mask:0xf
    v_add_f32_dpp v160, v168, v168 row_ror:1 row_mask:0xf bank_mask:0xf
    v_add_f32_dpp v161, v169, v169 row_ror:1 row_mask:0xf bank_mask:0xf
    v_add_f32_dpp v162, v170, v170 row_ror:1 row_mask:0xf bank_mask:0xf
    v_add_f32_dpp v163, v171, v171 row_ror:1 row_mask:0xf bank_mask:0xf
    v_add_f32_dpp v164, v172, v172 row_ror:1 row_mask:0xf bank_mask:0xf
    v_add_f32_dpp v165, v173, v173 row_ror:1 row_mask:0xf bank_mask:0xf
    v_add_f32_dpp v166, v174, v174 row_ror:1 row_mask:0xf bank_mask:0xf
    v_add_f32_dpp v167, v175, v175 row_ror:1 row_mask:0xf bank_mask:0xf
    v_mov_b32 v168, v160
    v_mov_b32 v169, v161
    v_mov_b32 v170, v162
    v_mov_b32 v171, v163
    v_mov_b32 v172, v164
    v_mov_b32 v173, v165
    v_mov_b32 v174, v166
    v_mov_b32 v175, v167
    v_permlane16_swap_b32 v160, v168
    v_permlane16_swap_b32 v161, v169
    v_permlane16_swap_b32 v162, v170
    v_permlane16_swap_b32 v163, v171
    v_permlane16_swap_b32 v164, v172
    v_permlane16_swap_b32 v165, v173
    v_permlane16_swap_b32 v166, v174
    v_permlane16_swap_b32 v167, v175
    v_add_f32 v160, v160, v168
    v_add_f32 v161, v161, v169
    v_add_f32 v162, v162, v170
    v_add_f32 v163, v163, v171
    v_add_f32 v164, v164, v172
    v_add_f32 v165, v165, v173
    v_add_f32 v166, v166, v174
    v_add_f32 v167, v167, v175
    v_mov_b32 v168, v160
    v_mov_b32 v169, v161
    v_mov_b32 v170, v162
    v_mov_b32 v171, v163
    v_mov_b32 v172, v164
    v_mov_b32 v173, v165
    v_mov_b32 v174, v166
    v_mov_b32 v175, v167
    v_permlane32_swap_b32 v160, v168
    v_permlane32_swap_b32 v161, v169
    v_permlane32_swap_b32 v162, v170
    v_permlane32_swap_b32 v163, v171
    v_permlane32_swap_b32 v164, v172
    v_permlane32_swap_b32 v165, v173
    v_permlane32_swap_b32 v166, v174
    v_permlane32_swap_b32 v167, v175
    v_add_f32 v160, v160, v168
    v_add_f32 v161, v161, v169
    v_add_f32 v162, v162, v170
    v_add_f32 v163, v163, v171
    v_add_f32 v164, v164, v172
    v_add_f32 v165, v165, v173
    v_add_f32 v166, v166, v174
    v_add_f32 v167, v167, v175
    v_mul_f32 v116, 0x3b000000, v160
    v_mul_f32 v117, 0x3b000000, v161
    v_fma_f32 v117, -v116, v116, v117
    v_max_f32 v117, 0, v117
    v_cvt_pk_bf16_f32 v117, v117, v117
    v_and_b32 v117, 0xffff0000, v117
    v_add_f32 v117, 0x3727c5ac, v117
    v_cvt_pk_bf16_f32 v117, v117, v117
    v_and_b32 v117, 0xffff0000, v117
    v_sqrt_f32 v117, v117
    v_cvt_pk_bf16_f32 v116, v116, v116
    v_and_b32 v116, 0xffff0000, v116
    v_cvt_pk_bf16_f32 v117, v117, v117
    v_and_b32 v117, 0xffff0000, v117
    v_rcp_f32 v117, v117
    v_sub_f32 v72, v72, v116
    v_sub_f32 v73, v73, v116
    v_sub_f32 v74, v74, v116
    v_sub_f32 v75, v75, v116
    v_sub_f32 v76, v76, v116
    v_sub_f32 v77, v77, v116
    v_sub_f32 v78, v78, v116
    v_sub_f32 v79, v79, v116
    v_cvt_pk_bf16_f32 v56, v72, v73
    v_cvt_pk_bf16_f32 v57, v74, v75
    v_cvt_pk_bf16_f32 v58, v76, v77
    v_cvt_pk_bf16_f32 v59, v78, v79
    v_lshlrev_b32 v72, 16, v56
    v_and_b32 v73, 0xffff0000, v56
    v_lshlrev_b32 v74, 16, v57
    v_and_b32 v75, 0xffff0000, v57
    v_lshlrev_b32 v76, 16, v58
    v_and_b32 v77, 0xffff0000, v58
    v_lshlrev_b32 v78, 16, v59
    v_and_b32 v79, 0xffff0000, v59
    v_pk_mul_f32 v[72:73], v[72:73], v[116:117] op_sel:[0,1] op_sel_hi:[1,1]
    v_pk_mul_f32 v[74:75], v[74:75], v[116:117] op_sel:[0,1] op_sel_hi:[1,1]
    v_pk_mul_f32 v[76:77], v[76:77], v[116:117] op_sel:[0,1] op_sel_hi:[1,1]
    v_pk_mul_f32 v[78:79], v[78:79], v[116:117] op_sel:[0,1] op_sel_hi:[1,1]
    v_cvt_pk_bf16_f32 v56, v72, v73
    v_cvt_pk_bf16_f32 v57, v74, v75
    v_cvt_pk_bf16_f32 v58, v76, v77
    v_cvt_pk_bf16_f32 v59, v78, v79
    v_xor_b32 v112, s38, v112
    global_store_dwordx4 v112, v[56:59], s[42:43] sc1
    v_mul_f32 v116, 0x3b000000, v162
    v_mul_f32 v117, 0x3b000000, v163
    v_fma_f32 v117, -v116, v116, v117
    v_max_f32 v117, 0, v117
    v_cvt_pk_bf16_f32 v117, v117, v117
    v_and_b32 v117, 0xffff0000, v117
    v_add_f32 v117, 0x3727c5ac, v117
    v_cvt_pk_bf16_f32 v117, v117, v117
    v_and_b32 v117, 0xffff0000, v117
    v_sqrt_f32 v117, v117
    v_cvt_pk_bf16_f32 v116, v116, v116
    v_and_b32 v116, 0xffff0000, v116
    v_cvt_pk_bf16_f32 v117, v117, v117
    v_and_b32 v117, 0xffff0000, v117
    v_rcp_f32 v117, v117
    v_sub_f32 v80, v80, v116
    v_sub_f32 v81, v81, v116
    v_sub_f32 v82, v82, v116
    v_sub_f32 v83, v83, v116
    v_sub_f32 v84, v84, v116
    v_sub_f32 v85, v85, v116
    v_sub_f32 v86, v86, v116
    v_sub_f32 v87, v87, v116
    v_cvt_pk_bf16_f32 v60, v80, v81
    v_cvt_pk_bf16_f32 v61, v82, v83
    v_cvt_pk_bf16_f32 v62, v84, v85
    v_cvt_pk_bf16_f32 v63, v86, v87
    v_lshlrev_b32 v80, 16, v60
    v_and_b32 v81, 0xffff0000, v60
    v_lshlrev_b32 v82, 16, v61
    v_and_b32 v83, 0xffff0000, v61
    v_lshlrev_b32 v84, 16, v62
    v_and_b32 v85, 0xffff0000, v62
    v_lshlrev_b32 v86, 16, v63
    v_and_b32 v87, 0xffff0000, v63
    v_pk_mul_f32 v[80:81], v[80:81], v[116:117] op_sel:[0,1] op_sel_hi:[1,1]
    v_pk_mul_f32 v[82:83], v[82:83], v[116:117] op_sel:[0,1] op_sel_hi:[1,1]
    v_pk_mul_f32 v[84:85], v[84:85], v[116:117] op_sel:[0,1] op_sel_hi:[1,1]
    v_pk_mul_f32 v[86:87], v[86:87], v[116:117] op_sel:[0,1] op_sel_hi:[1,1]
    v_cvt_pk_bf16_f32 v60, v80, v81
    v_cvt_pk_bf16_f32 v61, v82, v83
    v_cvt_pk_bf16_f32 v62, v84, v85
    v_cvt_pk_bf16_f32 v63, v86, v87
    v_xor_b32 v113, s38, v113
    global_store_dwordx4 v113, v[60:63], s[42:43] sc1
    v_mul_f32 v116, 0x3b000000, v164
    v_mul_f32 v117, 0x3b000000, v165
    v_fma_f32 v117, -v116, v116, v117
    v_max_f32 v117, 0, v117
    v_cvt_pk_bf16_f32 v117, v117, v117
    v_and_b32 v117, 0xffff0000, v117
    v_add_f32 v117, 0x3727c5ac, v117
    v_cvt_pk_bf16_f32 v117, v117, v117
    v_and_b32 v117, 0xffff0000, v117
    v_sqrt_f32 v117, v117
    v_cvt_pk_bf16_f32 v116, v116, v116
    v_and_b32 v116, 0xffff0000, v116
    v_cvt_pk_bf16_f32 v117, v117, v117
    v_and_b32 v117, 0xffff0000, v117
    v_rcp_f32 v117, v117
    v_sub_f32 v88, v88, v116
    v_sub_f32 v89, v89, v116
    v_sub_f32 v90, v90, v116
    v_sub_f32 v91, v91, v116
    v_sub_f32 v92, v92, v116
    v_sub_f32 v93, v93, v116
    v_sub_f32 v94, v94, v116
    v_sub_f32 v95, v95, v116
    v_cvt_pk_bf16_f32 v64, v88, v89
    v_cvt_pk_bf16_f32 v65, v90, v91
    v_cvt_pk_bf16_f32 v66, v92, v93
    v_cvt_pk_bf16_f32 v67, v94, v95
    v_lshlrev_b32 v88, 16, v64
    v_and_b32 v89, 0xffff0000, v64
    v_lshlrev_b32 v90, 16, v65
    v_and_b32 v91, 0xffff0000, v65
    v_lshlrev_b32 v92, 16, v66
    v_and_b32 v93, 0xffff0000, v66
    v_lshlrev_b32 v94, 16, v67
    v_and_b32 v95, 0xffff0000, v67
    v_pk_mul_f32 v[88:89], v[88:89], v[116:117] op_sel:[0,1] op_sel_hi:[1,1]
    v_pk_mul_f32 v[90:91], v[90:91], v[116:117] op_sel:[0,1] op_sel_hi:[1,1]
    v_pk_mul_f32 v[92:93], v[92:93], v[116:117] op_sel:[0,1] op_sel_hi:[1,1]
    v_pk_mul_f32 v[94:95], v[94:95], v[116:117] op_sel:[0,1] op_sel_hi:[1,1]
    v_cvt_pk_bf16_f32 v64, v88, v89
    v_cvt_pk_bf16_f32 v65, v90, v91
    v_cvt_pk_bf16_f32 v66, v92, v93
    v_cvt_pk_bf16_f32 v67, v94, v95
    v_xor_b32 v114, s38, v114
    global_store_dwordx4 v114, v[64:67], s[42:43] sc1
    v_mul_f32 v116, 0x3b000000, v166
    v_mul_f32 v117, 0x3b000000, v167
    v_fma_f32 v117, -v116, v116, v117
    v_max_f32 v117, 0, v117
    v_cvt_pk_bf16_f32 v117, v117, v117
    v_and_b32 v117, 0xffff0000, v117
    v_add_f32 v117, 0x3727c5ac, v117
    v_cvt_pk_bf16_f32 v117, v117, v117
    v_and_b32 v117, 0xffff0000, v117
    v_sqrt_f32 v117, v117
    v_cvt_pk_bf16_f32 v116, v116, v116
    v_and_b32 v116, 0xffff0000, v116
    v_cvt_pk_bf16_f32 v117, v117, v117
    v_and_b32 v117, 0xffff0000, v117
    v_rcp_f32 v117, v117
    v_sub_f32 v96, v96, v116
    v_sub_f32 v97, v97, v116
    v_sub_f32 v98, v98, v116
    v_sub_f32 v99, v99, v116
    v_sub_f32 v100, v100, v116
    v_sub_f32 v101, v101, v116
    v_sub_f32 v102, v102, v116
    v_sub_f32 v103, v103, v116
    v_cvt_pk_bf16_f32 v68, v96, v97
    v_cvt_pk_bf16_f32 v69, v98, v99
    v_cvt_pk_bf16_f32 v70, v100, v101
    v_cvt_pk_bf16_f32 v71, v102, v103
    v_lshlrev_b32 v96, 16, v68
    v_and_b32 v97, 0xffff0000, v68
    v_lshlrev_b32 v98, 16, v69
    v_and_b32 v99, 0xffff0000, v69
    v_lshlrev_b32 v100, 16, v70
    v_and_b32 v101, 0xffff0000, v70
    v_lshlrev_b32 v102, 16, v71
    v_and_b32 v103, 0xffff0000, v71
    v_pk_mul_f32 v[96:97], v[96:97], v[116:117] op_sel:[0,1] op_sel_hi:[1,1]
    v_pk_mul_f32 v[98:99], v[98:99], v[116:117] op_sel:[0,1] op_sel_hi:[1,1]
    v_pk_mul_f32 v[100:101], v[100:101], v[116:117] op_sel:[0,1] op_sel_hi:[1,1]
    v_pk_mul_f32 v[102:103], v[102:103], v[116:117] op_sel:[0,1] op_sel_hi:[1,1]
    v_cvt_pk_bf16_f32 v68, v96, v97
    v_cvt_pk_bf16_f32 v69, v98, v99
    v_cvt_pk_bf16_f32 v70, v100, v101
    v_cvt_pk_bf16_f32 v71, v102, v103
    v_xor_b32 v115, s38, v115
    global_store_dwordx4 v115, v[68:71], s[42:43] sc1
    s_waitcnt vmcnt(0)
    s_barrier
    s_cmp_lg_u32 s34, 0
    s_cbranch_scc1 Larr_157
    s_lshl_b32 s37, s32, 2
    s_add_u32 s37, s37, 64
    v_mov_b32 v40, s37
    v_mov_b32 v41, 1
    s_mov_b64 exec, 1
    global_atomic_add v42, v40, v41, s[30:31] sc0
    s_waitcnt vmcnt(0)
    v_readfirstlane_b32 s36, v42
    s_cmp_lg_u32 s36, 31
    s_cbranch_scc1 Larn_158
    global_store_dword v40, v41, s[30:31] offset:128 sc1
Larn_158:
    s_mov_b64 exec, -1
Larr_157:
    s_lshl_b32 s41, s32, 22
    s_lshl_b32 s42, s33, 15
    s_add_u32 s41, s41, s42
    s_add_u32 s41, s41, 0x2000000
    s_add_u32 s42, s41, 0x0
    s_add_u32 s52, s4, s42
    s_addc_u32 s53, s5, 0
    global_load_dwordx4 v[56:59], v5, s[52:53] sc1
    s_add_u32 s42, s41, 0x1000
    s_add_u32 s52, s4, s42
    s_addc_u32 s53, s5, 0
    global_load_dwordx4 v[56:59], v5, s[52:53] sc1
    s_add_u32 s42, s41, 0x2000
    s_add_u32 s52, s4, s42
    s_addc_u32 s53, s5, 0
    global_load_dwordx4 v[56:59], v5, s[52:53] sc1
    s_add_u32 s42, s41, 0x3000
    s_add_u32 s52, s4, s42
    s_addc_u32 s53, s5, 0
    global_load_dwordx4 v[56:59], v5, s[52:53] sc1
    s_add_u32 s42, s41, 0x4000
    s_add_u32 s52, s4, s42
    s_addc_u32 s53, s5, 0
    global_load_dwordx4 v[56:59], v5, s[52:53] sc1
    s_add_u32 s42, s41, 0x5000
    s_add_u32 s52, s4, s42
    s_addc_u32 s53, s5, 0
    global_load_dwordx4 v[56:59], v5, s[52:53] sc1
    s_add_u32 s42, s41, 0x6000
    s_add_u32 s52, s4, s42
    s_addc_u32 s53, s5, 0
    global_load_dwordx4 v[56:59], v5, s[52:53] sc1
    s_add_u32 s42, s41, 0x7000
    s_add_u32 s52, s4, s42
    s_addc_u32 s53, s5, 0
    global_load_dwordx4 v[56:59], v5, s[52:53] sc1
    v_mov_b32 v41, 224
    s_cmp_lg_u32 s34, 0
    s_cbranch_scc1 Liwd_160
Liw_159:
    global_load_dword v40, v41, s[30:31] sc1
    s_waitcnt vmcnt(0)
    v_readfirstlane_b32 s36, v40
    s_cmp_ge_u32 s36, 1
    s_cbranch_scc1 Liwd_160
    s_sleep 2
    s_add_u32 s101, s101, 1
    s_cmp_gt_u32 s101, 0x40000
    s_cbranch_scc1 L_end
    s_branch Liw_159
Liwd_160:
    s_barrier
    s_mul_i32 s40, s33, 49152
    s_mul_i32 s44, s34, 12288
    s_add_u32 s40, s40, s44
    s_add_u32 s40, s40, 0x1800000
    s_add_u32 s52, s4, s40
    s_addc_u32 s53, s5, 0
    s_mov_b32 m0, s44
    s_add_u32 s44, s44, 4096
    global_load_lds_dwordx4 v1, s[52:53] offset:0 sc1
    global_load_lds_dwordx4 v1, s[52:53] offset:1024 sc1
    global_load_lds_dwordx4 v1, s[52:53] offset:2048 sc1
    global_load_lds_dwordx4 v1, s[52:53] offset:3072 sc1
    s_add_u32 s52, s52, 0x1000
    s_addc_u32 s53, s53, 0
    s_mov_b32 m0, s44
    s_add_u32 s44, s44, 4096
    global_load_lds_dwordx4 v1, s[52:53] offset:0 sc1
    global_load_lds_dwordx4 v1, s[52:53] offset:1024 sc1
    global_load_lds_dwordx4 v1, s[52:53] offset:2048 sc1
    global_load_lds_dwordx4 v1, s[52:53] offset:3072 sc1
    s_add_u32 s52, s52, 0x1000
    s_addc_u32 s53, s53, 0
    s_mov_b32 m0, s44
    s_add_u32 s44, s44, 4096
    global_load_lds_dwordx4 v1, s[52:53] offset:0 sc1
    global_load_lds_dwordx4 v1, s[52:53] offset:1024 sc1
    global_load_lds_dwordx4 v1, s[52:53] offset:2048 sc1
    global_load_lds_dwordx4 v1, s[52:53] offset:3072 sc1
    s_waitcnt vmcnt(0)
    s_barrier
    ds_read_b64_tr_b16 a[0:1], v46 offset:0
    ds_read_b64_tr_b16 a[2:3], v43 offset:0
    ds_read_b64_tr_b16 a[4:5], v46 offset:3072
    ds_read_b64_tr_b16 a[6:7], v43 offset:3072
    ds_read_b64_tr_b16 a[8:9], v46 offset:6144
    ds_read_b64_tr_b16 a[10:11], v43 offset:6144
    ds_read_b64_tr_b16 a[12:13], v46 offset:9216
    ds_read_b64_tr_b16 a[14:15], v43 offset:9216
    ds_read_b64_tr_b16 a[16:17], v46 offset:12288
    ds_read_b64_tr_b16 a[18:19], v43 offset:12288
    ds_read_b64_tr_b16 a[20:21], v46 offset:15360
    ds_read_b64_tr_b16 a[22:23], v43 offset:15360
    ds_read_b64_tr_b16 a[24:25], v46 offset:18432
    ds_read_b64_tr_b16 a[26:27], v43 offset:18432
    ds_read_b64_tr_b16 a[28:29], v46 offset:21504
    ds_read_b64_tr_b16 a[30:31], v43 offset:21504
    ds_read_b64_tr_b16 a[32:33], v46 offset:24576
    ds_read_b64_tr_b16 a[34:35], v43 offset:24576
    ds_read_b64_tr_b16 a[36:37], v46 offset:27648
    ds_read_b64_tr_b16 a[38:39], v43 offset:27648
    ds_read_b64_tr_b16 a[40:41], v46 offset:30720
    ds_read_b64_tr_b16 a[42:43], v43 offset:30720
    ds_read_b64_tr_b16 a[44:45], v46 offset:33792
    ds_read_b64_tr_b16 a[46:47], v43 offset:33792
    ds_read_b64_tr_b16 a[48:49], v46 offset:36864
    ds_read_b64_tr_b16 a[50:51], v43 offset:36864
    ds_read_b64_tr_b16 a[52:53], v46 offset:39936
    ds_read_b64_tr_b16 a[54:55], v43 offset:39936
    ds_read_b64_tr_b16 a[56:57], v46 offset:43008
    ds_read_b64_tr_b16 a[58:59], v43 offset:43008
    ds_read_b64_tr_b16 a[60:61], v46 offset:46080
    ds_read_b64_tr_b16 a[62:63], v43 offset:46080
    ds_read_b64_tr_b16 a[64:65], v46 offset:256
    ds_read_b64_tr_b16 a[66:67], v43 offset:256
    ds_read_b64_tr_b16 a[68:69], v46 offset:3328
    ds_read_b64_tr_b16 a[70:71], v43 offset:3328
    ds_read_b64_tr_b16 a[72:73], v46 offset:6400
    ds_read_b64_tr_b16 a[74:75], v43 offset:6400
    ds_read_b64_tr_b16 a[76:77], v46 offset:9472
    ds_read_b64_tr_b16 a[78:79], v43 offset:9472
    ds_read_b64_tr_b16 a[80:81], v46 offset:12544
    ds_read_b64_tr_b16 a[82:83], v43 offset:12544
    ds_read_b64_tr_b16 a[84:85], v46 offset:15616
    ds_read_b64_tr_b16 a[86:87], v43 offset:15616
    ds_read_b64_tr_b16 a[88:89], v46 offset:18688
    ds_read_b64_tr_b16 a[90:91], v43 offset:18688
    ds_read_b64_tr_b16 a[92:93], v46 offset:21760
    ds_read_b64_tr_b16 a[94:95], v43 offset:21760
    ds_read_b64_tr_b16 a[96:97], v46 offset:24832
    ds_read_b64_tr_b16 a[98:99], v43 offset:24832
    ds_read_b64_tr_b16 a[100:101], v46 offset:27904
    ds_read_b64_tr_b16 a[102:103], v43 offset:27904
    ds_read_b64_tr_b16 a[104:105], v46 offset:30976
    ds_read_b64_tr_b16 a[106:107], v43 offset:30976
    ds_read_b64_tr_b16 a[108:109], v46 offset:34048
    ds_read_b64_tr_b16 a[110:111], v43 offset:34048
    ds_read_b64_tr_b16 a[112:113], v46 offset:37120
    ds_read_b64_tr_b16 a[114:115], v43 offset:37120
    ds_read_b64_tr_b16 a[116:117], v46 offset:40192
    ds_read_b64_tr_b16 a[118:119], v43 offset:40192
    ds_read_b64_tr_b16 a[120:121], v46 offset:43264
    ds_read_b64_tr_b16 a[122:123], v43 offset:43264
    ds_read_b64_tr_b16 a[124:125], v46 offset:46336
    ds_read_b64_tr_b16 a[126:127], v43 offset:46336
    ds_read_b64_tr_b16 a[128:129], v46 offset:512
    ds_read_b64_tr_b16 a[130:131], v43 offset:512
    ds_read_b64_tr_b16 a[132:133], v46 offset:3584
    ds_read_b64_tr_b16 a[134:135], v43 offset:3584
    ds_read_b64_tr_b16 a[136:137], v46 offset:6656
    ds_read_b64_tr_b16 a[138:139], v43 offset:6656
    ds_read_b64_tr_b16 a[140:141], v46 offset:9728
    ds_read_b64_tr_b16 a[142:143], v43 offset:9728
    ds_read_b64_tr_b16 a[144:145], v46 offset:12800
    ds_read_b64_tr_b16 a[146:147], v43 offset:12800
    ds_read_b64_tr_b16 a[148:149], v46 offset:15872
    ds_read_b64_tr_b16 a[150:151], v43 offset:15872
    ds_read_b64_tr_b16 a[152:153], v46 offset:18944
    ds_read_b64_tr_b16 a[154:155], v43 offset:18944
    ds_read_b64_tr_b16 a[156:157], v46 offset:22016
    ds_read_b64_tr_b16 a[158:159], v43 offset:22016
    ds_read_b64_tr_b16 a[160:161], v46 offset:25088
    ds_read_b64_tr_b16 a[162:163], v43 offset:25088
    ds_read_b64_tr_b16 a[164:165], v46 offset:28160
    ds_read_b64_tr_b16 a[166:167], v43 offset:28160
    ds_read_b64_tr_b16 a[168:169], v46 offset:31232
    ds_read_b64_tr_b16 a[170:171], v43 offset:31232
    ds_read_b64_tr_b16 a[172:173], v46 offset:34304
    ds_read_b64_tr_b16 a[174:175], v43 offset:34304
    ds_read_b64_tr_b16 a[176:177], v46 offset:37376
    ds_read_b64_tr_b16 a[178:179], v43 offset:37376
    ds_read_b64_tr_b16 a[180:181], v46 offset:40448
    ds_read_b64_tr_b16 a[182:183], v43 offset:40448
    ds_read_b64_tr_b16 a[184:185], v46 offset:43520
    ds_read_b64_tr_b16 a[186:187], v43 offset:43520
    ds_read_b64_tr_b16 a[188:189], v46 offset:46592
    ds_read_b64_tr_b16 a[190:191], v43 offset:46592
    ds_read_b64_tr_b16 v[128:129], v47 offset:0
    ds_read_b64_tr_b16 v[130:131], v47 offset:8
    ds_read_b64_tr_b16 v[132:133], v47 offset:64
    ds_read_b64_tr_b16 v[134:135], v47 offset:72
    ds_read_b64_tr_b16 v[136:137], v47 offset:128
    ds_read_b64_tr_b16 v[138:139], v47 offset:136
    ds_read_b64_tr_b16 v[140:141], v47 offset:192
    ds_read_b64_tr_b16 v[142:143], v47 offset:200
    ds_read_b64_tr_b16 v[144:145], v47 offset:256
    ds_read_b64_tr_b16 v[146:147], v47 offset:264
    ds_read_b64_tr_b16 v[148:149], v47 offset:320
    ds_read_b64_tr_b16 v[150:151], v47 offset:328
    ds_read_b64_tr_b16 v[152:153], v47 offset:384
    ds_read_b64_tr_b16 v[154:155], v47 offset:392
    ds_read_b64_tr_b16 v[156:157], v47 offset:448
    ds_read_b64_tr_b16 v[158:159], v47 offset:456
    s_waitcnt lgkmcnt(0)
    s_lshl_b32 s37, s32, 2
    s_add_u32 s37, s37, 192
    v_mov_b32 v41, s37
    s_cmp_lg_u32 s34, 0
    s_cbranch_scc1 Liwd_162
Liw_161:
    global_load_dword v40, v41, s[30:31] sc1
    s_waitcnt vmcnt(0)
    v_readfirstlane_b32 s36, v40
    s_cmp_ge_u32 s36, 1
    s_cbranch_scc1 Liwd_162
    s_sleep 2
    s_add_u32 s101, s101, 1
    s_cmp_gt_u32 s101, 0x40000
    s_cbranch_scc1 L_end
    s_branch Liw_161
Liwd_162:
    s_and_b32 s37, s32, 4
    s_lshl_b32 s37, s37, 5
    s_and_b32 s36, s32, 3
    s_lshl_b32 s36, s36, 2
    s_add_u32 s37, s37, s36
    s_and_b32 s36, s32, 8
    s_lshl_b32 s36, s36, 1
    s_add_u32 s37, s37, s36
    v_mov_b32 v41, s37
    s_barrier
    global_load_dword v40, v41, s[30:31] sc1
    s_waitcnt vmcnt(0)
    v_readfirstlane_b32 s37, v40
    s_cmp_lt_u32 s37, 32
    s_cselect_b32 s35, 1, 0
    s_mov_b32 s48, 0
    s_mov_b32 s50, 0
    s_mov_b32 s84, 0
    s_mov_b32 s71, 45
    v_subrev_u32 v11, 131072, v10
L_aw_layer:
    s_barrier
    v_mov_b64 v[24:25], 0
    v_mov_b64 v[26:27], 0
    v_mov_b64 v[28:29], 0
    v_mov_b64 v[30:31], 0
    s_lshr_b32 s51, s34, 1
    s_cmp_lg_u32 s48, 0
    s_cbranch_scc1 L_aw_s1f
    s_add_u32 s49, s51, 0
    s_mul_i32 s49, s49, s68
    s_add_u32 s49, s49, s66
    s_lshl_b32 s41, s49, 15
    s_add_u32 s41, s41, s69
    s_add_u32 s41, s41, 0x200000
    s_add_u32 s52, s4, s41
    s_addc_u32 s53, s5, 0
    s_add_u32 s42, s70, 0
    s_mov_b32 m0, s42
    s_nop 0
    global_load_lds_dwordx4 v1, s[52:53] offset:0 sc1
    global_load_lds_dwordx4 v1, s[52:53] offset:1024 sc1
    global_load_lds_dwordx4 v1, s[52:53] offset:2048 sc1
    global_load_lds_dwordx4 v1, s[52:53] offset:3072 sc1
    s_add_u32 s42, s70, 4096
    s_mov_b32 m0, s42
    s_add_u32 s52, s52, 4096
    s_addc_u32 s53, s53, 0
    global_load_lds_dwordx4 v1, s[52:53] offset:0 sc1
    global_load_lds_dwordx4 v1, s[52:53] offset:1024 sc1
    global_load_lds_dwordx4 v1, s[52:53] offset:2048 sc1
    global_load_lds_dwordx4 v1, s[52:53] offset:3072 sc1
    s_add_u32 s42, s70, 8192
    s_mov_b32 m0, s42
    s_add_u32 s52, s52, 4096
    s_addc_u32 s53, s53, 0
    global_load_lds_dwordx4 v1, s[52:53] offset:0 sc1
    global_load_lds_dwordx4 v1, s[52:53] offset:1024 sc1
    global_load_lds_dwordx4 v1, s[52:53] offset:2048 sc1
    global_load_lds_dwordx4 v1, s[52:53] offset:3072 sc1
    s_add_u32 s42, s70, 12288
    s_mov_b32 m0, s42
    s_add_u32 s52, s52, 4096
    s_addc_u32 s53, s53, 0
    global_load_lds_dwordx4 v1, s[52:53] offset:0 sc1
    global_load_lds_dwordx4 v1, s[52:53] offset:1024 sc1
    global_load_lds_dwordx4 v1, s[52:53] offset:2048 sc1
    global_load_lds_dwordx4 v1, s[52:53] offset:3072 sc1
    s_add_u32 s44, s51, 2
    s_mul_i32 s44, s44, s68
    s_add_u32 s44, s44, s66
    s_lshl_b32 s41, s44, 15
    s_add_u32 s41, s41, s69
    s_add_u32 s41, s41, 0x200000
    s_add_u32 s52, s4, s41
    s_addc_u32 s53, s5, 0
    s_add_u32 s42, s70, 16384
    s_mov_b32 m0, s42
    s_nop 0
    global_load_lds_dwordx4 v1, s[52:53] offset:0 sc1
    global_load_lds_dwordx4 v1, s[52:53] offset:1024 sc1
    global_load_lds_dwordx4 v1, s[52:53] offset:2048 sc1
    global_load_lds_dwordx4 v1, s[52:53] offset:3072 sc1
    s_add_u32 s42, s70, 20480
    s_mov_b32 m0, s42
    s_add_u32 s52, s52, 4096
    s_addc_u32 s53, s53, 0
    global_load_lds_dwordx4 v1, s[52:53] offset:0 sc1
    global_load_lds_dwordx4 v1, s[52:53] offset:1024 sc1
    global_load_lds_dwordx4 v1, s[52:53] offset:2048 sc1
    global_load_lds_dwordx4 v1, s[52:53] offset:3072 sc1
    s_add_u32 s42, s70, 24576
    s_mov_b32 m0, s42
    s_add_u32 s52, s52, 4096
    s_addc_u32 s53, s53, 0
    global_load_lds_dwordx4 v1, s[52:53] offset:0 sc1
    global_load_lds_dwordx4 v1, s[52:53] offset:1024 sc1
    global_load_lds_dwordx4 v1, s[52:53] offset:2048 sc1
    global_load_lds_dwordx4 v1, s[52:53] offset:3072 sc1
    s_add_u32 s42, s70, 28672
    s_mov_b32 m0, s42
    s_add_u32 s52, s52, 4096
    s_addc_u32 s53, s53, 0
    global_load_lds_dwordx4 v1, s[52:53] offset:0 sc1
    global_load_lds_dwordx4 v1, s[52:53] offset:1024 sc1
    global_load_lds_dwordx4 v1, s[52:53] offset:2048 sc1
    global_load_lds_dwordx4 v1, s[52:53] offset:3072 sc1
    s_add_u32 s44, s51, 4
    s_mul_i32 s44, s44, s68
    s_add_u32 s44, s44, s66
    s_waitcnt vmcnt(16)
    ds_read_b128 v[32:35], v216 offset:0
    ds_read_b128 v[36:39], v217 offset:0
    ds_read_b128 v[40:43], v218 offset:0
    ds_read_b128 v[44:47], v219 offset:0
    ds_read_b128 v[48:51], v216 offset:256
    ds_read_b128 v[52:55], v217 offset:256
    ds_read_b128 v[56:59], v218 offset:256
    ds_read_b128 v[60:63], v219 offset:256
    s_lshl_b32 s41, s51, 10
    v_add_u32 v108, s41, v10
    ds_read_b128 v[64:67], v216 offset:512
    s_waitcnt lgkmcnt(8)
    v_mfma_f32_16x16x32_bf16 v[100:103], v[32:35], a[64:67], 0
    v_mfma_f32_16x16x32_bf16 v[96:99], a[0:3], v[32:35], 0
    v_mfma_f32_16x16x32_bf16 v[104:107], v[32:35], a[128:131], 0
    ds_read_b128 v[68:71], v217 offset:512
    s_waitcnt lgkmcnt(8)
    v_mfma_f32_16x16x32_bf16 v[100:103], v[36:39], a[68:71], v[100:103]
    v_mfma_f32_16x16x32_bf16 v[96:99], a[4:7], v[36:39], v[96:99]
    v_mfma_f32_16x16x32_bf16 v[104:107], v[36:39], a[132:135], v[104:107]
    ds_read_b128 v[72:75], v218 offset:512
    s_waitcnt lgkmcnt(8)
    v_mfma_f32_16x16x32_bf16 v[100:103], v[40:43], a[72:75], v[100:103]
    v_mfma_f32_16x16x32_bf16 v[96:99], a[8:11], v[40:43], v[96:99]
    v_mfma_f32_16x16x32_bf16 v[104:107], v[40:43], a[136:139], v[104:107]
    ds_read_b128 v[76:79], v219 offset:512
    s_waitcnt lgkmcnt(8)
    v_mfma_f32_16x16x32_bf16 v[100:103], v[44:47], a[76:79], v[100:103]
    v_mfma_f32_16x16x32_bf16 v[96:99], a[12:15], v[44:47], v[96:99]
    v_mfma_f32_16x16x32_bf16 v[104:107], v[44:47], a[140:143], v[104:107]
    ds_read_b128 v[80:83], v216 offset:768
    s_waitcnt lgkmcnt(8)
    v_mfma_f32_16x16x32_bf16 v[100:103], v[48:51], a[80:83], v[100:103]
    v_mfma_f32_16x16x32_bf16 v[96:99], a[16:19], v[48:51], v[96:99]
    v_mfma_f32_16x16x32_bf16 v[104:107], v[48:51], a[144:147], v[104:107]
    ds_read_b128 v[84:87], v217 offset:768
    s_waitcnt lgkmcnt(8)
    v_mfma_f32_16x16x32_bf16 v[100:103], v[52:55], a[84:87], v[100:103]
    v_mfma_f32_16x16x32_bf16 v[96:99], a[20:23], v[52:55], v[96:99]
    v_mfma_f32_16x16x32_bf16 v[104:107], v[52:55], a[148:151], v[104:107]
    ds_read_b128 v[88:91], v218 offset:768
    s_waitcnt lgkmcnt(8)
    v_mfma_f32_16x16x32_bf16 v[100:103], v[56:59], a[88:91], v[100:103]
    v_mfma_f32_16x16x32_bf16 v[96:99], a[24:27], v[56:59], v[96:99]
    v_mfma_f32_16x16x32_bf16 v[104:107], v[56:59], a[152:155], v[104:107]
    ds_read_b128 v[92:95], v219 offset:768
    s_waitcnt lgkmcnt(8)
    v_mfma_f32_16x16x32_bf16 v[100:103], v[60:63], a[92:95], v[100:103]
    v_mfma_f32_16x16x32_bf16 v[96:99], a[28:31], v[60:63], v[96:99]
    v_mfma_f32_16x16x32_bf16 v[104:107], v[60:63], a[156:159], v[104:107]
    s_waitcnt lgkmcnt(7)
    v_mfma_f32_16x16x32_bf16 v[100:103], v[64:67], a[96:99], v[100:103]
    v_mfma_f32_16x16x32_bf16 v[96:99], a[32:35], v[64:67], v[96:99]
    v_mfma_f32_16x16x32_bf16 v[104:107], v[64:67], a[160:163], v[104:107]
    s_waitcnt lgkmcnt(0)
    v_mfma_f32_16x16x32_bf16 v[100:103], v[68:71], a[100:103], v[100:103]
    s_lshl_b32 s41, s44, 15
    s_add_u32 s41, s41, s69
    s_add_u32 s41, s41, 0x200000
    s_add_u32 s52, s4, s41
    s_addc_u32 s53, s5, 0
    s_add_u32 s42, s70, 0
    s_mov_b32 m0, s42
    s_nop 0
    global_load_lds_dwordx4 v1, s[52:53] offset:0 sc1
    v_mfma_f32_16x16x32_bf16 v[96:99], a[36:39], v[68:71], v[96:99]
    global_load_lds_dwordx4 v1, s[52:53] offset:1024 sc1
    v_mfma_f32_16x16x32_bf16 v[104:107], v[68:71], a[164:167], v[104:107]
    global_load_lds_dwordx4 v1, s[52:53] offset:2048 sc1
    s_waitcnt lgkmcnt(15)
    v_mfma_f32_16x16x32_bf16 v[100:103], v[72:75], a[104:107], v[100:103]
    global_load_lds_dwordx4 v1, s[52:53] offset:3072 sc1
    v_mfma_f32_16x16x32_bf16 v[96:99], a[40:43], v[72:75], v[96:99]
    s_add_u32 s42, s70, 4096
    s_mov_b32 m0, s42
    s_add_u32 s52, s52, 4096
    s_addc_u32 s53, s53, 0
    global_load_lds_dwordx4 v1, s[52:53] offset:0 sc1
    v_mfma_f32_16x16x32_bf16 v[104:107], v[72:75], a[168:171], v[104:107]
    global_load_lds_dwordx4 v1, s[52:53] offset:1024 sc1
    s_waitcnt lgkmcnt(15)
    v_mfma_f32_16x16x32_bf16 v[100:103], v[76:79], a[108:111], v[100:103]
    global_load_lds_dwordx4 v1, s[52:53] offset:2048 sc1
    v_mfma_f32_16x16x32_bf16 v[96:99], a[44:47], v[76:79], v[96:99]
    global_load_lds_dwordx4 v1, s[52:53] offset:3072 sc1
    v_mfma_f32_16x16x32_bf16 v[104:107], v[76:79], a[172:175], v[104:107]
    s_add_u32 s42, s70, 8192
    s_mov_b32 m0, s42
    s_add_u32 s52, s52, 4096
    s_addc_u32 s53, s53, 0
    global_load_lds_dwordx4 v1, s[52:53] offset:0 sc1
    s_waitcnt lgkmcnt(15)
    v_mfma_f32_16x16x32_bf16 v[100:103], v[80:83], a[112:115], v[100:103]
    global_load_lds_dwordx4 v1, s[52:53] offset:1024 sc1
    v_mfma_f32_16x16x32_bf16 v[96:99], a[48:51], v[80:83], v[96:99]
    global_load_lds_dwordx4 v1, s[52:53] offset:2048 sc1
    v_mfma_f32_16x16x32_bf16 v[104:107], v[80:83], a[176:179], v[104:107]
    global_load_lds_dwordx4 v1, s[52:53] offset:3072 sc1
    s_waitcnt lgkmcnt(15)
    v_mfma_f32_16x16x32_bf16 v[100:103], v[84:87], a[116:119], v[100:103]
    s_add_u32 s42, s70, 12288
    s_mov_b32 m0, s42
    s_add_u32 s52, s52, 4096
    s_addc_u32 s53, s53, 0
    global_load_lds_dwordx4 v1, s[52:53] offset:0 sc1
    v_mfma_f32_16x16x32_bf16 v[96:99], a[52:55], v[84:87], v[96:99]
    global_load_lds_dwordx4 v1, s[52:53] offset:1024 sc1
    v_mfma_f32_16x16x32_bf16 v[104:107], v[84:87], a[180:183], v[104:107]
    global_load_lds_dwordx4 v1, s[52:53] offset:2048 sc1
    s_waitcnt lgkmcnt(15)
    v_mfma_f32_16x16x32_bf16 v[100:103], v[88:91], a[120:123], v[100:103]
    global_load_lds_dwordx4 v1, s[52:53] offset:3072 sc1
    v_mfma_f32_16x16x32_bf16 v[96:99], a[56:59], v[88:91], v[96:99]
    v_mfma_f32_16x16x32_bf16 v[104:107], v[88:91], a[184:187], v[104:107]
    s_waitcnt lgkmcnt(15)
    v_mfma_f32_16x16x32_bf16 v[100:103], v[92:95], a[124:127], v[100:103]
    v_mfma_f32_16x16x32_bf16 v[96:99], a[60:63], v[92:95], v[96:99]
    v_mfma_f32_16x16x32_bf16 v[104:107], v[92:95], a[188:191], v[104:107]
    s_add_u32 s51, s51, 2
L_aw_s1:
    s_add_u32 s44, s51, 4
    s_mul_i32 s44, s44, s68
    s_add_u32 s44, s44, s66
    s_cmp_ge_u32 s44, 64
    s_cbranch_scc1 L_aw_s1e1
    s_waitcnt vmcnt(16)
    ds_read_b128 v[32:35], v216 offset:16384
    ds_read_b128 v[36:39], v217 offset:16384
    ds_read_b128 v[40:43], v218 offset:16384
    ds_read_b128 v[44:47], v219 offset:16384
    ds_read_b128 v[48:51], v216 offset:16640
    ds_read_b128 v[52:55], v217 offset:16640
    ds_read_b128 v[56:59], v218 offset:16640
    ds_read_b128 v[60:63], v219 offset:16640
    s_lshl_b32 s41, s51, 10
    v_add_u32 v172, s41, v10
    ds_read_b128 v[64:67], v216 offset:16896
    s_waitcnt lgkmcnt(8)
    v_mfma_f32_16x16x32_bf16 v[164:167], v[32:35], a[64:67], 0
    v_mul_f32 v112, s67, v100
    v_min_f32 v112, 0, v112
    v_mfma_f32_16x16x32_bf16 v[160:163], a[0:3], v[32:35], 0
    v_mul_f32 v113, s67, v101
    v_min_f32 v113, 0, v113
    v_mfma_f32_16x16x32_bf16 v[168:171], v[32:35], a[128:131], 0
    v_mul_f32 v114, s67, v102
    v_min_f32 v114, 0, v114
    ds_read_b128 v[68:71], v217 offset:16896
    s_waitcnt lgkmcnt(8)
    v_mfma_f32_16x16x32_bf16 v[164:167], v[36:39], a[68:71], v[164:167]
    v_mul_f32 v115, s67, v103
    v_min_f32 v115, 0, v115
    v_mfma_f32_16x16x32_bf16 v[160:163], a[4:7], v[36:39], v[160:163]
    v_exp_f32 v112, v112
    v_exp_f32 v113, v113
    v_mfma_f32_16x16x32_bf16 v[168:171], v[36:39], a[132:135], v[168:171]
    v_exp_f32 v114, v114
    v_exp_f32 v115, v115
    ds_read_b128 v[72:75], v218 offset:16896
    s_waitcnt lgkmcnt(8)
    v_mfma_f32_16x16x32_bf16 v[164:167], v[40:43], a[72:75], v[164:167]
    v_max_f32 v100, 0, v100
    v_max_f32 v101, 0, v101
    v_mfma_f32_16x16x32_bf16 v[160:163], a[8:11], v[40:43], v[160:163]
    v_max_f32 v102, 0, v102
    v_max_f32 v103, 0, v103
    v_mfma_f32_16x16x32_bf16 v[168:171], v[40:43], a[136:139], v[168:171]
    v_add_f32 v112, 0x358637bd, v112
    v_add_f32 v113, 0x358637bd, v113
    ds_read_b128 v[76:79], v219 offset:16896
    s_waitcnt lgkmcnt(8)
    v_mfma_f32_16x16x32_bf16 v[164:167], v[44:47], a[76:79], v[164:167]
    v_add_f32 v114, 0x358637bd, v114
    v_add_f32 v115, 0x358637bd, v115
    v_mfma_f32_16x16x32_bf16 v[160:163], a[12:15], v[44:47], v[160:163]
    v_add_f32 v100, v100, v112
    v_add_f32 v101, v101, v113
    v_mfma_f32_16x16x32_bf16 v[168:171], v[44:47], a[140:143], v[168:171]
    v_add_f32 v102, v102, v114
    v_add_f32 v103, v103, v115
    ds_read_b128 v[80:83], v216 offset:17152
    s_waitcnt lgkmcnt(8)
    v_mfma_f32_16x16x32_bf16 v[164:167], v[48:51], a[80:83], v[164:167]
    v_cvt_pk_bf16_f32 v116, v100, v101
    v_cvt_pk_bf16_f32 v117, v102, v103
    v_mfma_f32_16x16x32_bf16 v[160:163], a[16:19], v[48:51], v[160:163]
    v_cvt_pk_bf16_f32 v118, v104, v105
    v_cvt_pk_bf16_f32 v119, v106, v107
    v_mfma_f32_16x16x32_bf16 v[168:171], v[48:51], a[144:147], v[168:171]
    v_mul_f32 v112, s67, v96
    v_min_f32 v112, 0, v112
    ds_read_b128 v[84:87], v217 offset:17152
    s_waitcnt lgkmcnt(8)
    v_mfma_f32_16x16x32_bf16 v[164:167], v[52:55], a[84:87], v[164:167]
    v_mul_f32 v113, s67, v97
    v_min_f32 v113, 0, v113
    v_mfma_f32_16x16x32_bf16 v[160:163], a[20:23], v[52:55], v[160:163]
    v_mul_f32 v114, s67, v98
    v_min_f32 v114, 0, v114
    v_mfma_f32_16x16x32_bf16 v[168:171], v[52:55], a[148:151], v[168:171]
    v_mul_f32 v115, s67, v99
    v_min_f32 v115, 0, v115
    ds_read_b128 v[88:91], v218 offset:17152
    s_waitcnt lgkmcnt(8)
    v_mfma_f32_16x16x32_bf16 v[164:167], v[56:59], a[88:91], v[164:167]
    v_exp_f32 v112, v112
    v_exp_f32 v113, v113
    v_mfma_f32_16x16x32_bf16 v[160:163], a[24:27], v[56:59], v[160:163]
    v_exp_f32 v114, v114
    v_exp_f32 v115, v115
    v_mfma_f32_16x16x32_bf16 v[168:171], v[56:59], a[152:155], v[168:171]
    v_max_f32 v96, 0, v96
    v_max_f32 v97, 0, v97
    ds_read_b128 v[92:95], v219 offset:17152
    s_waitcnt lgkmcnt(8)
    v_mfma_f32_16x16x32_bf16 v[164:167], v[60:63], a[92:95], v[164:167]
    v_max_f32 v98, 0, v98
    v_max_f32 v99, 0, v99
    v_mfma_f32_16x16x32_bf16 v[160:163], a[28:31], v[60:63], v[160:163]
    v_add_f32 v112, 0x358637bd, v112
    v_add_f32 v113, 0x358637bd, v113
    v_mfma_f32_16x16x32_bf16 v[168:171], v[60:63], a[156:159], v[168:171]
    v_add_f32 v114, 0x358637bd, v114
    v_add_f32 v115, 0x358637bd, v115
    s_waitcnt lgkmcnt(7)
    v_mfma_f32_16x16x32_bf16 v[164:167], v[64:67], a[96:99], v[164:167]
    v_add_f32 v96, v96, v112
    v_add_f32 v97, v97, v113
    v_mfma_f32_16x16x32_bf16 v[160:163], a[32:35], v[64:67], v[160:163]
    v_add_f32 v98, v98, v114
    v_add_f32 v99, v99, v115
    v_mfma_f32_16x16x32_bf16 v[168:171], v[64:67], a[160:163], v[168:171]
    v_mfma_f32_16x16x16_bf16 v[24:27], v[116:117], v[118:119], v[24:27]
    v_mfma_f32_16x16x16_bf16 v[28:31], v[116:117], v[16:17], v[28:31]
    s_waitcnt lgkmcnt(0)
    v_mfma_f32_16x16x32_bf16 v[164:167], v[68:71], a[100:103], v[164:167]
    v_cvt_pk_bf16_f32 v120, v96, v97
    v_cvt_pk_bf16_f32 v121, v98, v99
    s_lshl_b32 s41, s44, 15
    s_add_u32 s41, s41, s69
    s_add_u32 s41, s41, 0x200000
    s_add_u32 s52, s4, s41
    s_addc_u32 s53, s5, 0
    s_add_u32 s42, s70, 16384
    s_mov_b32 m0, s42
    s_nop 0
    global_load_lds_dwordx4 v1, s[52:53] offset:0 sc1
    v_mfma_f32_16x16x32_bf16 v[160:163], a[36:39], v[68:71], v[160:163]
    ds_write_b64 v108, v[120:121]
    global_load_lds_dwordx4 v1, s[52:53] offset:1024 sc1
    v_mfma_f32_16x16x32_bf16 v[168:171], v[68:71], a[164:167], v[168:171]
    global_load_lds_dwordx4 v1, s[52:53] offset:2048 sc1
    s_waitcnt lgkmcnt(15)
    v_mfma_f32_16x16x32_bf16 v[164:167], v[72:75], a[104:107], v[164:167]
    global_load_lds_dwordx4 v1, s[52:53] offset:3072 sc1
    v_mfma_f32_16x16x32_bf16 v[160:163], a[40:43], v[72:75], v[160:163]
    s_add_u32 s42, s70, 20480
    s_mov_b32 m0, s42
    s_add_u32 s52, s52, 4096
    s_addc_u32 s53, s53, 0
    global_load_lds_dwordx4 v1, s[52:53] offset:0 sc1
    v_mfma_f32_16x16x32_bf16 v[168:171], v[72:75], a[168:171], v[168:171]
    global_load_lds_dwordx4 v1, s[52:53] offset:1024 sc1
    s_waitcnt lgkmcnt(15)
    v_mfma_f32_16x16x32_bf16 v[164:167], v[76:79], a[108:111], v[164:167]
    global_load_lds_dwordx4 v1, s[52:53] offset:2048 sc1
    v_mfma_f32_16x16x32_bf16 v[160:163], a[44:47], v[76:79], v[160:163]
    global_load_lds_dwordx4 v1, s[52:53] offset:3072 sc1
    v_mfma_f32_16x16x32_bf16 v[168:171], v[76:79], a[172:175], v[168:171]
    s_add_u32 s42, s70, 24576
    s_mov_b32 m0, s42
    s_add_u32 s52, s52, 4096
    s_addc_u32 s53, s53, 0
    global_load_lds_dwordx4 v1, s[52:53] offset:0 sc1
    s_waitcnt lgkmcnt(15)
    v_mfma_f32_16x16x32_bf16 v[164:167], v[80:83], a[112:115], v[164:167]
    global_load_lds_dwordx4 v1, s[52:53] offset:1024 sc1
    v_mfma_f32_16x16x32_bf16 v[160:163], a[48:51], v[80:83], v[160:163]
    global_load_lds_dwordx4 v1, s[52:53] offset:2048 sc1
    v_mfma_f32_16x16x32_bf16 v[168:171], v[80:83], a[176:179], v[168:171]
    global_load_lds_dwordx4 v1, s[52:53] offset:3072 sc1
    s_waitcnt lgkmcnt(15)
    v_mfma_f32_16x16x32_bf16 v[164:167], v[84:87], a[116:119], v[164:167]
    s_add_u32 s42, s70, 28672
    s_mov_b32 m0, s42
    s_add_u32 s52, s52, 4096
    s_addc_u32 s53, s53, 0
    global_load_lds_dwordx4 v1, s[52:53] offset:0 sc1
    v_mfma_f32_16x16x32_bf16 v[160:163], a[52:55], v[84:87], v[160:163]
    global_load_lds_dwordx4 v1, s[52:53] offset:1024 sc1
    v_mfma_f32_16x16x32_bf16 v[168:171], v[84:87], a[180:183], v[168:171]
    global_load_lds_dwordx4 v1, s[52:53] offset:2048 sc1
    s_waitcnt lgkmcnt(15)
    v_mfma_f32_16x16x32_bf16 v[164:167], v[88:91], a[120:123], v[164:167]
    global_load_lds_dwordx4 v1, s[52:53] offset:3072 sc1
    v_mfma_f32_16x16x32_bf16 v[160:163], a[56:59], v[88:91], v[160:163]
    v_mfma_f32_16x16x32_bf16 v[168:171], v[88:91], a[184:187], v[168:171]
    s_waitcnt lgkmcnt(15)
    v_mfma_f32_16x16x32_bf16 v[164:167], v[92:95], a[124:127], v[164:167]
    v_mfma_f32_16x16x32_bf16 v[160:163], a[60:63], v[92:95], v[160:163]
    v_mfma_f32_16x16x32_bf16 v[168:171], v[92:95], a[188:191], v[168:171]
    s_add_u32 s51, s51, 2
    s_add_u32 s44, s51, 4
    s_mul_i32 s44, s44, s68
    s_add_u32 s44, s44, s66
    s_cmp_ge_u32 s44, 64
    s_cbranch_scc1 L_aw_s1e0
    s_waitcnt vmcnt(16)
    ds_read_b128 v[32:35], v216 offset:0
    ds_read_b128 v[36:39], v217 offset:0
    ds_read_b128 v[40:43], v218 offset:0
    ds_read_b128 v[44:47], v219 offset:0
    ds_read_b128 v[48:51], v216 offset:256
    ds_read_b128 v[52:55], v217 offset:256
    ds_read_b128 v[56:59], v218 offset:256
    ds_read_b128 v[60:63], v219 offset:256
    s_lshl_b32 s41, s51, 10
    v_add_u32 v108, s41, v10
    ds_read_b128 v[64:67], v216 offset:512
    s_waitcnt lgkmcnt(8)
    v_mfma_f32_16x16x32_bf16 v[100:103], v[32:35], a[64:67], 0
    v_mul_f32 v112, s67, v164
    v_min_f32 v112, 0, v112
    v_mfma_f32_16x16x32_bf16 v[96:99], a[0:3], v[32:35], 0
    v_mul_f32 v113, s67, v165
    v_min_f32 v113, 0, v113
    v_mfma_f32_16x16x32_bf16 v[104:107], v[32:35], a[128:131], 0
    v_mul_f32 v114, s67, v166
    v_min_f32 v114, 0, v114
    ds_read_b128 v[68:71], v217 offset:512
    s_waitcnt lgkmcnt(8)
    v_mfma_f32_16x16x32_bf16 v[100:103], v[36:39], a[68:71], v[100:103]
    v_mul_f32 v115, s67, v167
    v_min_f32 v115, 0, v115
    v_mfma_f32_16x16x32_bf16 v[96:99], a[4:7], v[36:39], v[96:99]
    v_exp_f32 v112, v112
    v_exp_f32 v113, v113
    v_mfma_f32_16x16x32_bf16 v[104:107], v[36:39], a[132:135], v[104:107]
    v_exp_f32 v114, v114
    v_exp_f32 v115, v115
    ds_read_b128 v[72:75], v218 offset:512
    s_waitcnt lgkmcnt(8)
    v_mfma_f32_16x16x32_bf16 v[100:103], v[40:43], a[72:75], v[100:103]
    v_max_f32 v164, 0, v164
    v_max_f32 v165, 0, v165
    v_mfma_f32_16x16x32_bf16 v[96:99], a[8:11], v[40:43], v[96:99]
    v_max_f32 v166, 0, v166
    v_max_f32 v167, 0, v167
    v_mfma_f32_16x16x32_bf16 v[104:107], v[40:43], a[136:139], v[104:107]
    v_add_f32 v112, 0x358637bd, v112
    v_add_f32 v113, 0x358637bd, v113
    ds_read_b128 v[76:79], v219 offset:512
    s_waitcnt lgkmcnt(8)
    v_mfma_f32_16x16x32_bf16 v[100:103], v[44:47], a[76:79], v[100:103]
    v_add_f32 v114, 0x358637bd, v114
    v_add_f32 v115, 0x358637bd, v115
    v_mfma_f32_16x16x32_bf16 v[96:99], a[12:15], v[44:47], v[96:99]
    v_add_f32 v164, v164, v112
    v_add_f32 v165, v165, v113
    v_mfma_f32_16x16x32_bf16 v[104:107], v[44:47], a[140:143], v[104:107]
    v_add_f32 v166, v166, v114
    v_add_f32 v167, v167, v115
    ds_read_b128 v[80:83], v216 offset:768
    s_waitcnt lgkmcnt(8)
    v_mfma_f32_16x16x32_bf16 v[100:103], v[48:51], a[80:83], v[100:103]
    v_cvt_pk_bf16_f32 v116, v164, v165
    v_cvt_pk_bf16_f32 v117, v166, v167
    v_mfma_f32_16x16x32_bf16 v[96:99], a[16:19], v[48:51], v[96:99]
    v_cvt_pk_bf16_f32 v118, v168, v169
    v_cvt_pk_bf16_f32 v119, v170, v171
    v_mfma_f32_16x16x32_bf16 v[104:107], v[48:51], a[144:147], v[104:107]
    v_mul_f32 v112, s67, v160
    v_min_f32 v112, 0, v112
    ds_read_b128 v[84:87], v217 offset:768
    s_waitcnt lgkmcnt(8)
    v_mfma_f32_16x16x32_bf16 v[100:103], v[52:55], a[84:87], v[100:103]
    v_mul_f32 v113, s67, v161
    v_min_f32 v113, 0, v113
    v_mfma_f32_16x16x32_bf16 v[96:99], a[20:23], v[52:55], v[96:99]
    v_mul_f32 v114, s67, v162
    v_min_f32 v114, 0, v114
    v_mfma_f32_16x16x32_bf16 v[104:107], v[52:55], a[148:151], v[104:107]
    v_mul_f32 v115, s67, v163
    v_min_f32 v115, 0, v115
    ds_read_b128 v[88:91], v218 offset:768
    s_waitcnt lgkmcnt(8)
    v_mfma_f32_16x16x32_bf16 v[100:103], v[56:59], a[88:91], v[100:103]
    v_exp_f32 v112, v112
    v_exp_f32 v113, v113
    v_mfma_f32_16x16x32_bf16 v[96:99], a[24:27], v[56:59], v[96:99]
    v_exp_f32 v114, v114
    v_exp_f32 v115, v115
    v_mfma_f32_16x16x32_bf16 v[104:107], v[56:59], a[152:155], v[104:107]
    v_max_f32 v160, 0, v160
    v_max_f32 v161, 0, v161
    ds_read_b128 v[92:95], v219 offset:768
    s_waitcnt lgkmcnt(8)
    v_mfma_f32_16x16x32_bf16 v[100:103], v[60:63], a[92:95], v[100:103]
    v_max_f32 v162, 0, v162
    v_max_f32 v163, 0, v163
    v_mfma_f32_16x16x32_bf16 v[96:99], a[28:31], v[60:63], v[96:99]
    v_add_f32 v112, 0x358637bd, v112
    v_add_f32 v113, 0x358637bd, v113
    v_mfma_f32_16x16x32_bf16 v[104:107], v[60:63], a[156:159], v[104:107]
    v_add_f32 v114, 0x358637bd, v114
    v_add_f32 v115, 0x358637bd, v115
    s_waitcnt lgkmcnt(7)
    v_mfma_f32_16x16x32_bf16 v[100:103], v[64:67], a[96:99], v[100:103]
    v_add_f32 v160, v160, v112
    v_add_f32 v161, v161, v113
    v_mfma_f32_16x16x32_bf16 v[96:99], a[32:35], v[64:67], v[96:99]
    v_add_f32 v162, v162, v114
    v_add_f32 v163, v163, v115
    v_mfma_f32_16x16x32_bf16 v[104:107], v[64:67], a[160:163], v[104:107]
    v_mfma_f32_16x16x16_bf16 v[24:27], v[116:117], v[118:119], v[24:27]
    v_mfma_f32_16x16x16_bf16 v[28:31], v[116:117], v[16:17], v[28:31]
    s_waitcnt lgkmcnt(0)
    v_mfma_f32_16x16x32_bf16 v[100:103], v[68:71], a[100:103], v[100:103]
    v_cvt_pk_bf16_f32 v120, v160, v161
    v_cvt_pk_bf16_f32 v121, v162, v163
    s_lshl_b32 s41, s44, 15
    s_add_u32 s41, s41, s69
    s_add_u32 s41, s41, 0x200000
    s_add_u32 s52, s4, s41
    s_addc_u32 s53, s5, 0
    s_add_u32 s42, s70, 0
    s_mov_b32 m0, s42
    s_nop 0
    global_load_lds_dwordx4 v1, s[52:53] offset:0 sc1
    v_mfma_f32_16x16x32_bf16 v[96:99], a[36:39], v[68:71], v[96:99]
    ds_write_b64 v172, v[120:121]
    global_load_lds_dwordx4 v1, s[52:53] offset:1024 sc1
    v_mfma_f32_16x16x32_bf16 v[104:107], v[68:71], a[164:167], v[104:107]
    global_load_lds_dwordx4 v1, s[52:53] offset:2048 sc1
    s_waitcnt lgkmcnt(15)
    v_mfma_f32_16x16x32_bf16 v[100:103], v[72:75], a[104:107], v[100:103]
    global_load_lds_dwordx4 v1, s[52:53] offset:3072 sc1
    v_mfma_f32_16x16x32_bf16 v[96:99], a[40:43], v[72:75], v[96:99]
    s_add_u32 s42, s70, 4096
    s_mov_b32 m0, s42
    s_add_u32 s52, s52, 4096
    s_addc_u32 s53, s53, 0
    global_load_lds_dwordx4 v1, s[52:53] offset:0 sc1
    v_mfma_f32_16x16x32_bf16 v[104:107], v[72:75], a[168:171], v[104:107]
    global_load_lds_dwordx4 v1, s[52:53] offset:1024 sc1
    s_waitcnt lgkmcnt(15)
    v_mfma_f32_16x16x32_bf16 v[100:103], v[76:79], a[108:111], v[100:103]
    global_load_lds_dwordx4 v1, s[52:53] offset:2048 sc1
    v_mfma_f32_16x16x32_bf16 v[96:99], a[44:47], v[76:79], v[96:99]
    global_load_lds_dwordx4 v1, s[52:53] offset:3072 sc1
    v_mfma_f32_16x16x32_bf16 v[104:107], v[76:79], a[172:175], v[104:107]
    s_add_u32 s42, s70, 8192
    s_mov_b32 m0, s42
    s_add_u32 s52, s52, 4096
    s_addc_u32 s53, s53, 0
    global_load_lds_dwordx4 v1, s[52:53] offset:0 sc1
    s_waitcnt lgkmcnt(15)
    v_mfma_f32_16x16x32_bf16 v[100:103], v[80:83], a[112:115], v[100:103]
    global_load_lds_dwordx4 v1, s[52:53] offset:1024 sc1
    v_mfma_f32_16x16x32_bf16 v[96:99], a[48:51], v[80:83], v[96:99]
    global_load_lds_dwordx4 v1, s[52:53] offset:2048 sc1
    v_mfma_f32_16x16x32_bf16 v[104:107], v[80:83], a[176:179], v[104:107]
    global_load_lds_dwordx4 v1, s[52:53] offset:3072 sc1
    s_waitcnt lgkmcnt(15)
    v_mfma_f32_16x16x32_bf16 v[100:103], v[84:87], a[116:119], v[100:103]
    s_add_u32 s42, s70, 12288
    s_mov_b32 m0, s42
    s_add_u32 s52, s52, 4096
    s_addc_u32 s53, s53, 0
    global_load_lds_dwordx4 v1, s[52:53] offset:0 sc1
    v_mfma_f32_16x16x32_bf16 v[96:99], a[52:55], v[84:87], v[96:99]
    global_load_lds_dwordx4 v1, s[52:53] offset:1024 sc1
    v_mfma_f32_16x16x32_bf16 v[104:107], v[84:87], a[180:183], v[104:107]
    global_load_lds_dwordx4 v1, s[52:53] offset:2048 sc1
    s_waitcnt lgkmcnt(15)
    v_mfma_f32_16x16x32_bf16 v[100:103], v[88:91], a[120:123], v[100:103]
    global_load_lds_dwordx4 v1, s[52:53] offset:3072 sc1
    v_mfma_f32_16x16x32_bf16 v[96:99], a[56:59], v[88:91], v[96:99]
    v_mfma_f32_16x16x32_bf16 v[104:107], v[88:91], a[184:187], v[104:107]
    s_waitcnt lgkmcnt(15)
    v_mfma_f32_16x16x32_bf16 v[100:103], v[92:95], a[124:127], v[100:103]
    v_mfma_f32_16x16x32_bf16 v[96:99], a[60:63], v[92:95], v[96:99]
    v_mfma_f32_16x16x32_bf16 v[104:107], v[92:95], a[188:191], v[104:107]
    s_add_u32 s51, s51, 2
    s_branch L_aw_s1
L_aw_s1e0:
    s_waitcnt vmcnt(16)
    ds_read_b128 v[32:35], v216 offset:0
    ds_read_b128 v[36:39], v217 offset:0
    ds_read_b128 v[40:43], v218 offset:0
    ds_read_b128 v[44:47], v219 offset:0
    ds_read_b128 v[48:51], v216 offset:256
    ds_read_b128 v[52:55], v217 offset:256
    ds_read_b128 v[56:59], v218 offset:256
    ds_read_b128 v[60:63], v219 offset:256
    s_lshl_b32 s41, s51, 10
    v_add_u32 v108, s41, v10
    ds_read_b128 v[64:67], v216 offset:512
    s_waitcnt lgkmcnt(8)
    v_mfma_f32_16x16x32_bf16 v[100:103], v[32:35], a[64:67], 0
    v_mul_f32 v112, s67, v164
    v_min_f32 v112, 0, v112
    v_mfma_f32_16x16x32_bf16 v[96:99], a[0:3], v[32:35], 0
    v_mul_f32 v113, s67, v165
    v_min_f32 v113, 0, v113
    v_mfma_f32_16x16x32_bf16 v[104:107], v[32:35], a[128:131], 0
    v_mul_f32 v114, s67, v166
    v_min_f32 v114, 0, v114
    ds_read_b128 v[68:71], v217 offset:512
    s_waitcnt lgkmcnt(8)
    v_mfma_f32_16x16x32_bf16 v[100:103], v[36:39], a[68:71], v[100:103]
    v_mul_f32 v115, s67, v167
    v_min_f32 v115, 0, v115
    v_mfma_f32_16x16x32_bf16 v[96:99], a[4:7], v[36:39], v[96:99]
    v_exp_f32 v112, v112
    v_exp_f32 v113, v113
    v_mfma_f32_16x16x32_bf16 v[104:107], v[36:39], a[132:135], v[104:107]
    v_exp_f32 v114, v114
    v_exp_f32 v115, v115
    ds_read_b128 v[72:75], v218 offset:512
    s_waitcnt lgkmcnt(8)
    v_mfma_f32_16x16x32_bf16 v[100:103], v[40:43], a[72:75], v[100:103]
    v_max_f32 v164, 0, v164
    v_max_f32 v165, 0, v165
    v_mfma_f32_16x16x32_bf16 v[96:99], a[8:11], v[40:43], v[96:99]
    v_max_f32 v166, 0, v166
    v_max_f32 v167, 0, v167
    v_mfma_f32_16x16x32_bf16 v[104:107], v[40:43], a[136:139], v[104:107]
    v_add_f32 v112, 0x358637bd, v112
    v_add_f32 v113, 0x358637bd, v113
    ds_read_b128 v[76:79], v219 offset:512
    s_waitcnt lgkmcnt(8)
    v_mfma_f32_16x16x32_bf16 v[100:103], v[44:47], a[76:79], v[100:103]
    v_add_f32 v114, 0x358637bd, v114
    v_add_f32 v115, 0x358637bd, v115
    v_mfma_f32_16x16x32_bf16 v[96:99], a[12:15], v[44:47], v[96:99]
    v_add_f32 v164, v164, v112
    v_add_f32 v165, v165, v113
    v_mfma_f32_16x16x32_bf16 v[104:107], v[44:47], a[140:143], v[104:107]
    v_add_f32 v166, v166, v114
    v_add_f32 v167, v167, v115
    ds_read_b128 v[80:83], v216 offset:768
    s_waitcnt lgkmcnt(8)
    v_mfma_f32_16x16x32_bf16 v[100:103], v[48:51], a[80:83], v[100:103]
    v_cvt_pk_bf16_f32 v116, v164, v165
    v_cvt_pk_bf16_f32 v117, v166, v167
    v_mfma_f32_16x16x32_bf16 v[96:99], a[16:19], v[48:51], v[96:99]
    v_cvt_pk_bf16_f32 v118, v168, v169
    v_cvt_pk_bf16_f32 v119, v170, v171
    v_mfma_f32_16x16x32_bf16 v[104:107], v[48:51], a[144:147], v[104:107]
    v_mul_f32 v112, s67, v160
    v_min_f32 v112, 0, v112
    ds_read_b128 v[84:87], v217 offset:768
    s_waitcnt lgkmcnt(8)
    v_mfma_f32_16x16x32_bf16 v[100:103], v[52:55], a[84:87], v[100:103]
    v_mul_f32 v113, s67, v161
    v_min_f32 v113, 0, v113
    v_mfma_f32_16x16x32_bf16 v[96:99], a[20:23], v[52:55], v[96:99]
    v_mul_f32 v114, s67, v162
    v_min_f32 v114, 0, v114
    v_mfma_f32_16x16x32_bf16 v[104:107], v[52:55], a[148:151], v[104:107]
    v_mul_f32 v115, s67, v163
    v_min_f32 v115, 0, v115
    ds_read_b128 v[88:91], v218 offset:768
    s_waitcnt lgkmcnt(8)
    v_mfma_f32_16x16x32_bf16 v[100:103], v[56:59], a[88:91], v[100:103]
    v_exp_f32 v112, v112
    v_exp_f32 v113, v113
    v_mfma_f32_16x16x32_bf16 v[96:99], a[24:27], v[56:59], v[96:99]
    v_exp_f32 v114, v114
    v_exp_f32 v115, v115
    v_mfma_f32_16x16x32_bf16 v[104:107], v[56:59], a[152:155], v[104:107]
    v_max_f32 v160, 0, v160
    v_max_f32 v161, 0, v161
    ds_read_b128 v[92:95], v219 offset:768
    s_waitcnt lgkmcnt(8)
    v_mfma_f32_16x16x32_bf16 v[100:103], v[60:63], a[92:95], v[100:103]
    v_max_f32 v162, 0, v162
    v_max_f32 v163, 0, v163
    v_mfma_f32_16x16x32_bf16 v[96:99], a[28:31], v[60:63], v[96:99]
    v_add_f32 v112, 0x358637bd, v112
    v_add_f32 v113, 0x358637bd, v113
    v_mfma_f32_16x16x32_bf16 v[104:107], v[60:63], a[156:159], v[104:107]
    v_add_f32 v114, 0x358637bd, v114
    v_add_f32 v115, 0x358637bd, v115
    s_waitcnt lgkmcnt(7)
    v_mfma_f32_16x16x32_bf16 v[100:103], v[64:67], a[96:99], v[100:103]
    v_add_f32 v160, v160, v112
    v_add_f32 v161, v161, v113
    v_mfma_f32_16x16x32_bf16 v[96:99], a[32:35], v[64:67], v[96:99]
    v_add_f32 v162, v162, v114
    v_add_f32 v163, v163, v115
    v_mfma_f32_16x16x32_bf16 v[104:107], v[64:67], a[160:163], v[104:107]
    v_mfma_f32_16x16x16_bf16 v[24:27], v[116:117], v[118:119], v[24:27]
    v_mfma_f32_16x16x16_bf16 v[28:31], v[116:117], v[16:17], v[28:31]
    s_waitcnt lgkmcnt(0)
    v_mfma_f32_16x16x32_bf16 v[100:103], v[68:71], a[100:103], v[100:103]
    v_cvt_pk_bf16_f32 v120, v160, v161
    v_cvt_pk_bf16_f32 v121, v162, v163
    v_mfma_f32_16x16x32_bf16 v[96:99], a[36:39], v[68:71], v[96:99]
    ds_write_b64 v172, v[120:121]
    v_mfma_f32_16x16x32_bf16 v[104:107], v[68:71], a[164:167], v[104:107]
    s_waitcnt lgkmcnt(15)
    v_mfma_f32_16x16x32_bf16 v[100:103], v[72:75], a[104:107], v[100:103]
    v_mfma_f32_16x16x32_bf16 v[96:99], a[40:43], v[72:75], v[96:99]
    v_mfma_f32_16x16x32_bf16 v[104:107], v[72:75], a[168:171], v[104:107]
    s_waitcnt lgkmcnt(15)
    v_mfma_f32_16x16x32_bf16 v[100:103], v[76:79], a[108:111], v[100:103]
    v_mfma_f32_16x16x32_bf16 v[96:99], a[44:47], v[76:79], v[96:99]
    v_mfma_f32_16x16x32_bf16 v[104:107], v[76:79], a[172:175], v[104:107]
    s_waitcnt lgkmcnt(15)
    v_mfma_f32_16x16x32_bf16 v[100:103], v[80:83], a[112:115], v[100:103]
    v_mfma_f32_16x16x32_bf16 v[96:99], a[48:51], v[80:83], v[96:99]
    v_mfma_f32_16x16x32_bf16 v[104:107], v[80:83], a[176:179], v[104:107]
    s_waitcnt lgkmcnt(15)
    v_mfma_f32_16x16x32_bf16 v[100:103], v[84:87], a[116:119], v[100:103]
    v_mfma_f32_16x16x32_bf16 v[96:99], a[52:55], v[84:87], v[96:99]
    v_mfma_f32_16x16x32_bf16 v[104:107], v[84:87], a[180:183], v[104:107]
    s_waitcnt lgkmcnt(15)
    v_mfma_f32_16x16x32_bf16 v[100:103], v[88:91], a[120:123], v[100:103]
    v_mfma_f32_16x16x32_bf16 v[96:99], a[56:59], v[88:91], v[96:99]
    v_mfma_f32_16x16x32_bf16 v[104:107], v[88:91], a[184:187], v[104:107]
    s_waitcnt lgkmcnt(15)
    v_mfma_f32_16x16x32_bf16 v[100:103], v[92:95], a[124:127], v[100:103]
    v_mfma_f32_16x16x32_bf16 v[96:99], a[60:63], v[92:95], v[96:99]
    v_mfma_f32_16x16x32_bf16 v[104:107], v[92:95], a[188:191], v[104:107]
    s_add_u32 s51, s51, 2
    s_waitcnt vmcnt(0)
    ds_read_b128 v[32:35], v216 offset:16384
    ds_read_b128 v[36:39], v217 offset:16384
    ds_read_b128 v[40:43], v218 offset:16384
    ds_read_b128 v[44:47], v219 offset:16384
    ds_read_b128 v[48:51], v216 offset:16640
    ds_read_b128 v[52:55], v217 offset:16640
    ds_read_b128 v[56:59], v218 offset:16640
    ds_read_b128 v[60:63], v219 offset:16640
    s_lshl_b32 s41, s51, 10
    v_add_u32 v172, s41, v10
    ds_read_b128 v[64:67], v216 offset:16896
    s_waitcnt lgkmcnt(8)
    v_mfma_f32_16x16x32_bf16 v[164:167], v[32:35], a[64:67], 0
    v_mul_f32 v112, s67, v100
    v_min_f32 v112, 0, v112
    v_mfma_f32_16x16x32_bf16 v[160:163], a[0:3], v[32:35], 0
    v_mul_f32 v113, s67, v101
    v_min_f32 v113, 0, v113
    v_mfma_f32_16x16x32_bf16 v[168:171], v[32:35], a[128:131], 0
    v_mul_f32 v114, s67, v102
    v_min_f32 v114, 0, v114
    ds_read_b128 v[68:71], v217 offset:16896
    s_waitcnt lgkmcnt(8)
    v_mfma_f32_16x16x32_bf16 v[164:167], v[36:39], a[68:71], v[164:167]
    v_mul_f32 v115, s67, v103
    v_min_f32 v115, 0, v115
    v_mfma_f32_16x16x32_bf16 v[160:163], a[4:7], v[36:39], v[160:163]
    v_exp_f32 v112, v112
    v_exp_f32 v113, v113
    v_mfma_f32_16x16x32_bf16 v[168:171], v[36:39], a[132:135], v[168:171]
    v_exp_f32 v114, v114
    v_exp_f32 v115, v115
    ds_read_b128 v[72:75], v218 offset:16896
    s_waitcnt lgkmcnt(8)
    v_mfma_f32_16x16x32_bf16 v[164:167], v[40:43], a[72:75], v[164:167]
    v_max_f32 v100, 0, v100
    v_max_f32 v101, 0, v101
    v_mfma_f32_16x16x32_bf16 v[160:163], a[8:11], v[40:43], v[160:163]
    v_max_f32 v102, 0, v102
    v_max_f32 v103, 0, v103
    v_mfma_f32_16x16x32_bf16 v[168:171], v[40:43], a[136:139], v[168:171]
    v_add_f32 v112, 0x358637bd, v112
    v_add_f32 v113, 0x358637bd, v113
    ds_read_b128 v[76:79], v219 offset:16896
    s_waitcnt lgkmcnt(8)
    v_mfma_f32_16x16x32_bf16 v[164:167], v[44:47], a[76:79], v[164:167]
    v_add_f32 v114, 0x358637bd, v114
    v_add_f32 v115, 0x358637bd, v115
    v_mfma_f32_16x16x32_bf16 v[160:163], a[12:15], v[44:47], v[160:163]
    v_add_f32 v100, v100, v112
    v_add_f32 v101, v101, v113
    v_mfma_f32_16x16x32_bf16 v[168:171], v[44:47], a[140:143], v[168:171]
    v_add_f32 v102, v102, v114
    v_add_f32 v103, v103, v115
    ds_read_b128 v[80:83], v216 offset:17152
    s_waitcnt lgkmcnt(8)
    v_mfma_f32_16x16x32_bf16 v[164:167], v[48:51], a[80:83], v[164:167]
    v_cvt_pk_bf16_f32 v116, v100, v101
    v_cvt_pk_bf16_f32 v117, v102, v103
    v_mfma_f32_16x16x32_bf16 v[160:163], a[16:19], v[48:51], v[160:163]
    v_cvt_pk_bf16_f32 v118, v104, v105
    v_cvt_pk_bf16_f32 v119, v106, v107
    v_mfma_f32_16x16x32_bf16 v[168:171], v[48:51], a[144:147], v[168:171]
    v_mul_f32 v112, s67, v96
    v_min_f32 v112, 0, v112
    ds_read_b128 v[84:87], v217 offset:17152
    s_waitcnt lgkmcnt(8)
    v_mfma_f32_16x16x32_bf16 v[164:167], v[52:55], a[84:87], v[164:167]
    v_mul_f32 v113, s67, v97
    v_min_f32 v113, 0, v113
    v_mfma_f32_16x16x32_bf16 v[160:163], a[20:23], v[52:55], v[160:163]
    v_mul_f32 v114, s67, v98
    v_min_f32 v114, 0, v114
    v_mfma_f32_16x16x32_bf16 v[168:171], v[52:55], a[148:151], v[168:171]
    v_mul_f32 v115, s67, v99
    v_min_f32 v115, 0, v115
    ds_read_b128 v[88:91], v218 offset:17152
    s_waitcnt lgkmcnt(8)
    v_mfma_f32_16x16x32_bf16 v[164:167], v[56:59], a[88:91], v[164:167]
    v_exp_f32 v112, v112
    v_exp_f32 v113, v113
    v_mfma_f32_16x16x32_bf16 v[160:163], a[24:27], v[56:59], v[160:163]
    v_exp_f32 v114, v114
    v_exp_f32 v115, v115
    v_mfma_f32_16x16x32_bf16 v[168:171], v[56:59], a[152:155], v[168:171]
    v_max_f32 v96, 0, v96
    v_max_f32 v97, 0, v97
    ds_read_b128 v[92:95], v219 offset:17152
    s_waitcnt lgkmcnt(8)
    v_mfma_f32_16x16x32_bf16 v[164:167], v[60:63], a[92:95], v[164:167]
    v_max_f32 v98, 0, v98
    v_max_f32 v99, 0, v99
    v_mfma_f32_16x16x32_bf16 v[160:163], a[28:31], v[60:63], v[160:163]
    v_add_f32 v112, 0x358637bd, v112
    v_add_f32 v113, 0x358637bd, v113
    v_mfma_f32_16x16x32_bf16 v[168:171], v[60:63], a[156:159], v[168:171]
    v_add_f32 v114, 0x358637bd, v114
    v_add_f32 v115, 0x358637bd, v115
    s_waitcnt lgkmcnt(7)
    v_mfma_f32_16x16x32_bf16 v[164:167], v[64:67], a[96:99], v[164:167]
    v_add_f32 v96, v96, v112
    v_add_f32 v97, v97, v113
    v_mfma_f32_16x16x32_bf16 v[160:163], a[32:35], v[64:67], v[160:163]
    v_add_f32 v98, v98, v114
    v_add_f32 v99, v99, v115
    v_mfma_f32_16x16x32_bf16 v[168:171], v[64:67], a[160:163], v[168:171]
    v_mfma_f32_16x16x16_bf16 v[24:27], v[116:117], v[118:119], v[24:27]
    v_mfma_f32_16x16x16_bf16 v[28:31], v[116:117], v[16:17], v[28:31]
    s_waitcnt lgkmcnt(0)
    v_mfma_f32_16x16x32_bf16 v[164:167], v[68:71], a[100:103], v[164:167]
    v_cvt_pk_bf16_f32 v120, v96, v97
    v_cvt_pk_bf16_f32 v121, v98, v99
    v_mfma_f32_16x16x32_bf16 v[160:163], a[36:39], v[68:71], v[160:163]
    ds_write_b64 v108, v[120:121]
    v_mfma_f32_16x16x32_bf16 v[168:171], v[68:71], a[164:167], v[168:171]
    s_waitcnt lgkmcnt(15)
    v_mfma_f32_16x16x32_bf16 v[164:167], v[72:75], a[104:107], v[164:167]
    v_mfma_f32_16x16x32_bf16 v[160:163], a[40:43], v[72:75], v[160:163]
    v_mfma_f32_16x16x32_bf16 v[168:171], v[72:75], a[168:171], v[168:171]
    s_waitcnt lgkmcnt(15)
    v_mfma_f32_16x16x32_bf16 v[164:167], v[76:79], a[108:111], v[164:167]
    v_mfma_f32_16x16x32_bf16 v[160:163], a[44:47], v[76:79], v[160:163]
    v_mfma_f32_16x16x32_bf16 v[168:171], v[76:79], a[172:175], v[168:171]
    s_waitcnt lgkmcnt(15)
    v_mfma_f32_16x16x32_bf16 v[164:167], v[80:83], a[112:115], v[164:167]
    v_mfma_f32_16x16x32_bf16 v[160:163], a[48:51], v[80:83], v[160:163]
    v_mfma_f32_16x16x32_bf16 v[168:171], v[80:83], a[176:179], v[168:171]
    s_waitcnt lgkmcnt(15)
    v_mfma_f32_16x16x32_bf16 v[164:167], v[84:87], a[116:119], v[164:167]
    v_mfma_f32_16x16x32_bf16 v[160:163], a[52:55], v[84:87], v[160:163]
    v_mfma_f32_16x16x32_bf16 v[168:171], v[84:87], a[180:183], v[168:171]
    s_waitcnt lgkmcnt(15)
    v_mfma_f32_16x16x32_bf16 v[164:167], v[88:91], a[120:123], v[164:167]
    v_mfma_f32_16x16x32_bf16 v[160:163], a[56:59], v[88:91], v[160:163]
    v_mfma_f32_16x16x32_bf16 v[168:171], v[88:91], a[184:187], v[168:171]
    s_waitcnt lgkmcnt(15)
    v_mfma_f32_16x16x32_bf16 v[164:167], v[92:95], a[124:127], v[164:167]
    v_mfma_f32_16x16x32_bf16 v[160:163], a[60:63], v[92:95], v[160:163]
    v_mfma_f32_16x16x32_bf16 v[168:171], v[92:95], a[188:191], v[168:171]
    s_nop 5
    v_mul_f32 v112, s67, v164
    v_min_f32 v112, 0, v112
    v_mul_f32 v113, s67, v165
    v_min_f32 v113, 0, v113
    v_mul_f32 v114, s67, v166
    v_min_f32 v114, 0, v114
    v_mul_f32 v115, s67, v167
    v_min_f32 v115, 0, v115
    v_exp_f32 v112, v112
    v_exp_f32 v113, v113
    v_exp_f32 v114, v114
    v_exp_f32 v115, v115
    v_max_f32 v164, 0, v164
    v_max_f32 v165, 0, v165
    v_max_f32 v166, 0, v166
    v_max_f32 v167, 0, v167
    v_add_f32 v112, 0x358637bd, v112
    v_add_f32 v113, 0x358637bd, v113
    v_add_f32 v114, 0x358637bd, v114
    v_add_f32 v115, 0x358637bd, v115
    v_add_f32 v164, v164, v112
    v_add_f32 v165, v165, v113
    v_add_f32 v166, v166, v114
    v_add_f32 v167, v167, v115
    v_cvt_pk_bf16_f32 v116, v164, v165
    v_cvt_pk_bf16_f32 v117, v166, v167
    v_cvt_pk_bf16_f32 v118, v168, v169
    v_cvt_pk_bf16_f32 v119, v170, v171
    v_mul_f32 v112, s67, v160
    v_min_f32 v112, 0, v112
    v_mul_f32 v113, s67, v161
    v_min_f32 v113, 0, v113
    v_mul_f32 v114, s67, v162
    v_min_f32 v114, 0, v114
    v_mul_f32 v115, s67, v163
    v_min_f32 v115, 0, v115
    v_exp_f32 v112, v112
    v_exp_f32 v113, v113
    v_exp_f32 v114, v114
    v_exp_f32 v115, v115
    v_max_f32 v160, 0, v160
    v_max_f32 v161, 0, v161
    v_max_f32 v162, 0, v162
    v_max_f32 v163, 0, v163
    v_add_f32 v112, 0x358637bd, v112
    v_add_f32 v113, 0x358637bd, v113
    v_add_f32 v114, 0x358637bd, v114
    v_add_f32 v115, 0x358637bd, v115
    v_add_f32 v160, v160, v112
    v_add_f32 v161, v161, v113
    v_add_f32 v162, v162, v114
    v_add_f32 v163, v163, v115
    v_mfma_f32_16x16x16_bf16 v[24:27], v[116:117], v[118:119], v[24:27]
    v_mfma_f32_16x16x16_bf16 v[28:31], v[116:117], v[16:17], v[28:31]
    v_cvt_pk_bf16_f32 v120, v160, v161
    v_cvt_pk_bf16_f32 v121, v162, v163
    ds_write_b64 v172, v[120:121]
    s_add_u32 s51, s51, 2
    s_branch L_aw_s1t
L_aw_s1e1:
    s_waitcnt vmcnt(16)
    ds_read_b128 v[32:35], v216 offset:16384
    ds_read_b128 v[36:39], v217 offset:16384
    ds_read_b128 v[40:43], v218 offset:16384
    ds_read_b128 v[44:47], v219 offset:16384
    ds_read_b128 v[48:51], v216 offset:16640
    ds_read_b128 v[52:55], v217 offset:16640
    ds_read_b128 v[56:59], v218 offset:16640
    ds_read_b128 v[60:63], v219 offset:16640
    s_lshl_b32 s41, s51, 10
    v_add_u32 v172, s41, v10
    ds_read_b128 v[64:67], v216 offset:16896
    s_waitcnt lgkmcnt(8)
    v_mfma_f32_16x16x32_bf16 v[164:167], v[32:35], a[64:67], 0
    v_mul_f32 v112, s67, v100
    v_min_f32 v112, 0, v112
    v_mfma_f32_16x16x32_bf16 v[160:163], a[0:3], v[32:35], 0
    v_mul_f32 v113, s67, v101
    v_min_f32 v113, 0, v113
    v_mfma_f32_16x16x32_bf16 v[168:171], v[32:35], a[128:131], 0
    v_mul_f32 v114, s67, v102
    v_min_f32 v114, 0, v114
    ds_read_b128 v[68:71], v217 offset:16896
    s_waitcnt lgkmcnt(8)
    v_mfma_f32_16x16x32_bf16 v[164:167], v[36:39], a[68:71], v[164:167]
    v_mul_f32 v115, s67, v103
    v_min_f32 v115, 0, v115
    v_mfma_f32_16x16x32_bf16 v[160:163], a[4:7], v[36:39], v[160:163]
    v_exp_f32 v112, v112
    v_exp_f32 v113, v113
    v_mfma_f32_16x16x32_bf16 v[168:171], v[36:39], a[132:135], v[168:171]
    v_exp_f32 v114, v114
    v_exp_f32 v115, v115
    ds_read_b128 v[72:75], v218 offset:16896
    s_waitcnt lgkmcnt(8)
    v_mfma_f32_16x16x32_bf16 v[164:167], v[40:43], a[72:75], v[164:167]
    v_max_f32 v100, 0, v100
    v_max_f32 v101, 0, v101
    v_mfma_f32_16x16x32_bf16 v[160:163], a[8:11], v[40:43], v[160:163]
    v_max_f32 v102, 0, v102
    v_max_f32 v103, 0, v103
    v_mfma_f32_16x16x32_bf16 v[168:171], v[40:43], a[136:139], v[168:171]
    v_add_f32 v112, 0x358637bd, v112
    v_add_f32 v113, 0x358637bd, v113
    ds_read_b128 v[76:79], v219 offset:16896
    s_waitcnt lgkmcnt(8)
    v_mfma_f32_16x16x32_bf16 v[164:167], v[44:47], a[76:79], v[164:167]
    v_add_f32 v114, 0x358637bd, v114
    v_add_f32 v115, 0x358637bd, v115
    v_mfma_f32_16x16x32_bf16 v[160:163], a[12:15], v[44:47], v[160:163]
    v_add_f32 v100, v100, v112
    v_add_f32 v101, v101, v113
    v_mfma_f32_16x16x32_bf16 v[168:171], v[44:47], a[140:143], v[168:171]
    v_add_f32 v102, v102, v114
    v_add_f32 v103, v103, v115
    ds_read_b128 v[80:83], v216 offset:17152
    s_waitcnt lgkmcnt(8)
    v_mfma_f32_16x16x32_bf16 v[164:167], v[48:51], a[80:83], v[164:167]
    v_cvt_pk_bf16_f32 v116, v100, v101
    v_cvt_pk_bf16_f32 v117, v102, v103
    v_mfma_f32_16x16x32_bf16 v[160:163], a[16:19], v[48:51], v[160:163]
    v_cvt_pk_bf16_f32 v118, v104, v105
    v_cvt_pk_bf16_f32 v119, v106, v107
    v_mfma_f32_16x16x32_bf16 v[168:171], v[48:51], a[144:147], v[168:171]
    v_mul_f32 v112, s67, v96
    v_min_f32 v112, 0, v112
    ds_read_b128 v[84:87], v217 offset:17152
    s_waitcnt lgkmcnt(8)
    v_mfma_f32_16x16x32_bf16 v[164:167], v[52:55], a[84:87], v[164:167]
    v_mul_f32 v113, s67, v97
    v_min_f32 v113, 0, v113
    v_mfma_f32_16x16x32_bf16 v[160:163], a[20:23], v[52:55], v[160:163]
    v_mul_f32 v114, s67, v98
    v_min_f32 v114, 0, v114
    v_mfma_f32_16x16x32_bf16 v[168:171], v[52:55], a[148:151], v[168:171]
    v_mul_f32 v115, s67, v99
    v_min_f32 v115, 0, v115
    ds_read_b128 v[88:91], v218 offset:17152
    s_waitcnt lgkmcnt(8)
    v_mfma_f32_16x16x32_bf16 v[164:167], v[56:59], a[88:91], v[164:167]
    v_exp_f32 v112, v112
    v_exp_f32 v113, v113
    v_mfma_f32_16x16x32_bf16 v[160:163], a[24:27], v[56:59], v[160:163]
    v_exp_f32 v114, v114
    v_exp_f32 v115, v115
    v_mfma_f32_16x16x32_bf16 v[168:171], v[56:59], a[152:155], v[168:171]
    v_max_f32 v96, 0, v96
    v_max_f32 v97, 0, v97
    ds_read_b128 v[92:95], v219 offset:17152
    s_waitcnt lgkmcnt(8)
    v_mfma_f32_16x16x32_bf16 v[164:167], v[60:63], a[92:95], v[164:167]
    v_max_f32 v98, 0, v98
    v_max_f32 v99, 0, v99
    v_mfma_f32_16x16x32_bf16 v[160:163], a[28:31], v[60:63], v[160:163]
    v_add_f32 v112, 0x358637bd, v112
    v_add_f32 v113, 0x358637bd, v113
    v_mfma_f32_16x16x32_bf16 v[168:171], v[60:63], a[156:159], v[168:171]
    v_add_f32 v114, 0x358637bd, v114
    v_add_f32 v115, 0x358637bd, v115
    s_waitcnt lgkmcnt(7)
    v_mfma_f32_16x16x32_bf16 v[164:167], v[64:67], a[96:99], v[164:167]
    v_add_f32 v96, v96, v112
    v_add_f32 v97, v97, v113
    v_mfma_f32_16x16x32_bf16 v[160:163], a[32:35], v[64:67], v[160:163]
    v_add_f32 v98, v98, v114
    v_add_f32 v99, v99, v115
    v_mfma_f32_16x16x32_bf16 v[168:171], v[64:67], a[160:163], v[168:171]
    v_mfma_f32_16x16x16_bf16 v[24:27], v[116:117], v[118:119], v[24:27]
    v_mfma_f32_16x16x16_bf16 v[28:31], v[116:117], v[16:17], v[28:31]
    s_waitcnt lgkmcnt(0)
    v_mfma_f32_16x16x32_bf16 v[164:167], v[68:71], a[100:103], v[164:167]
    v_cvt_pk_bf16_f32 v120, v96, v97
    v_cvt_pk_bf16_f32 v121, v98, v99
    v_mfma_f32_16x16x32_bf16 v[160:163], a[36:39], v[68:71], v[160:163]
    ds_write_b64 v108, v[120:121]
    v_mfma_f32_16x16x32_bf16 v[168:171], v[68:71], a[164:167], v[168:171]
    s_waitcnt lgkmcnt(15)
    v_mfma_f32_16x16x32_bf16 v[164:167], v[72:75], a[104:107], v[164:167]
    v_mfma_f32_16x16x32_bf16 v[160:163], a[40:43], v[72:75], v[160:163]
    v_mfma_f32_16x16x32_bf16 v[168:171], v[72:75], a[168:171], v[168:171]
    s_waitcnt lgkmcnt(15)
    v_mfma_f32_16x16x32_bf16 v[164:167], v[76:79], a[108:111], v[164:167]
    v_mfma_f32_16x16x32_bf16 v[160:163], a[44:47], v[76:79], v[160:163]
    v_mfma_f32_16x16x32_bf16 v[168:171], v[76:79], a[172:175], v[168:171]
    s_waitcnt lgkmcnt(15)
    v_mfma_f32_16x16x32_bf16 v[164:167], v[80:83], a[112:115], v[164:167]
    v_mfma_f32_16x16x32_bf16 v[160:163], a[48:51], v[80:83], v[160:163]
    v_mfma_f32_16x16x32_bf16 v[168:171], v[80:83], a[176:179], v[168:171]
    s_waitcnt lgkmcnt(15)
    v_mfma_f32_16x16x32_bf16 v[164:167], v[84:87], a[116:119], v[164:167]
    v_mfma_f32_16x16x32_bf16 v[160:163], a[52:55], v[84:87], v[160:163]
    v_mfma_f32_16x16x32_bf16 v[168:171], v[84:87], a[180:183], v[168:171]
    s_waitcnt lgkmcnt(15)
    v_mfma_f32_16x16x32_bf16 v[164:167], v[88:91], a[120:123], v[164:167]
    v_mfma_f32_16x16x32_bf16 v[160:163], a[56:59], v[88:91], v[160:163]
    v_mfma_f32_16x16x32_bf16 v[168:171], v[88:91], a[184:187], v[168:171]
    s_waitcnt lgkmcnt(15)
    v_mfma_f32_16x16x32_bf16 v[164:167], v[92:95], a[124:127], v[164:167]
    v_mfma_f32_16x16x32_bf16 v[160:163], a[60:63], v[92:95], v[160:163]
    v_mfma_f32_16x16x32_bf16 v[168:171], v[92:95], a[188:191], v[168:171]
    s_add_u32 s51, s51, 2
    s_waitcnt vmcnt(0)
    ds_read_b128 v[32:35], v216 offset:0
    ds_read_b128 v[36:39], v217 offset:0
    ds_read_b128 v[40:43], v218 offset:0
    ds_read_b128 v[44:47], v219 offset:0
    ds_read_b128 v[48:51], v216 offset:256
    ds_read_b128 v[52:55], v217 offset:256
    ds_read_b128 v[56:59], v218 offset:256
    ds_read_b128 v[60:63], v219 offset:256
    s_lshl_b32 s41, s51, 10
    v_add_u32 v108, s41, v10
    ds_read_b128 v[64:67], v216 offset:512
    s_waitcnt lgkmcnt(8)
    v_mfma_f32_16x16x32_bf16 v[100:103], v[32:35], a[64:67], 0
    v_mul_f32 v112, s67, v164
    v_min_f32 v112, 0, v112
    v_mfma_f32_16x16x32_bf16 v[96:99], a[0:3], v[32:35], 0
    v_mul_f32 v113, s67, v165
    v_min_f32 v113, 0, v113
    v_mfma_f32_16x16x32_bf16 v[104:107], v[32:35], a[128:131], 0
    v_mul_f32 v114, s67, v166
    v_min_f32 v114, 0, v114
    ds_read_b128 v[68:71], v217 offset:512
    s_waitcnt lgkmcnt(8)
    v_mfma_f32_16x16x32_bf16 v[100:103], v[36:39], a[68:71], v[100:103]
    v_mul_f32 v115, s67, v167
    v_min_f32 v115, 0, v115
    v_mfma_f32_16x16x32_bf16 v[96:99], a[4:7], v[36:39], v[96:99]
    v_exp_f32 v112, v112
    v_exp_f32 v113, v113
    v_mfma_f32_16x16x32_bf16 v[104:107], v[36:39], a[132:135], v[104:107]
    v_exp_f32 v114, v114
    v_exp_f32 v115, v115
    ds_read_b128 v[72:75], v218 offset:512
    s_waitcnt lgkmcnt(8)
    v_mfma_f32_16x16x32_bf16 v[100:103], v[40:43], a[72:75], v[100:103]
    v_max_f32 v164, 0, v164
    v_max_f32 v165, 0, v165
    v_mfma_f32_16x16x32_bf16 v[96:99], a[8:11], v[40:43], v[96:99]
    v_max_f32 v166, 0, v166
    v_max_f32 v167, 0, v167
    v_mfma_f32_16x16x32_bf16 v[104:107], v[40:43], a[136:139], v[104:107]
    v_add_f32 v112, 0x358637bd, v112
    v_add_f32 v113, 0x358637bd, v113
    ds_read_b128 v[76:79], v219 offset:512
    s_waitcnt lgkmcnt(8)
    v_mfma_f32_16x16x32_bf16 v[100:103], v[44:47], a[76:79], v[100:103]
    v_add_f32 v114, 0x358637bd, v114
    v_add_f32 v115, 0x358637bd, v115
    v_mfma_f32_16x16x32_bf16 v[96:99], a[12:15], v[44:47], v[96:99]
    v_add_f32 v164, v164, v112
    v_add_f32 v165, v165, v113
    v_mfma_f32_16x16x32_bf16 v[104:107], v[44:47], a[140:143], v[104:107]
    v_add_f32 v166, v166, v114
    v_add_f32 v167, v167, v115
    ds_read_b128 v[80:83], v216 offset:768
    s_waitcnt lgkmcnt(8)
    v_mfma_f32_16x16x32_bf16 v[100:103], v[48:51], a[80:83], v[100:103]
    v_cvt_pk_bf16_f32 v116, v164, v165
    v_cvt_pk_bf16_f32 v117, v166, v167
    v_mfma_f32_16x16x32_bf16 v[96:99], a[16:19], v[48:51], v[96:99]
    v_cvt_pk_bf16_f32 v118, v168, v169
    v_cvt_pk_bf16_f32 v119, v170, v171
    v_mfma_f32_16x16x32_bf16 v[104:107], v[48:51], a[144:147], v[104:107]
    v_mul_f32 v112, s67, v160
    v_min_f32 v112, 0, v112
    ds_read_b128 v[84:87], v217 offset:768
    s_waitcnt lgkmcnt(8)
    v_mfma_f32_16x16x32_bf16 v[100:103], v[52:55], a[84:87], v[100:103]
    v_mul_f32 v113, s67, v161
    v_min_f32 v113, 0, v113
    v_mfma_f32_16x16x32_bf16 v[96:99], a[20:23], v[52:55], v[96:99]
    v_mul_f32 v114, s67, v162
    v_min_f32 v114, 0, v114
    v_mfma_f32_16x16x32_bf16 v[104:107], v[52:55], a[148:151], v[104:107]
    v_mul_f32 v115, s67, v163
    v_min_f32 v115, 0, v115
    ds_read_b128 v[88:91], v218 offset:768
    s_waitcnt lgkmcnt(8)
    v_mfma_f32_16x16x32_bf16 v[100:103], v[56:59], a[88:91], v[100:103]
    v_exp_f32 v112, v112
    v_exp_f32 v113, v113
    v_mfma_f32_16x16x32_bf16 v[96:99], a[24:27], v[56:59], v[96:99]
    v_exp_f32 v114, v114
    v_exp_f32 v115, v115
    v_mfma_f32_16x16x32_bf16 v[104:107], v[56:59], a[152:155], v[104:107]
    v_max_f32 v160, 0, v160
    v_max_f32 v161, 0, v161
    ds_read_b128 v[92:95], v219 offset:768
    s_waitcnt lgkmcnt(8)
    v_mfma_f32_16x16x32_bf16 v[100:103], v[60:63], a[92:95], v[100:103]
    v_max_f32 v162, 0, v162
    v_max_f32 v163, 0, v163
    v_mfma_f32_16x16x32_bf16 v[96:99], a[28:31], v[60:63], v[96:99]
    v_add_f32 v112, 0x358637bd, v112
    v_add_f32 v113, 0x358637bd, v113
    v_mfma_f32_16x16x32_bf16 v[104:107], v[60:63], a[156:159], v[104:107]
    v_add_f32 v114, 0x358637bd, v114
    v_add_f32 v115, 0x358637bd, v115
    s_waitcnt lgkmcnt(7)
    v_mfma_f32_16x16x32_bf16 v[100:103], v[64:67], a[96:99], v[100:103]
    v_add_f32 v160, v160, v112
    v_add_f32 v161, v161, v113
    v_mfma_f32_16x16x32_bf16 v[96:99], a[32:35], v[64:67], v[96:99]
    v_add_f32 v162, v162, v114
    v_add_f32 v163, v163, v115
    v_mfma_f32_16x16x32_bf16 v[104:107], v[64:67], a[160:163], v[104:107]
    v_mfma_f32_16x16x16_bf16 v[24:27], v[116:117], v[118:119], v[24:27]
    v_mfma_f32_16x16x16_bf16 v[28:31], v[116:117], v[16:17], v[28:31]
    s_waitcnt lgkmcnt(0)
    v_mfma_f32_16x16x32_bf16 v[100:103], v[68:71], a[100:103], v[100:103]
    v_cvt_pk_bf16_f32 v120, v160, v161
    v_cvt_pk_bf16_f32 v121, v162, v163
    v_mfma_f32_16x16x32_bf16 v[96:99], a[36:39], v[68:71], v[96:99]
    ds_write_b64 v172, v[120:121]
    v_mfma_f32_16x16x32_bf16 v[104:107], v[68:71], a[164:167], v[104:107]
    s_waitcnt lgkmcnt(15)
    v_mfma_f32_16x16x32_bf16 v[100:103], v[72:75], a[104:107], v[100:103]
    v_mfma_f32_16x16x32_bf16 v[96:99], a[40:43], v[72:75], v[96:99]
    v_mfma_f32_16x16x32_bf16 v[104:107], v[72:75], a[168:171], v[104:107]
    s_waitcnt lgkmcnt(15)
    v_mfma_f32_16x16x32_bf16 v[100:103], v[76:79], a[108:111], v[100:103]
    v_mfma_f32_16x16x32_bf16 v[96:99], a[44:47], v[76:79], v[96:99]
    v_mfma_f32_16x16x32_bf16 v[104:107], v[76:79], a[172:175], v[104:107]
    s_waitcnt lgkmcnt(15)
    v_mfma_f32_16x16x32_bf16 v[100:103], v[80:83], a[112:115], v[100:103]
    v_mfma_f32_16x16x32_bf16 v[96:99], a[48:51], v[80:83], v[96:99]
    v_mfma_f32_16x16x32_bf16 v[104:107], v[80:83], a[176:179], v[104:107]
    s_waitcnt lgkmcnt(15)
    v_mfma_f32_16x16x32_bf16 v[100:103], v[84:87], a[116:119], v[100:103]
    v_mfma_f32_16x16x32_bf16 v[96:99], a[52:55], v[84:87], v[96:99]
    v_mfma_f32_16x16x32_bf16 v[104:107], v[84:87], a[180:183], v[104:107]
    s_waitcnt lgkmcnt(15)
    v_mfma_f32_16x16x32_bf16 v[100:103], v[88:91], a[120:123], v[100:103]
    v_mfma_f32_16x16x32_bf16 v[96:99], a[56:59], v[88:91], v[96:99]
    v_mfma_f32_16x16x32_bf16 v[104:107], v[88:91], a[184:187], v[104:107]
    s_waitcnt lgkmcnt(15)
    v_mfma_f32_16x16x32_bf16 v[100:103], v[92:95], a[124:127], v[100:103]
    v_mfma_f32_16x16x32_bf16 v[96:99], a[60:63], v[92:95], v[96:99]
    v_mfma_f32_16x16x32_bf16 v[104:107], v[92:95], a[188:191], v[104:107]
    s_nop 5
    v_mul_f32 v112, s67, v100
    v_min_f32 v112, 0, v112
    v_mul_f32 v113, s67, v101
    v_min_f32 v113, 0, v113
    v_mul_f32 v114, s67, v102
    v_min_f32 v114, 0, v114
    v_mul_f32 v115, s67, v103
    v_min_f32 v115, 0, v115
    v_exp_f32 v112, v112
    v_exp_f32 v113, v113
    v_exp_f32 v114, v114
    v_exp_f32 v115, v115
    v_max_f32 v100, 0, v100
    v_max_f32 v101, 0, v101
    v_max_f32 v102, 0, v102
    v_max_f32 v103, 0, v103
    v_add_f32 v112, 0x358637bd, v112
    v_add_f32 v113, 0x358637bd, v113
    v_add_f32 v114, 0x358637bd, v114
    v_add_f32 v115, 0x358637bd, v115
    v_add_f32 v100, v100, v112
    v_add_f32 v101, v101, v113
    v_add_f32 v102, v102, v114
    v_add_f32 v103, v103, v115
    v_cvt_pk_bf16_f32 v116, v100, v101
    v_cvt_pk_bf16_f32 v117, v102, v103
    v_cvt_pk_bf16_f32 v118, v104, v105
    v_cvt_pk_bf16_f32 v119, v106, v107
    v_mul_f32 v112, s67, v96
    v_min_f32 v112, 0, v112
    v_mul_f32 v113, s67, v97
    v_min_f32 v113, 0, v113
    v_mul_f32 v114, s67, v98
    v_min_f32 v114, 0, v114
    v_mul_f32 v115, s67, v99
    v_min_f32 v115, 0, v115
    v_exp_f32 v112, v112
    v_exp_f32 v113, v113
    v_exp_f32 v114, v114
    v_exp_f32 v115, v115
    v_max_f32 v96, 0, v96
    v_max_f32 v97, 0, v97
    v_max_f32 v98, 0, v98
    v_max_f32 v99, 0, v99
    v_add_f32 v112, 0x358637bd, v112
    v_add_f32 v113, 0x358637bd, v113
    v_add_f32 v114, 0x358637bd, v114
    v_add_f32 v115, 0x358637bd, v115
    v_add_f32 v96, v96, v112
    v_add_f32 v97, v97, v113
    v_add_f32 v98, v98, v114
    v_add_f32 v99, v99, v115
    v_mfma_f32_16x16x16_bf16 v[24:27], v[116:117], v[118:119], v[24:27]
    v_mfma_f32_16x16x16_bf16 v[28:31], v[116:117], v[16:17], v[28:31]
    v_cvt_pk_bf16_f32 v120, v96, v97
    v_cvt_pk_bf16_f32 v121, v98, v99
    ds_write_b64 v108, v[120:121]
    s_add_u32 s51, s51, 2
L_aw_s1t:
    s_waitcnt vmcnt(0)
    s_branch L_aw_s1done
L_aw_s1f:
    s_add_u32 s49, s51, 0
    s_mul_i32 s49, s49, s68
    s_add_u32 s49, s49, s66
    s_cmp_ge_u32 s49, 64
    s_cbranch_scc1 L_aw_s1done
    s_cmp_ge_u32 s49, 62
    s_cbranch_scc1 L_aw_s1p
    s_lshl_b32 s42, s49, 7
    s_add_u32 s42, s42, 0x4000
    s_add_u32 s52, s4, s42
    s_addc_u32 s53, s5, 0
Lwf_163:
    global_load_dword v32, v7, s[52:53] sc1
    s_waitcnt vmcnt(0)
    v_cmp_eq_u32 vcc, 0, v32
    s_cbranch_vccz Lwo_164
    s_sleep 8
    s_add_u32 s101, s101, 1
    s_cmp_gt_u32 s101, 0x40000
    s_cbranch_scc1 L_end
    s_branch Lwf_163
Lwo_164:
    s_lshl_b32 s41, s49, 15
    s_add_u32 s41, s41, s69
    s_add_u32 s41, s41, 0xe00000
    s_add_u32 s52, s4, s41
    s_addc_u32 s53, s5, 0
    s_add_u32 s42, s70, 0
    s_mov_b32 m0, s42
    s_nop 0
    global_load_lds_dwordx4 v1, s[52:53] offset:0 sc1
    global_load_lds_dwordx4 v1, s[52:53] offset:1024 sc1
    global_load_lds_dwordx4 v1, s[52:53] offset:2048 sc1
    global_load_lds_dwordx4 v1, s[52:53] offset:3072 sc1
    s_add_u32 s42, s70, 4096
    s_mov_b32 m0, s42
    s_add_u32 s52, s52, 4096
    s_addc_u32 s53, s53, 0
    global_load_lds_dwordx4 v1, s[52:53] offset:0 sc1
    global_load_lds_dwordx4 v1, s[52:53] offset:1024 sc1
    global_load_lds_dwordx4 v1, s[52:53] offset:2048 sc1
    global_load_lds_dwordx4 v1, s[52:53] offset:3072 sc1
    s_add_u32 s42, s70, 8192
    s_mov_b32 m0, s42
    s_add_u32 s52, s52, 4096
    s_addc_u32 s53, s53, 0
    global_load_lds_dwordx4 v1, s[52:53] offset:0 sc1
    global_load_lds_dwordx4 v1, s[52:53] offset:1024 sc1
    global_load_lds_dwordx4 v1, s[52:53] offset:2048 sc1
    global_load_lds_dwordx4 v1, s[52:53] offset:3072 sc1
    s_add_u32 s42, s70, 12288
    s_mov_b32 m0, s42
    s_add_u32 s52, s52, 4096
    s_addc_u32 s53, s53, 0
    global_load_lds_dwordx4 v1, s[52:53] offset:0 sc1
    global_load_lds_dwordx4 v1, s[52:53] offset:1024 sc1
    global_load_lds_dwordx4 v1, s[52:53] offset:2048 sc1
    global_load_lds_dwordx4 v1, s[52:53] offset:3072 sc1
L_aw_s1q:
    s_waitcnt vmcnt(0)
    ds_read_b128 v[32:35], v216 offset:0
    ds_read_b128 v[36:39], v217 offset:0
    ds_read_b128 v[40:43], v218 offset:0
    ds_read_b128 v[44:47], v219 offset:0
    ds_read_b128 v[48:51], v216 offset:256
    ds_read_b128 v[52:55], v217 offset:256
    ds_read_b128 v[56:59], v218 offset:256
    ds_read_b128 v[60:63], v219 offset:256
    s_lshl_b32 s41, s51, 10
    v_add_u32 v108, s41, v10
    ds_read_b128 v[64:67], v216 offset:512
    s_waitcnt lgkmcnt(8)
    v_mfma_f32_16x16x32_bf16 v[100:103], v[32:35], a[64:67], 0
    v_mfma_f32_16x16x32_bf16 v[96:99], a[0:3], v[32:35], 0
    v_mfma_f32_16x16x32_bf16 v[104:107], v[32:35], a[128:131], 0
    ds_read_b128 v[68:71], v217 offset:512
    s_waitcnt lgkmcnt(8)
    v_mfma_f32_16x16x32_bf16 v[100:103], v[36:39], a[68:71], v[100:103]
    v_mfma_f32_16x16x32_bf16 v[96:99], a[4:7], v[36:39], v[96:99]
    v_mfma_f32_16x16x32_bf16 v[104:107], v[36:39], a[132:135], v[104:107]
    ds_read_b128 v[72:75], v218 offset:512
    s_waitcnt lgkmcnt(8)
    v_mfma_f32_16x16x32_bf16 v[100:103], v[40:43], a[72:75], v[100:103]
    v_mfma_f32_16x16x32_bf16 v[96:99], a[8:11], v[40:43], v[96:99]
    v_mfma_f32_16x16x32_bf16 v[104:107], v[40:43], a[136:139], v[104:107]
    ds_read_b128 v[76:79], v219 offset:512
    s_waitcnt lgkmcnt(8)
    v_mfma_f32_16x16x32_bf16 v[100:103], v[44:47], a[76:79], v[100:103]
    v_mfma_f32_16x16x32_bf16 v[96:99], a[12:15], v[44:47], v[96:99]
    v_mfma_f32_16x16x32_bf16 v[104:107], v[44:47], a[140:143], v[104:107]
    ds_read_b128 v[80:83], v216 offset:768
    s_waitcnt lgkmcnt(8)
    v_mfma_f32_16x16x32_bf16 v[100:103], v[48:51], a[80:83], v[100:103]
    v_mfma_f32_16x16x32_bf16 v[96:99], a[16:19], v[48:51], v[96:99]
    v_mfma_f32_16x16x32_bf16 v[104:107], v[48:51], a[144:147], v[104:107]
    ds_read_b128 v[84:87], v217 offset:768
    s_waitcnt lgkmcnt(8)
    v_mfma_f32_16x16x32_bf16 v[100:103], v[52:55], a[84:87], v[100:103]
    v_mfma_f32_16x16x32_bf16 v[96:99], a[20:23], v[52:55], v[96:99]
    v_mfma_f32_16x16x32_bf16 v[104:107], v[52:55], a[148:151], v[104:107]
    ds_read_b128 v[88:91], v218 offset:768
    s_waitcnt lgkmcnt(8)
    v_mfma_f32_16x16x32_bf16 v[100:103], v[56:59], a[88:91], v[100:103]
    v_mfma_f32_16x16x32_bf16 v[96:99], a[24:27], v[56:59], v[96:99]
    v_mfma_f32_16x16x32_bf16 v[104:107], v[56:59], a[152:155], v[104:107]
    ds_read_b128 v[92:95], v219 offset:768
    s_waitcnt lgkmcnt(8)
    v_mfma_f32_16x16x32_bf16 v[100:103], v[60:63], a[92:95], v[100:103]
    v_mfma_f32_16x16x32_bf16 v[96:99], a[28:31], v[60:63], v[96:99]
    v_mfma_f32_16x16x32_bf16 v[104:107], v[60:63], a[156:159], v[104:107]
    s_waitcnt lgkmcnt(7)
    v_mfma_f32_16x16x32_bf16 v[100:103], v[64:67], a[96:99], v[100:103]
    v_mfma_f32_16x16x32_bf16 v[96:99], a[32:35], v[64:67], v[96:99]
    v_mfma_f32_16x16x32_bf16 v[104:107], v[64:67], a[160:163], v[104:107]
    s_waitcnt lgkmcnt(0)
    v_mfma_f32_16x16x32_bf16 v[100:103], v[68:71], a[100:103], v[100:103]
    v_mfma_f32_16x16x32_bf16 v[96:99], a[36:39], v[68:71], v[96:99]
    v_mfma_f32_16x16x32_bf16 v[104:107], v[68:71], a[164:167], v[104:107]
    s_waitcnt lgkmcnt(15)
    v_mfma_f32_16x16x32_bf16 v[100:103], v[72:75], a[104:107], v[100:103]
    v_mfma_f32_16x16x32_bf16 v[96:99], a[40:43], v[72:75], v[96:99]
    v_mfma_f32_16x16x32_bf16 v[104:107], v[72:75], a[168:171], v[104:107]
    s_waitcnt lgkmcnt(15)
    v_mfma_f32_16x16x32_bf16 v[100:103], v[76:79], a[108:111], v[100:103]
    v_mfma_f32_16x16x32_bf16 v[96:99], a[44:47], v[76:79], v[96:99]
    v_mfma_f32_16x16x32_bf16 v[104:107], v[76:79], a[172:175], v[104:107]
    s_waitcnt lgkmcnt(15)
    v_mfma_f32_16x16x32_bf16 v[100:103], v[80:83], a[112:115], v[100:103]
    v_mfma_f32_16x16x32_bf16 v[96:99], a[48:51], v[80:83], v[96:99]
    v_mfma_f32_16x16x32_bf16 v[104:107], v[80:83], a[176:179], v[104:107]
    s_waitcnt lgkmcnt(15)
    v_mfma_f32_16x16x32_bf16 v[100:103], v[84:87], a[116:119], v[100:103]
    v_mfma_f32_16x16x32_bf16 v[96:99], a[52:55], v[84:87], v[96:99]
    v_mfma_f32_16x16x32_bf16 v[104:107], v[84:87], a[180:183], v[104:107]
    s_waitcnt lgkmcnt(15)
    v_mfma_f32_16x16x32_bf16 v[100:103], v[88:91], a[120:123], v[100:103]
    v_mfma_f32_16x16x32_bf16 v[96:99], a[56:59], v[88:91], v[96:99]
    v_mfma_f32_16x16x32_bf16 v[104:107], v[88:91], a[184:187], v[104:107]
    s_waitcnt lgkmcnt(15)
    v_mfma_f32_16x16x32_bf16 v[100:103], v[92:95], a[124:127], v[100:103]
    v_mfma_f32_16x16x32_bf16 v[96:99], a[60:63], v[92:95], v[96:99]
    v_mfma_f32_16x16x32_bf16 v[104:107], v[92:95], a[188:191], v[104:107]
    s_nop 5
    v_mul_f32 v112, s67, v100
    v_min_f32 v112, 0, v112
    v_mul_f32 v113, s67, v101
    v_min_f32 v113, 0, v113
    v_mul_f32 v114, s67, v102
    v_min_f32 v114, 0, v114
    v_mul_f32 v115, s67, v103
    v_min_f32 v115, 0, v115
    v_exp_f32 v112, v112
    v_exp_f32 v113, v113
    v_exp_f32 v114, v114
    v_exp_f32 v115, v115
    v_max_f32 v100, 0, v100
    v_max_f32 v101, 0, v101
    v_max_f32 v102, 0, v102
    v_max_f32 v103, 0, v103
    v_add_f32 v112, 0x358637bd, v112
    v_add_f32 v113, 0x358637bd, v113
    v_add_f32 v114, 0x358637bd, v114
    v_add_f32 v115, 0x358637bd, v115
    v_add_f32 v100, v100, v112
    v_add_f32 v101, v101, v113
    v_add_f32 v102, v102, v114
    v_add_f32 v103, v103, v115
    v_cvt_pk_bf16_f32 v116, v100, v101
    v_cvt_pk_bf16_f32 v117, v102, v103
    v_cvt_pk_bf16_f32 v118, v104, v105
    v_cvt_pk_bf16_f32 v119, v106, v107
    v_mul_f32 v112, s67, v96
    v_min_f32 v112, 0, v112
    v_mul_f32 v113, s67, v97
    v_min_f32 v113, 0, v113
    v_mul_f32 v114, s67, v98
    v_min_f32 v114, 0, v114
    v_mul_f32 v115, s67, v99
    v_min_f32 v115, 0, v115
    v_exp_f32 v112, v112
    v_exp_f32 v113, v113
    v_exp_f32 v114, v114
    v_exp_f32 v115, v115
    v_max_f32 v96, 0, v96
    v_max_f32 v97, 0, v97
    v_max_f32 v98, 0, v98
    v_max_f32 v99, 0, v99
    v_add_f32 v112, 0x358637bd, v112
    v_add_f32 v113, 0x358637bd, v113
    v_add_f32 v114, 0x358637bd, v114
    v_add_f32 v115, 0x358637bd, v115
    v_add_f32 v96, v96, v112
    v_add_f32 v97, v97, v113
    v_add_f32 v98, v98, v114
    v_add_f32 v99, v99, v115
    v_mfma_f32_16x16x16_bf16 v[24:27], v[116:117], v[118:119], v[24:27]
    v_mfma_f32_16x16x16_bf16 v[28:31], v[116:117], v[16:17], v[28:31]
    v_cvt_pk_bf16_f32 v120, v96, v97
    v_cvt_pk_bf16_f32 v121, v98, v99
    ds_write_b64 v108, v[120:121]
    s_add_u32 s51, s51, 2
    s_branch L_aw_s1f
L_aw_s1done:
    s_lshl_b32 s41, s48, 5
    s_add_u32 s41, s41, s33
    s_lshl_b32 s41, s41, 14
    s_add_u32 s41, s41, 0x1000000
    s_add_u32 s52, s4, s41
    s_addc_u32 s53, s5, 0
    s_lshl_b32 s43, s66, 11
    s_add_u32 s56, s52, s43
    s_addc_u32 s57, s53, 0
    s_lshl_b32 s42, s34, 15
    v_add_u32 v32, s42, v1
    s_nop 2
    ds_write_b128 v32, v[24:27]
    ds_write_b128 v32, v[28:31] offset:1024
    s_waitcnt lgkmcnt(0)
    s_barrier
    s_cmp_lg_u32 s34, 0
    s_cbranch_scc1 L_aw_nopub
    v_add_u32 v32, 0x10000, v1
    ds_read_b128 v[40:43], v1 offset:32768
    ds_read_b128 v[44:47], v1 offset:33792
    ds_read_b128 v[48:51], v32 offset:0
    ds_read_b128 v[52:55], v32 offset:1024
    ds_read_b128 v[56:59], v32 offset:32768
    ds_read_b128 v[60:63], v32 offset:33792
    s_waitcnt lgkmcnt(0)
    v_pk_add_f32 v[24:25], v[24:25], v[40:41]
    v_pk_add_f32 v[26:27], v[26:27], v[42:43]
    v_pk_add_f32 v[28:29], v[28:29], v[44:45]
    v_pk_add_f32 v[30:31], v[30:31], v[46:47]
    v_pk_add_f32 v[24:25], v[24:25], v[48:49]
    v_pk_add_f32 v[26:27], v[26:27], v[50:51]
    v_pk_add_f32 v[28:29], v[28:29], v[52:53]
    v_pk_add_f32 v[30:31], v[30:31], v[54:55]
    v_pk_add_f32 v[24:25], v[24:25], v[56:57]
    v_pk_add_f32 v[26:27], v[26:27], v[58:59]
    v_pk_add_f32 v[28:29], v[28:29], v[60:61]
    v_pk_add_f32 v[30:31], v[30:31], v[62:63]
    v_min_u32 v24, -2, v24
    v_min_u32 v28, -2, v28
    global_store_dwordx4 v1, v[24:27], s[56:57] sc1
    global_store_dwordx4 v1, v[28:31], s[56:57] offset:1024 sc1
L_aw_nopub:
    s_add_u32 s54, s52, 0x1000
    s_addc_u32 s55, s53, 0
    s_add_u32 s56, s52, 0x2000
    s_addc_u32 s57, s53, 0
    s_cmp_lg_u32 s48, 0
    s_cbranch_scc1 L_aw_g1
L_aw_g0:
    global_load_dwordx4 v[32:35], v1, s[52:53] offset:0 sc1
    global_load_dwordx4 v[36:39], v1, s[52:53] offset:1024 sc1
    global_load_dwordx4 v[40:43], v1, s[52:53] offset:2048 sc1
    global_load_dwordx4 v[44:47], v1, s[52:53] offset:3072 sc1
    global_load_dwordx4 v[48:51], v1, s[54:55] offset:0 sc1
    global_load_dwordx4 v[52:55], v1, s[54:55] offset:1024 sc1
    global_load_dwordx4 v[56:59], v1, s[54:55] offset:2048 sc1
    global_load_dwordx4 v[60:63], v1, s[54:55] offset:3072 sc1
    global_load_dwordx4 v[64:67], v1, s[56:57] offset:0 sc1
    global_load_dwordx4 v[68:71], v1, s[56:57] offset:1024 sc1
    s_add_u32 s101, s101, 1
    s_cmp_gt_u32 s101, 0x40000
    s_cbranch_scc1 L_end
    s_waitcnt vmcnt(0)
    v_max_u32 v8, v32, v36
    v_max3_u32 v8, v8, v40, v44
    v_max3_u32 v8, v8, v48, v52
    v_max3_u32 v8, v8, v56, v60
    v_max3_u32 v8, v8, v64, v68
    v_cmp_eq_u32 vcc, -1, v8
    s_cbranch_vccnz L_aw_g0
    v_pk_add_f32 v[32:33], v[32:33], v[40:41]
    v_pk_add_f32 v[34:35], v[34:35], v[42:43]
    v_pk_add_f32 v[36:37], v[36:37], v[44:45]
    v_pk_add_f32 v[38:39], v[38:39], v[46:47]
    v_pk_add_f32 v[32:33], v[32:33], v[48:49]
    v_pk_add_f32 v[34:35], v[34:35], v[50:51]
    v_pk_add_f32 v[36:37], v[36:37], v[52:53]
    v_pk_add_f32 v[38:39], v[38:39], v[54:55]
    v_pk_add_f32 v[32:33], v[32:33], v[56:57]
    v_pk_add_f32 v[34:35], v[34:35], v[58:59]
    v_pk_add_f32 v[36:37], v[36:37], v[60:61]
    v_pk_add_f32 v[38:39], v[38:39], v[62:63]
    v_pk_add_f32 v[32:33], v[32:33], v[64:65]
    v_pk_add_f32 v[34:35], v[34:35], v[66:67]
    v_pk_add_f32 v[36:37], v[36:37], v[68:69]
    v_pk_add_f32 v[38:39], v[38:39], v[70:71]
    s_branch L_aw_g2
L_aw_g1:
    global_load_dwordx4 v[32:35], v1, s[52:53] offset:0 sc1
    global_load_dwordx4 v[36:39], v1, s[52:53] offset:1024 sc1
    global_load_dwordx4 v[40:43], v1, s[52:53] offset:2048 sc1
    global_load_dwordx4 v[44:47], v1, s[52:53] offset:3072 sc1
    s_add_u32 s101, s101, 1
    s_cmp_gt_u32 s101, 0x40000
    s_cbranch_scc1 L_end
    s_waitcnt vmcnt(0)
    v_max_u32 v8, v32, v36
    v_max3_u32 v8, v8, v40, v44
    v_cmp_eq_u32 vcc, -1, v8
    s_cbranch_vccnz L_aw_g1
    v_pk_add_f32 v[32:33], v[32:33], v[40:41]
    v_pk_add_f32 v[34:35], v[34:35], v[42:43]
    v_pk_add_f32 v[36:37], v[36:37], v[44:45]
    v_pk_add_f32 v[38:39], v[38:39], v[46:47]
L_aw_g2:
    s_barrier
    v_cvt_pk_bf16_f32 v18, v32, v33
    v_cvt_pk_bf16_f32 v19, v34, v35
    v_cvt_pk_bf16_f32 v20, v36, v37
    v_cvt_pk_bf16_f32 v21, v38, v39
    s_mov_b32 s51, 0
    s_mov_b32 s49, s66
    s_mov_b32 s72, 0
L_aw_s2:
    s_lshl_b32 s41, s51, 10
    v_add_u32 v32, s41, v10
    s_cmp_lg_u32 s72, 0
    s_cbranch_scc1 L_aw_pg
    ds_read_b64 v[34:35], v32
L_aw_pb:
    s_lshl_b32 s41, s32, 22
    s_add_u32 s41, s41, s84
    s_add_u32 s41, s41, 0x2000000
    s_add_u32 s54, s4, s41
    s_addc_u32 s55, s5, 0
    s_add_u32 s84, s84, 0x100000
    s_cmp_eq_u32 s84, 0x200000
    s_cselect_b32 s84, 0, s84
    s_lshl_b32 s41, s33, 10
    s_add_u32 s56, s54, s41
    s_addc_u32 s57, s55, 0
    s_lshl_b32 s41, s33, 15
    s_add_u32 s54, s54, s41
    s_addc_u32 s55, s55, 0
    s_lshl_b32 s47, s48, 6
    s_add_u32 s47, s47, s49
    s_lshl_b32 s41, s47, 7
    s_add_u32 s41, s41, 0xc000
    s_add_u32 s60, s4, s41
    s_addc_u32 s61, s5, 0
    s_lshl_b32 s41, s49, 5
    s_add_u32 s41, s41, s33
    s_lshl_b32 s42, s41, 10
    s_lshl_b32 s43, s48, 21
    s_add_u32 s43, s43, s42
    s_add_u32 s44, s43, 0x400000
    s_add_u32 s64, s4, s44
    s_addc_u32 s65, s5, 0
    s_add_u32 s44, s43, 0x800000
    s_add_u32 s58, s4, s44
    s_addc_u32 s59, s5, 0
    s_lshl_b32 s44, s47, 5
    s_add_u32 s44, s44, s33
    s_lshl_b32 s44, s44, 2
    s_add_u32 s44, s44, 0x0
    s_add_u32 s62, s4, s44
    s_addc_u32 s63, s5, 0
    s_add_u32 s44, s42, 0xc00000
    s_add_u32 s52, s4, s44
    s_addc_u32 s53, s5, 0
    s_cmp_lg_u32 s48, 0
    s_cbranch_scc1 L_aw_res
    s_add_u32 s52, s8, s42
    s_addc_u32 s53, s9, 0
L_aw_res:
    global_load_dwordx2 v[196:197], v6, s[52:53] sc1
    s_waitcnt lgkmcnt(0)
    v_mfma_f32_16x16x16_bf16 v[40:43], v[20:21], v[34:35], 0
    v_mfma_f32_16x16x16_bf16 v[36:39], v[18:19], v[34:35], 0
    s_nop 6
    v_add_f32 v40, 0x358637bd, v40
    v_rcp_f32 v40, v40
    s_nop 0
    v_pk_mul_f32 v[36:37], v[36:37], v[40:41] op_sel_hi:[1,0]
    v_pk_mul_f32 v[38:39], v[38:39], v[40:41] op_sel_hi:[1,0]
    v_cvt_pk_bf16_f32 v34, v36, v37
    v_cvt_pk_bf16_f32 v35, v38, v39
    s_nop 1
    v_mfma_f32_16x16x16_bf16 v[48:51], v[128:129], v[34:35], 0
    v_mfma_f32_16x16x16_bf16 v[52:55], v[130:131], v[34:35], 0
    v_mfma_f32_16x16x16_bf16 v[56:59], v[132:133], v[34:35], 0
    v_mfma_f32_16x16x16_bf16 v[60:63], v[134:135], v[34:35], 0
    v_mfma_f32_16x16x16_bf16 v[64:67], v[136:137], v[34:35], 0
    v_mfma_f32_16x16x16_bf16 v[68:71], v[138:139], v[34:35], 0
    v_mfma_f32_16x16x16_bf16 v[72:75], v[140:141], v[34:35], 0
    v_mfma_f32_16x16x16_bf16 v[76:79], v[142:143], v[34:35], 0
    v_mfma_f32_16x16x16_bf16 v[80:83], v[144:145], v[34:35], 0
    v_mfma_f32_16x16x16_bf16 v[84:87], v[146:147], v[34:35], 0
    v_mfma_f32_16x16x16_bf16 v[88:91], v[148:149], v[34:35], 0
    v_mfma_f32_16x16x16_bf16 v[92:95], v[150:151], v[34:35], 0
    v_mfma_f32_16x16x16_bf16 v[96:99], v[152:153], v[34:35], 0
    v_mfma_f32_16x16x16_bf16 v[100:103], v[154:155], v[34:35], 0
    v_mfma_f32_16x16x16_bf16 v[104:107], v[156:157], v[34:35], 0
    v_mfma_f32_16x16x16_bf16 v[108:111], v[158:159], v[34:35], 0
    v_cvt_pk_bf16_f32 v48, v48, v49
    v_cvt_pk_bf16_f32 v49, v50, v51
    v_cvt_pk_bf16_f32 v50, v52, v53
    v_cvt_pk_bf16_f32 v51, v54, v55
    ds_write_b128 v220, v[48:51]
    v_cvt_pk_bf16_f32 v56, v56, v57
    v_cvt_pk_bf16_f32 v57, v58, v59
    v_cvt_pk_bf16_f32 v58, v60, v61
    v_cvt_pk_bf16_f32 v59, v62, v63
    ds_write_b128 v221, v[56:59]
    v_cvt_pk_bf16_f32 v64, v64, v65
    v_cvt_pk_bf16_f32 v65, v66, v67
    v_cvt_pk_bf16_f32 v66, v68, v69
    v_cvt_pk_bf16_f32 v67, v70, v71
    ds_write_b128 v222, v[64:67]
    v_cvt_pk_bf16_f32 v72, v72, v73
    v_cvt_pk_bf16_f32 v73, v74, v75
    v_cvt_pk_bf16_f32 v74, v76, v77
    v_cvt_pk_bf16_f32 v75, v78, v79
    ds_write_b128 v223, v[72:75]
    v_cvt_pk_bf16_f32 v80, v80, v81
    v_cvt_pk_bf16_f32 v81, v82, v83
    v_cvt_pk_bf16_f32 v82, v84, v85
    v_cvt_pk_bf16_f32 v83, v86, v87
    ds_write_b128 v224, v[80:83]
    v_cvt_pk_bf16_f32 v88, v88, v89
    v_cvt_pk_bf16_f32 v89, v90, v91
    v_cvt_pk_bf16_f32 v90, v92, v93
    v_cvt_pk_bf16_f32 v91, v94, v95
    ds_write_b128 v225, v[88:91]
    s_nop 1
    v_cvt_pk_bf16_f32 v96, v96, v97
    v_cvt_pk_bf16_f32 v97, v98, v99
    v_cvt_pk_bf16_f32 v98, v100, v101
    v_cvt_pk_bf16_f32 v99, v102, v103
    ds_write_b128 v226, v[96:99]
    v_cvt_pk_bf16_f32 v104, v104, v105
    v_cvt_pk_bf16_f32 v105, v106, v107
    v_cvt_pk_bf16_f32 v106, v108, v109
    v_cvt_pk_bf16_f32 v107, v110, v111
    ds_write_b128 v227, v[104:107]
    ds_read_b128 v[48:51], v228 offset:0
    ds_read_b128 v[52:55], v229 offset:0
    ds_read_b128 v[56:59], v230 offset:0
    ds_read_b128 v[60:63], v231 offset:0
    ds_read_b128 v[64:67], v232 offset:0
    ds_read_b128 v[68:71], v233 offset:0
    ds_read_b128 v[72:75], v234 offset:0
    ds_read_b128 v[76:79], v235 offset:0
    s_waitcnt lgkmcnt(7)
    s_cmp_lg_u32 s35, 0
    s_cbranch_scc1 Lmx_165
    global_store_dwordx4 v4, v[48:51], s[56:57]
Lmy_166:
    s_add_u32 s56, s56, 0x10000
    s_addc_u32 s57, s57, 0
    s_waitcnt lgkmcnt(6)
    s_cmp_lg_u32 s35, 0
    s_cbranch_scc1 Lmx_167
    global_store_dwordx4 v4, v[52:55], s[56:57]
Lmy_168:
    s_add_u32 s56, s56, 0x10000
    s_addc_u32 s57, s57, 0
    s_waitcnt lgkmcnt(5)
    s_cmp_lg_u32 s35, 0
    s_cbranch_scc1 Lmx_169
    global_store_dwordx4 v4, v[56:59], s[56:57]
Lmy_170:
    s_add_u32 s56, s56, 0x10000
    s_addc_u32 s57, s57, 0
    s_waitcnt lgkmcnt(4)
    s_cmp_lg_u32 s35, 0
    s_cbranch_scc1 Lmx_171
    global_store_dwordx4 v4, v[60:63], s[56:57]
Lmy_172:
    s_add_u32 s56, s56, 0x10000
    s_addc_u32 s57, s57, 0
    s_waitcnt lgkmcnt(3)
    s_cmp_lg_u32 s35, 0
    s_cbranch_scc1 Lmx_173
    global_store_dwordx4 v4, v[64:67], s[56:57]
Lmy_174:
    s_add_u32 s56, s56, 0x10000
    s_addc_u32 s57, s57, 0
    s_waitcnt lgkmcnt(2)
    s_cmp_lg_u32 s35, 0
    s_cbranch_scc1 Lmx_175
    global_store_dwordx4 v4, v[68:71], s[56:57]
Lmy_176:
    s_add_u32 s56, s56, 0x10000
    s_addc_u32 s57, s57, 0
    s_waitcnt lgkmcnt(1)
    s_cmp_lg_u32 s35, 0
    s_cbranch_scc1 Lmx_177
    global_store_dwordx4 v4, v[72:75], s[56:57]
Lmy_178:
    s_add_u32 s56, s56, 0x10000
    s_addc_u32 s57, s57, 0
    s_waitcnt lgkmcnt(0)
    s_cmp_lg_u32 s35, 0
    s_cbranch_scc1 Lmx_179
    global_store_dwordx4 v4, v[76:79], s[56:57]
Lmy_180:
    s_lshl_b32 s40, s33, 2
    v_mov_b32 v32, s40
    v_mov_b32 v33, 1
    s_waitcnt vmcnt(0)
    s_barrier
    s_cmp_lg_u32 s34, 1
    s_cbranch_scc1 Lpp_181
    s_mov_b64 exec, 1
    s_cmp_lg_u32 s35, 0
    s_cbranch_scc1 Lmx_182
    global_store_dword v32, v33, s[60:61]
Lmy_183:
    s_mov_b64 exec, -1
Lpp_181:
    v_add_u32 v209, 4096, v5
    v_add_u32 v210, 8192, v5
    v_add_u32 v211, 12288, v5
    v_add_u32 v212, 16384, v5
    v_add_u32 v213, 20480, v5
    v_add_u32 v214, 24576, v5
    v_add_u32 v215, 28672, v5
    s_and_b32 s41, s50, 1
    s_lshl_b32 s41, s41, 11
    s_add_u32 s41, s41, 32768
Lwf_184:
    global_load_dword v200, v7, s[60:61] sc1
    s_waitcnt vmcnt(0)
    v_cmp_eq_u32 vcc, 0, v200
    s_cbranch_vccz Lwo_185
    s_add_u32 s101, s101, 1
    s_cmp_gt_u32 s101, 0x40000
    s_cbranch_scc1 L_end
    s_branch Lwf_184
Lwo_185:
    global_load_dwordx4 v[160:163], v5, s[54:55] sc1
    global_load_dwordx4 v[164:167], v209, s[54:55] sc1
    global_load_dwordx4 v[168:171], v210, s[54:55] sc1
    global_load_dwordx4 v[172:175], v211, s[54:55] sc1
    global_load_dwordx4 v[176:179], v212, s[54:55] sc1
    global_load_dwordx4 v[180:183], v213, s[54:55] sc1
    global_load_dwordx4 v[184:187], v214, s[54:55] sc1
    global_load_dwordx4 v[188:191], v215, s[54:55] sc1
    v_lshlrev_b32 v200, 16, v196
    v_and_b32 v201, 0xffff0000, v196
    v_lshlrev_b32 v202, 16, v197
    v_and_b32 v203, 0xffff0000, v197
    s_add_u32 s42, s41, 32
    v_add_u32 v204, s42, v6
    v_add_u32 v206, s42, v1
    s_lshl_b32 s40, s34, 3
    s_add_u32 s40, s40, s41
    v_mov_b32 v205, s40
    v_mov_b32 v207, s41
    s_waitcnt vmcnt(7)
    v_mfma_f32_16x16x32_bf16 v[192:195], v[12:15], v[160:163], 0
    s_waitcnt vmcnt(6)
    v_mfma_f32_16x16x32_bf16 v[192:195], v[12:15], v[164:167], v[192:195]
    s_waitcnt vmcnt(5)
    v_mfma_f32_16x16x32_bf16 v[192:195], v[12:15], v[168:171], v[192:195]
    s_waitcnt vmcnt(4)
    v_mfma_f32_16x16x32_bf16 v[192:195], v[12:15], v[172:175], v[192:195]
    s_waitcnt vmcnt(3)
    v_mfma_f32_16x16x32_bf16 v[192:195], v[12:15], v[176:179], v[192:195]
    s_waitcnt vmcnt(2)
    v_mfma_f32_16x16x32_bf16 v[192:195], v[12:15], v[180:183], v[192:195]
    s_waitcnt vmcnt(1)
    v_mfma_f32_16x16x32_bf16 v[192:195], v[12:15], v[184:187], v[192:195]
    s_waitcnt vmcnt(0)
    v_mfma_f32_16x16x32_bf16 v[192:195], v[12:15], v[188:191], v[192:195]
    s_nop 7
    v_cvt_pk_bf16_f32 v196, v192, v193
    v_cvt_pk_bf16_f32 v197, v194, v195
    v_lshlrev_b32 v192, 16, v196
    v_and_b32 v193, 0xffff0000, v196
    v_lshlrev_b32 v194, 16, v197
    v_and_b32 v195, 0xffff0000, v197
    v_add_f32 v192, v192, v200
    v_add_f32 v193, v193, v201
    v_add_f32 v194, v194, v202
    v_add_f32 v195, v195, v203
    v_cvt_pk_bf16_f32 v196, v192, v193
    v_cvt_pk_bf16_f32 v197, v194, v195
    s_cmp_eq_u32 s48, 2
    s_cbranch_scc1 Lfin_187
    ds_write_b64 v204, v[196:197]
    v_lshlrev_b32 v192, 16, v196
    v_and_b32 v193, 0xffff0000, v196
    v_lshlrev_b32 v194, 16, v197
    v_and_b32 v195, 0xffff0000, v197
    v_add_f32 v200, v192, v193
    v_mul_f32 v201, v192, v192
    v_add_f32 v200, v200, v194
    v_fmac_f32 v201, v193, v193
    v_add_f32 v200, v200, v195
    v_fmac_f32 v201, v194, v194
    v_fmac_f32 v201, v195, v195
    s_nop 0
    s_nop 0
    v_add_f32_dpp v202, v200, v200 row_ror:8 row_mask:0xf bank_mask:0xf
    v_add_f32_dpp v203, v201, v201 row_ror:8 row_mask:0xf bank_mask:0xf
    s_nop 0
    v_add_f32_dpp v200, v202, v202 row_ror:4 row_mask:0xf bank_mask:0xf
    v_add_f32_dpp v201, v203, v203 row_ror:4 row_mask:0xf bank_mask:0xf
    s_nop 0
    v_add_f32_dpp v202, v200, v200 row_ror:2 row_mask:0xf bank_mask:0xf
    v_add_f32_dpp v203, v201, v201 row_ror:2 row_mask:0xf bank_mask:0xf
    s_nop 0
    v_add_f32_dpp v200, v202, v202 row_ror:1 row_mask:0xf bank_mask:0xf
    v_add_f32_dpp v201, v203, v203 row_ror:1 row_mask:0xf bank_mask:0xf
    v_mov_b64 v[202:203], v[200:201]
    s_nop 1
    v_permlane16_swap_b32 v200, v202
    v_permlane16_swap_b32 v201, v203
    v_pk_add_f32 v[200:201], v[200:201], v[202:203]
    ds_write_b64 v205, v[200:201]
    s_waitcnt lgkmcnt(0)
    s_barrier
    s_cmp_lg_u32 s34, 0
    s_cbranch_scc1 Lrdone_186
    ds_read_b128 v[168:171], v206 offset:0
    ds_read_b128 v[160:163], v207 offset:0
    ds_read_b128 v[164:167], v207 offset:16
    s_waitcnt lgkmcnt(2)
    global_store_dwordx4 v1, v[168:171], s[64:65] sc1
    v_lshlrev_b32 v176, 16, v168
    v_and_b32 v177, 0xffff0000, v168
    v_lshlrev_b32 v178, 16, v169
    v_and_b32 v179, 0xffff0000, v169
    v_lshlrev_b32 v180, 16, v170
    v_and_b32 v181, 0xffff0000, v170
    v_lshlrev_b32 v182, 16, v171
    v_and_b32 v183, 0xffff0000, v171
    s_waitcnt lgkmcnt(0)
    v_pk_add_f32 v[160:161], v[160:161], v[162:163]
    v_pk_add_f32 v[164:165], v[164:165], v[166:167]
    v_pk_add_f32 v[160:161], v[160:161], v[164:165]
    v_mul_f32 v200, 0x3b000000, v160
    v_mul_f32 v201, 0x3b000000, v161
    v_fma_f32 v201, -v200, v200, v201
    v_max_f32 v201, 0, v201
    v_cvt_pk_bf16_f32 v201, v201, v201
    v_and_b32 v201, 0xffff0000, v201
    v_add_f32 v201, 0x3727c5ac, v201
    v_cvt_pk_bf16_f32 v201, v201, v201
    v_and_b32 v201, 0xffff0000, v201
    v_sqrt_f32 v201, v201
    v_cvt_pk_bf16_f32 v200, v200, v200
    v_and_b32 v200, 0xffff0000, v200
    v_cvt_pk_bf16_f32 v201, v201, v201
    v_and_b32 v201, 0xffff0000, v201
    v_rcp_f32 v201, v201
    v_sub_f32 v176, v176, v200
    v_sub_f32 v177, v177, v200
    v_sub_f32 v178, v178, v200
    v_sub_f32 v179, v179, v200
    v_sub_f32 v180, v180, v200
    v_sub_f32 v181, v181, v200
    v_sub_f32 v182, v182, v200
    v_sub_f32 v183, v183, v200
    v_cvt_pk_bf16_f32 v172, v176, v177
    v_cvt_pk_bf16_f32 v173, v178, v179
    v_cvt_pk_bf16_f32 v174, v180, v181
    v_cvt_pk_bf16_f32 v175, v182, v183
    v_lshlrev_b32 v176, 16, v172
    v_and_b32 v177, 0xffff0000, v172
    v_lshlrev_b32 v178, 16, v173
    v_and_b32 v179, 0xffff0000, v173
    v_lshlrev_b32 v180, 16, v174
    v_and_b32 v181, 0xffff0000, v174
    v_lshlrev_b32 v182, 16, v175
    v_and_b32 v183, 0xffff0000, v175
    v_pk_mul_f32 v[176:177], v[176:177], v[200:201] op_sel:[0,1] op_sel_hi:[1,1]
    v_pk_mul_f32 v[178:179], v[178:179], v[200:201] op_sel:[0,1] op_sel_hi:[1,1]
    v_pk_mul_f32 v[180:181], v[180:181], v[200:201] op_sel:[0,1] op_sel_hi:[1,1]
    v_pk_mul_f32 v[182:183], v[182:183], v[200:201] op_sel:[0,1] op_sel_hi:[1,1]
    v_cvt_pk_bf16_f32 v172, v176, v177
    v_cvt_pk_bf16_f32 v173, v178, v179
    v_cvt_pk_bf16_f32 v174, v180, v181
    v_cvt_pk_bf16_f32 v175, v182, v183
    v_min_u32 v172, -2, v172
    s_and_b32 s40, s33, 15
    s_lshl_b32 s40, s40, 4
    v_xor_b32 v202, s40, v1
    global_store_dwordx4 v202, v[172:175], s[58:59] sc1
    v_mov_b32 v201, 1
    s_waitcnt vmcnt(0)
    s_mov_b64 exec, 1
    global_store_dword v1, v201, s[62:63] sc1
    s_mov_b64 exec, -1
Lrdone_186:
    s_add_u32 s50, s50, 1
    s_add_u32 s51, s51, 1
    s_add_u32 s49, s49, s68
    s_cmp_lt_u32 s49, s71
    s_cbranch_scc1 L_aw_s2
    s_cmp_eq_u32 s71, 64
    s_cbranch_scc1 L_aw_ld
    s_add_u32 s41, s34, 0
    s_mul_i32 s42, s41, 5
    s_add_u32 s42, s42, s49
    s_cmp_lt_u32 s42, 64
    s_cselect_b32 s41, s41, 0
    s_cselect_b32 s42, s42, s49
    s_add_u32 s41, s41, s51
    s_lshl_b32 s41, s41, 10
    s_add_u32 s41, s41, 131072
    v_add_u32 v32, s41, v1
    ds_read_b128 v[36:39], v32 offset:0
    s_lshl_b32 s42, s42, 5
    s_add_u32 s42, s42, s33
    s_lshl_b32 s42, s42, 10
    s_add_u32 s42, s42, 0x1a00000
    s_add_u32 s52, s4, s42
    s_addc_u32 s53, s5, 0
    s_waitcnt lgkmcnt(0)
    global_store_dwordx4 v1, v[36:39], s[52:53] sc1
    s_lshl_b32 s41, s33, 5
    s_add_u32 s41, s41, 0x18000
    s_add_u32 s74, s4, s41
    s_addc_u32 s75, s5, 0
    s_lshl_b32 s42, s66, 2
    v_mov_b32 v32, s42
    v_mov_b32 v33, 1
    s_waitcnt vmcnt(0)
    s_barrier
    s_mov_b64 exec, 1
    global_store_dword v32, v33, s[74:75] sc1
    s_mov_b64 exec, -1
    s_cmp_ge_u32 s66, 2
    s_cbranch_scc1 L_p2
    v_lshrrev_b32 v8, 4, v1
    v_min_u32 v8, 4, v8
    v_lshlrev_b32 v8, 2, v8
Lwf_188:
    global_load_dword v32, v8, s[74:75] sc1
    s_waitcnt vmcnt(0)
    v_cmp_eq_u32 vcc, 0, v32
    s_cbranch_vccz Lwo_189
    s_sleep 2
    s_add_u32 s101, s101, 1
    s_cmp_gt_u32 s101, 0x40000
    s_cbranch_scc1 L_end
    s_branch Lwf_188
Lwo_189:
    s_mov_b32 s68, 2
    s_mov_b32 s71, 64
    s_mov_b32 s72, 1
    s_add_u32 s49, s66, 45
    s_add_u32 s41, s49, 0
    s_min_u32 s41, s41, 63
    s_lshl_b32 s41, s41, 5
    s_add_u32 s41, s41, s33
    s_lshl_b32 s41, s41, 10
    s_add_u32 s41, s41, 0x1a00000
    s_add_u32 s74, s4, s41
    s_addc_u32 s75, s5, 0
    global_load_dwordx2 v[22:23], v11, s[74:75] sc1
    s_waitcnt vmcnt(0)
    s_branch L_aw_s2
L_aw_ld:
    s_add_u32 s48, s48, 1
    s_cmp_lt_u32 s48, 2
    s_cbranch_scc1 L_aw_layer
    s_branch L_end
L_aw_s1p:
    s_lshl_b32 s41, s49, 15
    s_add_u32 s41, s41, s69
    s_add_u32 s41, s41, 0xe00000
    s_add_u32 s52, s4, s41
    s_addc_u32 s53, s5, 0
    s_add_u32 s54, s52, 0x1000
    s_addc_u32 s55, s53, 0
    s_add_u32 s56, s52, 0x2000
    s_addc_u32 s57, s53, 0
    s_add_u32 s58, s52, 0x3000
    s_addc_u32 s59, s53, 0
    v_add_u32 v109, s70, v1
Lpt_190:
    global_load_dwordx4 v[32:35], v1, s[52:53] offset:0 sc1
    global_load_dwordx4 v[36:39], v1, s[52:53] offset:1024 sc1
    global_load_dwordx4 v[40:43], v1, s[52:53] offset:2048 sc1
    global_load_dwordx4 v[44:47], v1, s[52:53] offset:3072 sc1
    global_load_dwordx4 v[48:51], v1, s[54:55] offset:0 sc1
    global_load_dwordx4 v[52:55], v1, s[54:55] offset:1024 sc1
    global_load_dwordx4 v[56:59], v1, s[54:55] offset:2048 sc1
    global_load_dwordx4 v[60:63], v1, s[54:55] offset:3072 sc1
    global_load_dwordx4 v[64:67], v1, s[56:57] offset:0 sc1
    global_load_dwordx4 v[68:71], v1, s[56:57] offset:1024 sc1
    global_load_dwordx4 v[72:75], v1, s[56:57] offset:2048 sc1
    global_load_dwordx4 v[76:79], v1, s[56:57] offset:3072 sc1
    global_load_dwordx4 v[80:83], v1, s[58:59] offset:0 sc1
    global_load_dwordx4 v[84:87], v1, s[58:59] offset:1024 sc1
    global_load_dwordx4 v[88:91], v1, s[58:59] offset:2048 sc1
    global_load_dwordx4 v[92:95], v1, s[58:59] offset:3072 sc1
    s_add_u32 s101, s101, 1
    s_cmp_gt_u32 s101, 0x40000
    s_cbranch_scc1 L_end
    s_waitcnt vmcnt(0)
    v_max_u32 v108, v32, v36
    v_max3_u32 v108, v108, v40, v44
    v_max3_u32 v108, v108, v48, v52
    v_max3_u32 v108, v108, v56, v60
    v_max3_u32 v108, v108, v64, v68
    v_max3_u32 v108, v108, v72, v76
    v_max3_u32 v108, v108, v80, v84
    v_max3_u32 v108, v108, v88, v92
    v_cmp_eq_u32 vcc, -1, v108
    s_cbranch_vccnz Lpt_190
    ds_write_b128 v109, v[32:35] offset:0
    ds_write_b128 v109, v[36:39] offset:1024
    ds_write_b128 v109, v[40:43] offset:2048
    ds_write_b128 v109, v[44:47] offset:3072
    ds_write_b128 v109, v[48:51] offset:4096
    ds_write_b128 v109, v[52:55] offset:5120
    ds_write_b128 v109, v[56:59] offset:6144
    ds_write_b128 v109, v[60:63] offset:7168
    ds_write_b128 v109, v[64:67] offset:8192
    ds_write_b128 v109, v[68:71] offset:9216
    ds_write_b128 v109, v[72:75] offset:10240
    ds_write_b128 v109, v[76:79] offset:11264
    ds_write_b128 v109, v[80:83] offset:12288
    ds_write_b128 v109, v[84:87] offset:13312
    ds_write_b128 v109, v[88:91] offset:14336
    ds_write_b128 v109, v[92:95] offset:15360
    s_waitcnt lgkmcnt(0)
    s_branch L_aw_s1q
L_aw_pg:
    v_mov_b64 v[34:35], v[22:23]
    s_add_u32 s41, s49, 2
    s_min_u32 s41, s41, 63
    s_lshl_b32 s41, s41, 5
    s_add_u32 s41, s41, s33
    s_lshl_b32 s41, s41, 10
    s_add_u32 s41, s41, 0x1a00000
    s_add_u32 s74, s4, s41
    s_addc_u32 s75, s5, 0
    global_load_dwordx2 v[22:23], v11, s[74:75] sc1
    s_branch L_aw_pb
Lmx_165:
    global_store_dwordx4 v4, v[48:51], s[56:57] sc1
    s_branch Lmy_166
Lmx_167:
    global_store_dwordx4 v4, v[52:55], s[56:57] sc1
    s_branch Lmy_168
Lmx_169:
    global_store_dwordx4 v4, v[56:59], s[56:57] sc1
    s_branch Lmy_170
Lmx_171:
    global_store_dwordx4 v4, v[60:63], s[56:57] sc1
    s_branch Lmy_172
Lmx_173:
    global_store_dwordx4 v4, v[64:67], s[56:57] sc1
    s_branch Lmy_174
Lmx_175:
    global_store_dwordx4 v4, v[68:71], s[56:57] sc1
    s_branch Lmy_176
Lmx_177:
    global_store_dwordx4 v4, v[72:75], s[56:57] sc1
    s_branch Lmy_178
Lmx_179:
    global_store_dwordx4 v4, v[76:79], s[56:57] sc1
    s_branch Lmy_180
Lmx_182:
    global_store_dword v32, v33, s[60:61] sc1
    s_branch Lmy_183
Lfin_187:
    global_store_dwordx2 v6, v[196:197], s[64:65]
    s_branch Lrdone_186
L_overflow:
    s_cmp_lg_u32 s34, 0
    s_cbranch_scc1 L_of1
    v_mov_b32 v1, 100
    v_mov_b32 v2, 1
    s_mov_b64 exec, 1
    global_atomic_add v3, v1, v2, s[30:31] sc0
    s_waitcnt vmcnt(0)
    ds_write_b32 v6, v3
    s_mov_b64 exec, -1
L_of1:
    s_waitcnt lgkmcnt(0)
    s_barrier
    ds_read_b32 v3, v6
    s_waitcnt lgkmcnt(0)
    v_readfirstlane_b32 s38, v3
    s_barrier
    s_mov_b32 s32, 0
    v_and_b32 v41, 63, v0
    v_lshlrev_b32 v41, 2, v41
Liw_191:
    global_load_dword v40, v41, s[30:31] sc1
    s_waitcnt vmcnt(0)
    s_mov_b32 s36, 0
    v_readlane_b32 s37, v40, 0
    s_add_u32 s36, s36, s37
    v_readlane_b32 s37, v40, 1
    s_add_u32 s36, s36, s37
    v_readlane_b32 s37, v40, 2
    s_add_u32 s36, s36, s37
    v_readlane_b32 s37, v40, 3
    s_add_u32 s36, s36, s37
    v_readlane_b32 s37, v40, 32
    s_add_u32 s36, s36, s37
    v_readlane_b32 s37, v40, 33
    s_add_u32 s36, s36, s37
    v_readlane_b32 s37, v40, 34
    s_add_u32 s36, s36, s37
    v_readlane_b32 s37, v40, 35
    s_add_u32 s36, s36, s37
    v_readlane_b32 s37, v40, 4
    s_add_u32 s36, s36, s37
    v_readlane_b32 s37, v40, 5
    s_add_u32 s36, s36, s37
    v_readlane_b32 s37, v40, 6
    s_add_u32 s36, s36, s37
    v_readlane_b32 s37, v40, 7
    s_add_u32 s36, s36, s37
    v_readlane_b32 s37, v40, 36
    s_add_u32 s36, s36, s37
    v_readlane_b32 s37, v40, 37
    s_add_u32 s36, s36, s37
    v_readlane_b32 s37, v40, 38
    s_add_u32 s36, s36, s37
    v_readlane_b32 s37, v40, 39
    s_add_u32 s36, s36, s37
    s_cmp_ge_u32 s36, 256
    s_cbranch_scc1 Liwd_192
    s_sleep 2
    s_add_u32 s101, s101, 1
    s_cmp_gt_u32 s101, 0x40000
    s_cbranch_scc1 L_end
    s_branch Liw_191
Liwd_192:
    s_barrier
    s_mov_b32 s32, 0
L_of2:
    s_and_b32 s37, s32, 4
    s_lshl_b32 s37, s37, 5
    s_and_b32 s36, s32, 3
    s_lshl_b32 s36, s36, 2
    s_add_u32 s37, s37, s36
    s_and_b32 s36, s32, 8
    s_lshl_b32 s36, s36, 1
    s_add_u32 s37, s37, s36
    s_lshr_b32 s37, s37, 2
    v_readlane_b32 s37, v40, s37
    s_min_u32 s37, s37, 32
    s_sub_u32 s39, 32, s37
    s_cmp_lt_u32 s38, s39
    s_cbranch_scc1 L_of3
    s_sub_u32 s38, s38, s39
    s_add_u32 s32, s32, 1
    s_cmp_lt_u32 s32, 8
    s_cbranch_scc1 L_of2
    s_branch L_end
L_of3:
    s_add_u32 s33, s37, s38
    s_and_b32 s33, s33, 31
    s_branch L_roles
L_end:
    s_endpgm
.section .rodata,"a"
.p2align 6
.amdhsa_kernel interleave_layers__linear_attn_block__memory_aug_recurrent_mem_tr__prompt_kernel
  .amdhsa_next_free_vgpr 512
  .amdhsa_next_free_sgpr 102
  .amdhsa_accum_offset 256
  .amdhsa_group_segment_fixed_size 0
  .amdhsa_kernarg_size 104
  .amdhsa_user_sgpr_count 2
  .amdhsa_user_sgpr_kernarg_segment_ptr 1
  .amdhsa_system_sgpr_workgroup_id_x 1
.end_amdhsa_kernel
```
